```python
import torch

def _softmax(x, axis=-1):
    return torch.softmax(x, dim=axis)
def _gelu(x):
    return torch.nn.functional.gelu(x, approximate="tanh")
def _silu(x):
    return torch.nn.functional.silu(x)
def _sigmoid(x):
    return torch.sigmoid(x)
def _layernorm(x, axis=-1, eps=1e-5):
    m = x.mean(dim=axis, keepdim=True)
    v = x.var(dim=axis, keepdim=True, unbiased=False)
    return (x - m) / torch.sqrt(v + eps)
def _scatter_add(tgt, idx, src, axis=0):
    return tgt.clone().index_add_(axis, idx, src)
def _segment_sum(src, seg, n):
    out = torch.zeros((n,) + src.shape[1:], dtype=src.dtype)
    return out.index_add_(0, seg, src)
def _pad(x, pw):
    flat = tuple(v for pair in reversed(pw) for v in pair)
    return torch.nn.functional.pad(x, flat)

kernel_name = 'sequential_preLN__sliding_block__mixer_token_mlp__prompt'

def setup_inputs():

    _w = (lambda a: (lambda t: t.to(torch.bfloat16) if t.is_floating_point() else t)(torch.as_tensor(a)))
    def _A_setup():
        B, S, D = 1, 2048, 576
        return {
            "x": _w((lambda *s: torch.randn(*s, dtype=torch.bfloat16) * 0.05)(B, S, D)),
            "wqkv": _w((lambda *s: torch.randn(*s, dtype=torch.bfloat16) * 0.05)(D, 3 * D)),
            "wo": _w((lambda *s: torch.randn(*s, dtype=torch.bfloat16) * 0.05)(D, D)),
        }
    _A_in = _A_setup()

    def _B_setup():
        B, S, D, F = 1, 2048, 576, 4608
        return {
            "x": _w((lambda *s: torch.randn(*s, dtype=torch.bfloat16) * 0.05)(B, S, D)),
            "w1": _w((lambda *s: torch.randn(*s, dtype=torch.bfloat16) * 0.8)(S, F) * (S ** -0.5)),
            "b1": _w((lambda *s: torch.randn(*s, dtype=torch.bfloat16) * 0.8)(F) * 0.02),
            "w2": _w((lambda *s: torch.randn(*s, dtype=torch.bfloat16) * 0.8)(F, S) * (F ** -0.5)),
            "b2": _w((lambda *s: torch.randn(*s, dtype=torch.bfloat16) * 0.8)(S) * 0.02),
        }
    _B_in = _B_setup()

    return {
        "A_x": _A_in["x"],
        "A_wqkv": _A_in["wqkv"],
        "A_wo": _A_in["wo"],
        "B_x": _B_in["x"],
        "B_w1": _B_in["w1"],
        "B_b1": _B_in["b1"],
        "B_w2": _B_in["w2"],
        "B_b2": _B_in["b2"],
    }

def reference(A_x, A_wqkv, A_wo, B_x, B_w1, B_b1, B_w2, B_b2):
    def _A_ref(x, wqkv, wo):
        B, S, D = x.shape
        H = 32; Dh = D // H; W = 256
        qkv = (lambda x, *d: x.permute(*d))((x @ wqkv).reshape(B, S, 3, H, Dh), 2, 0, 3, 1, 4)
        q, k, v = qkv[0], qkv[1], qkv[2]
        scores = torch.einsum("bhqd,bhkd->bhqk", q, k) * (Dh ** -0.5)
        idx = torch.arange(S)
        mask = (idx[:, None] - idx[None, :] >= 0) & (idx[:, None] - idx[None, :] < W)
        scores = torch.where(mask[None, None], scores, -1e9)
        p = _softmax(scores, axis=-1)
        o = torch.einsum("bhqk,bhkd->bhqd", p, v)
        return (lambda x, *d: x.permute(*d))(o, 0, 2, 1, 3).reshape(B, S, D) @ wo

    def _B_ref(x, w1, b1, w2, b2):
        B, S, D = x.shape
        h = _layernorm(x, axis=-1)
        u = torch.einsum("bsd,sf->bdf", h, w1) + b1
        u = _gelu(u)
        y = torch.einsum("bdf,fs->bds", u, w2) + b2
        return (lambda x, *d: x.permute(*d))(y, 0, 2, 1)

    x = A_x
    h = x + _A_ref(_layernorm(x, axis=-1), A_wqkv, A_wo)
    h2 = h + _B_ref(_layernorm(h, axis=-1), B_w1, B_b1, B_w2, B_b2)
    return h2
```

```asm
; @launch grid=(256,1,1) block=(512,1,1) lds=163840
.amdgcn_target "amdgcn-amd-amdhsa--gfx950"
.text
.globl sequential_preLN__sliding_block__mixer_token_mlp__prompt_kernel
.p2align 8
.type sequential_preLN__sliding_block__mixer_token_mlp__prompt_kernel,@function
sequential_preLN__sliding_block__mixer_token_mlp__prompt_kernel:
    s_cmp_ge_u32 s2, 192
    s_cbranch_scc1 k1_pf
    s_load_dwordx4 s[32:35], s[0:1], 0
    s_load_dwordx4 s[36:39], s[0:1], 72
    v_lshrrev_b32 v1, 6, v0
    v_and_b32 v0, 63, v0
    v_readfirstlane_b32 s20, v1
    s_lshr_b32 s23, s2, 3
    s_mul_i32 s21, s23, 43
    s_lshr_b32 s21, s21, 8
    s_mul_i32 s22, s21, 6
    s_sub_u32 s22, s23, s22
    s_bfe_u32 s23, s2, 0x20001
    s_lshl_b32 s23, s23, 2
    s_add_u32 s21, s21, s23
    s_and_b32 s23, s2, 1
    s_mul_i32 s23, s23, 6
    s_add_u32 s22, s22, s23
    s_lshr_b32 s28, s22, 2
    s_and_b32 s29, s22, 3
    s_mov_b32 s3, s20
    s_mul_i32 s25, s28, 1152
    s_mul_i32 s41, s29, 288
    s_add_u32 s25, s25, s41
    s_and_b32 s30, s20, 3
    s_mul_i32 s23, s30, 320
    s_mul_i32 s41, s30, 5120
    s_add_u32 s41, s41, 16384
    s_cmp_ge_u32 s20, 4
    s_cbranch_scc1 k1_loader
    v_add_u32 v40, s23, v0
    v_mul_u32_u24 v41, 6899, v40
    v_lshrrev_b32 v41, 20, v41
    v_mul_u32_u24 v42, 152, v41
    v_sub_u32 v42, v40, v42
    v_mul_u32_u24 v43, 3641, v42
    v_lshrrev_b32 v43, 16, v43
    v_mul_u32_u24 v44, 18, v43
    v_sub_u32 v44, v42, v44
    v_lshl_add_u32 v43, v41, 3, v43
    v_mul_u32_u24 v43, 3456, v43
    v_lshl_add_u32 v43, v44, 4, v43
    v_cmp_lt_u32 vcc, 143, v42
    v_mov_b32 v44, 0x40000000
    s_nop 0
    v_cndmask_b32 v46, v43, v44, vcc
    s_waitcnt lgkmcnt(0)
    s_mov_b32 s12, s34
    s_and_b32 s13, s35, 0xffff
    s_mov_b32 s14, 0x1e6000
    s_mov_b32 s15, 0x20000
    s_add_u32 m0, s41, 0
    s_nop 0
    buffer_load_dwordx4 v46, s[12:15], s25 offen lds
    v_add_u32 v40, s23, v0
    v_add_u32 v40, 64, v40
    v_mul_u32_u24 v41, 6899, v40
    v_lshrrev_b32 v41, 20, v41
    v_mul_u32_u24 v42, 152, v41
    v_sub_u32 v42, v40, v42
    v_mul_u32_u24 v43, 3641, v42
    v_lshrrev_b32 v43, 16, v43
    v_mul_u32_u24 v44, 18, v43
    v_sub_u32 v44, v42, v44
    v_lshl_add_u32 v43, v41, 3, v43
    v_mul_u32_u24 v43, 3456, v43
    v_lshl_add_u32 v43, v44, 4, v43
    v_cmp_lt_u32 vcc, 143, v42
    v_mov_b32 v44, 0x40000000
    s_nop 0
    v_cndmask_b32 v47, v43, v44, vcc
    s_add_u32 m0, s41, 1024
    s_nop 0
    buffer_load_dwordx4 v47, s[12:15], s25 offen lds
    v_add_u32 v40, s23, v0
    v_add_u32 v40, 128, v40
    v_mul_u32_u24 v41, 6899, v40
    v_lshrrev_b32 v41, 20, v41
    v_mul_u32_u24 v42, 152, v41
    v_sub_u32 v42, v40, v42
    v_mul_u32_u24 v43, 3641, v42
    v_lshrrev_b32 v43, 16, v43
    v_mul_u32_u24 v44, 18, v43
    v_sub_u32 v44, v42, v44
    v_lshl_add_u32 v43, v41, 3, v43
    v_mul_u32_u24 v43, 3456, v43
    v_lshl_add_u32 v43, v44, 4, v43
    v_cmp_lt_u32 vcc, 143, v42
    v_mov_b32 v44, 0x40000000
    s_nop 0
    v_cndmask_b32 v48, v43, v44, vcc
    s_add_u32 m0, s41, 2048
    s_nop 0
    buffer_load_dwordx4 v48, s[12:15], s25 offen lds
    v_lshrrev_b32 v2, 4, v0
    v_bfe_u32 v3, v0, 2, 2
    v_and_b32 v4, 3, v0
    v_and_b32 v5, 15, v0
    v_lshrrev_b32 v6, 1, v5
    v_xor_b32 v6, v6, v2
    s_lshl_b32 s23, s20, 12
    v_lshlrev_b32 v7, 7, v5
    v_add_u32 v7, s23, v7
    v_lshl_add_u32 v8, v6, 4, v7
    v_xor_b32 v9, 64, v8
    v_lshl_add_u32 v6, v2, 3, v3
    v_mul_u32_u24 v6, 288, v6
    v_lshl_add_u32 v6, v2, 7, v6
    v_add_u32 v7, 16384, v6
    v_lshl_add_u32 v10, v4, 3, v7
    v_mul_u32_u24 v6, 72, v4
    v_add3_u32 v11, v6, v7, 32
    v_mov_b32 v64, 0
    v_mov_b32 v65, 0
    v_mov_b32 v66, 0
    v_mov_b32 v67, 0
    v_mov_b32 v68, 0
    v_mov_b32 v69, 0
    v_mov_b32 v70, 0
    v_mov_b32 v71, 0
    v_mov_b32 v72, 0
    v_mov_b32 v73, 0
    v_mov_b32 v74, 0
    v_mov_b32 v75, 0
    v_mov_b32 v76, 0
    v_mov_b32 v77, 0
    v_mov_b32 v78, 0
    v_mov_b32 v79, 0
    v_mov_b32 v80, 0
    v_mov_b32 v81, 0
    v_mov_b32 v82, 0
    v_mov_b32 v83, 0
    v_mov_b32 v84, 0
    v_mov_b32 v85, 0
    v_mov_b32 v86, 0
    v_mov_b32 v87, 0
    v_mov_b32 v88, 0
    v_mov_b32 v89, 0
    v_mov_b32 v90, 0
    v_mov_b32 v91, 0
    v_mov_b32 v92, 0
    v_mov_b32 v93, 0
    v_mov_b32 v94, 0
    v_mov_b32 v95, 0
    v_mov_b32 v96, 0
    v_mov_b32 v97, 0
    v_mov_b32 v98, 0
    v_mov_b32 v99, 0
    v_mov_b32 v100, 0
    v_mov_b32 v101, 0
    v_mov_b32 v102, 0
    v_mov_b32 v103, 0
    v_mov_b32 v104, 0
    v_mov_b32 v105, 0
    v_mov_b32 v106, 0
    v_mov_b32 v107, 0
    v_mov_b32 v108, 0
    v_mov_b32 v109, 0
    v_mov_b32 v110, 0
    v_mov_b32 v111, 0
    v_mov_b32 v112, 0
    v_mov_b32 v113, 0
    v_mov_b32 v114, 0
    v_mov_b32 v115, 0
    v_mov_b32 v116, 0
    v_mov_b32 v117, 0
    v_mov_b32 v118, 0
    v_mov_b32 v119, 0
    v_mov_b32 v120, 0
    v_mov_b32 v121, 0
    v_mov_b32 v122, 0
    v_mov_b32 v123, 0
    v_mov_b32 v124, 0
    v_mov_b32 v125, 0
    v_mov_b32 v126, 0
    v_mov_b32 v127, 0
    v_mov_b32 v128, 0
    v_mov_b32 v129, 0
    v_mov_b32 v130, 0
    v_mov_b32 v131, 0
    v_mov_b32 v132, 0
    v_mov_b32 v133, 0
    v_mov_b32 v134, 0
    v_mov_b32 v135, 0
    s_mov_b32 s16, s38
    s_and_b32 s17, s39, 0xffff
    s_mov_b32 s18, 0x1c06000
    s_mov_b32 s19, 0x20000
    s_waitcnt vmcnt(0)
    s_cmp_eq_u32 s28, 2
    s_cbranch_scc1 k1_vb
    s_mov_b32 s26, 0
    v_add_u32 v12, s26, v8
    v_add_u32 v13, s26, v9
    v_add_u32 v14, s26, v10
    v_add_u32 v15, s26, v11
    s_barrier
    ds_read_b128 v[136:139], v12 offset:0
    ds_read_b64_tr_b16 v[144:145], v14 offset:0
    ds_read_b64_tr_b16 v[146:147], v14 offset:1152
    ds_read_b128 v[140:143], v12 offset:2048
    ds_read_b64_tr_b16 v[148:149], v14 offset:40
    ds_read_b64_tr_b16 v[150:151], v14 offset:1192
    ds_read_b64_tr_b16 v[152:153], v14 offset:72
    ds_read_b64_tr_b16 v[154:155], v14 offset:1224
    ds_read_b64_tr_b16 v[156:157], v14 offset:112
    ds_read_b64_tr_b16 v[158:159], v14 offset:1264
    ds_read_b64_tr_b16 v[160:161], v14 offset:144
    ds_read_b64_tr_b16 v[162:163], v14 offset:1296
    ds_read_b64_tr_b16 v[164:165], v14 offset:184
    ds_read_b64_tr_b16 v[166:167], v14 offset:1336
    ds_read_b64_tr_b16 v[168:169], v14 offset:216
    ds_read_b64_tr_b16 v[170:171], v14 offset:1368
    ds_read_b64_tr_b16 v[172:173], v14 offset:256
    ds_read_b64_tr_b16 v[174:175], v14 offset:1408
    ds_read_b64_tr_b16 v[176:177], v15 offset:0
    ds_read_b64_tr_b16 v[178:179], v15 offset:1152
    s_mov_b32 s27, 8
k1_cp_loopa:
    s_waitcnt lgkmcnt(15)
    v_mfma_f32_16x16x32_bf16 v[64:67], v[144:147], v[136:139], v[64:67]
    ds_read_b128 v[180:183], v13 offset:0
    ds_read_b64_tr_b16 v[188:189], v14 offset:9728
    v_mfma_f32_16x16x32_bf16 v[68:71], v[144:147], v[140:143], v[68:71]
    ds_read_b64_tr_b16 v[190:191], v14 offset:10880
    s_waitcnt lgkmcnt(15)
    v_mfma_f32_16x16x32_bf16 v[72:75], v[148:151], v[136:139], v[72:75]
    ds_read_b128 v[184:187], v13 offset:2048
    v_mfma_f32_16x16x32_bf16 v[76:79], v[148:151], v[140:143], v[76:79]
    ds_read_b64_tr_b16 v[192:193], v14 offset:9768
    v_mfma_f32_16x16x32_bf16 v[80:83], v[152:155], v[136:139], v[80:83]
    ds_read_b64_tr_b16 v[194:195], v14 offset:10920
    v_mfma_f32_16x16x32_bf16 v[84:87], v[152:155], v[140:143], v[84:87]
    ds_read_b64_tr_b16 v[196:197], v14 offset:9800
    s_waitcnt lgkmcnt(15)
    v_mfma_f32_16x16x32_bf16 v[88:91], v[156:159], v[136:139], v[88:91]
    ds_read_b64_tr_b16 v[198:199], v14 offset:10952
    v_mfma_f32_16x16x32_bf16 v[92:95], v[156:159], v[140:143], v[92:95]
    ds_read_b64_tr_b16 v[200:201], v14 offset:9840
    v_mfma_f32_16x16x32_bf16 v[96:99], v[160:163], v[136:139], v[96:99]
    ds_read_b64_tr_b16 v[202:203], v14 offset:10992
    v_mfma_f32_16x16x32_bf16 v[100:103], v[160:163], v[140:143], v[100:103]
    ds_read_b64_tr_b16 v[204:205], v14 offset:9872
    ds_read_b64_tr_b16 v[206:207], v14 offset:11024
    s_waitcnt lgkmcnt(15)
    v_mfma_f32_16x16x32_bf16 v[104:107], v[164:167], v[136:139], v[104:107]
    ds_read_b64_tr_b16 v[208:209], v14 offset:9912
    v_mfma_f32_16x16x32_bf16 v[108:111], v[164:167], v[140:143], v[108:111]
    ds_read_b64_tr_b16 v[210:211], v14 offset:11064
    v_mfma_f32_16x16x32_bf16 v[112:115], v[168:171], v[136:139], v[112:115]
    ds_read_b64_tr_b16 v[212:213], v14 offset:9944
    v_mfma_f32_16x16x32_bf16 v[116:119], v[168:171], v[140:143], v[116:119]
    ds_read_b64_tr_b16 v[214:215], v14 offset:11096
    s_waitcnt lgkmcnt(15)
    v_mfma_f32_16x16x32_bf16 v[120:123], v[172:175], v[136:139], v[120:123]
    ds_read_b64_tr_b16 v[216:217], v14 offset:9984
    v_mfma_f32_16x16x32_bf16 v[124:127], v[172:175], v[140:143], v[124:127]
    ds_read_b64_tr_b16 v[218:219], v14 offset:11136
    v_mfma_f32_16x16x32_bf16 v[128:131], v[176:179], v[136:139], v[128:131]
    ds_read_b64_tr_b16 v[220:221], v15 offset:9728
    v_mfma_f32_16x16x32_bf16 v[132:135], v[176:179], v[140:143], v[132:135]
    ds_read_b64_tr_b16 v[222:223], v15 offset:10880
    s_add_u32 s26, s26, 35840
    s_cmp_eq_u32 s26, 143360
    s_cselect_b32 s26, 0, s26
    s_barrier
    s_waitcnt lgkmcnt(15)
    v_mfma_f32_16x16x32_bf16 v[64:67], v[188:191], v[180:183], v[64:67]
    v_add_u32 v12, s26, v8
    v_add_u32 v13, s26, v9
    v_mfma_f32_16x16x32_bf16 v[68:71], v[188:191], v[184:187], v[68:71]
    v_add_u32 v14, s26, v10
    s_waitcnt lgkmcnt(14)
    v_mfma_f32_16x16x32_bf16 v[72:75], v[192:195], v[180:183], v[72:75]
    v_add_u32 v15, s26, v11
    v_mfma_f32_16x16x32_bf16 v[76:79], v[192:195], v[184:187], v[76:79]
    ds_read_b128 v[136:139], v12 offset:0
    ds_read_b64_tr_b16 v[144:145], v14 offset:0
    s_waitcnt lgkmcnt(14)
    v_mfma_f32_16x16x32_bf16 v[80:83], v[196:199], v[180:183], v[80:83]
    ds_read_b64_tr_b16 v[146:147], v14 offset:1152
    v_mfma_f32_16x16x32_bf16 v[84:87], v[196:199], v[184:187], v[84:87]
    ds_read_b128 v[140:143], v12 offset:2048
    s_waitcnt lgkmcnt(14)
    v_mfma_f32_16x16x32_bf16 v[88:91], v[200:203], v[180:183], v[88:91]
    ds_read_b64_tr_b16 v[148:149], v14 offset:40
    ds_read_b64_tr_b16 v[150:151], v14 offset:1192
    v_mfma_f32_16x16x32_bf16 v[92:95], v[200:203], v[184:187], v[92:95]
    ds_read_b64_tr_b16 v[152:153], v14 offset:72
    s_waitcnt lgkmcnt(15)
    v_mfma_f32_16x16x32_bf16 v[96:99], v[204:207], v[180:183], v[96:99]
    ds_read_b64_tr_b16 v[154:155], v14 offset:1224
    v_mfma_f32_16x16x32_bf16 v[100:103], v[204:207], v[184:187], v[100:103]
    ds_read_b64_tr_b16 v[156:157], v14 offset:112
    ds_read_b64_tr_b16 v[158:159], v14 offset:1264
    s_waitcnt lgkmcnt(15)
    v_mfma_f32_16x16x32_bf16 v[104:107], v[208:211], v[180:183], v[104:107]
    ds_read_b64_tr_b16 v[160:161], v14 offset:144
    v_mfma_f32_16x16x32_bf16 v[108:111], v[208:211], v[184:187], v[108:111]
    ds_read_b64_tr_b16 v[162:163], v14 offset:1296
    s_waitcnt lgkmcnt(15)
    v_mfma_f32_16x16x32_bf16 v[112:115], v[212:215], v[180:183], v[112:115]
    ds_read_b64_tr_b16 v[164:165], v14 offset:184
    ds_read_b64_tr_b16 v[166:167], v14 offset:1336
    v_mfma_f32_16x16x32_bf16 v[116:119], v[212:215], v[184:187], v[116:119]
    ds_read_b64_tr_b16 v[168:169], v14 offset:216
    s_waitcnt lgkmcnt(15)
    v_mfma_f32_16x16x32_bf16 v[120:123], v[216:219], v[180:183], v[120:123]
    ds_read_b64_tr_b16 v[170:171], v14 offset:1368
    v_mfma_f32_16x16x32_bf16 v[124:127], v[216:219], v[184:187], v[124:127]
    ds_read_b64_tr_b16 v[172:173], v14 offset:256
    ds_read_b64_tr_b16 v[174:175], v14 offset:1408
    v_mfma_f32_16x16x32_bf16 v[128:131], v[220:223], v[180:183], v[128:131]
    ds_read_b64_tr_b16 v[176:177], v15 offset:0
    v_mfma_f32_16x16x32_bf16 v[132:135], v[220:223], v[184:187], v[132:135]
    ds_read_b64_tr_b16 v[178:179], v15 offset:1152
    s_sub_u32 s27, s27, 1
    s_cmp_lg_u32 s27, 0
    s_cbranch_scc1 k1_cp_loopa
    s_waitcnt lgkmcnt(15)
    v_mfma_f32_16x16x32_bf16 v[64:67], v[144:147], v[136:139], v[64:67]
    ds_read_b128 v[180:183], v13 offset:0
    ds_read_b64_tr_b16 v[188:189], v14 offset:9728
    v_mfma_f32_16x16x32_bf16 v[68:71], v[144:147], v[140:143], v[68:71]
    ds_read_b64_tr_b16 v[190:191], v14 offset:10880
    s_waitcnt lgkmcnt(15)
    v_mfma_f32_16x16x32_bf16 v[72:75], v[148:151], v[136:139], v[72:75]
    ds_read_b128 v[184:187], v13 offset:2048
    v_mfma_f32_16x16x32_bf16 v[76:79], v[148:151], v[140:143], v[76:79]
    ds_read_b64_tr_b16 v[192:193], v14 offset:9768
    v_mfma_f32_16x16x32_bf16 v[80:83], v[152:155], v[136:139], v[80:83]
    ds_read_b64_tr_b16 v[194:195], v14 offset:10920
    v_mfma_f32_16x16x32_bf16 v[84:87], v[152:155], v[140:143], v[84:87]
    ds_read_b64_tr_b16 v[196:197], v14 offset:9800
    s_waitcnt lgkmcnt(15)
    v_mfma_f32_16x16x32_bf16 v[88:91], v[156:159], v[136:139], v[88:91]
    ds_read_b64_tr_b16 v[198:199], v14 offset:10952
    v_mfma_f32_16x16x32_bf16 v[92:95], v[156:159], v[140:143], v[92:95]
    ds_read_b64_tr_b16 v[200:201], v14 offset:9840
    v_mfma_f32_16x16x32_bf16 v[96:99], v[160:163], v[136:139], v[96:99]
    ds_read_b64_tr_b16 v[202:203], v14 offset:10992
    v_mfma_f32_16x16x32_bf16 v[100:103], v[160:163], v[140:143], v[100:103]
    ds_read_b64_tr_b16 v[204:205], v14 offset:9872
    ds_read_b64_tr_b16 v[206:207], v14 offset:11024
    s_waitcnt lgkmcnt(15)
    v_mfma_f32_16x16x32_bf16 v[104:107], v[164:167], v[136:139], v[104:107]
    ds_read_b64_tr_b16 v[208:209], v14 offset:9912
    v_mfma_f32_16x16x32_bf16 v[108:111], v[164:167], v[140:143], v[108:111]
    ds_read_b64_tr_b16 v[210:211], v14 offset:11064
    v_mfma_f32_16x16x32_bf16 v[112:115], v[168:171], v[136:139], v[112:115]
    ds_read_b64_tr_b16 v[212:213], v14 offset:9944
    v_mfma_f32_16x16x32_bf16 v[116:119], v[168:171], v[140:143], v[116:119]
    ds_read_b64_tr_b16 v[214:215], v14 offset:11096
    s_waitcnt lgkmcnt(15)
    v_mfma_f32_16x16x32_bf16 v[120:123], v[172:175], v[136:139], v[120:123]
    ds_read_b64_tr_b16 v[216:217], v14 offset:9984
    v_mfma_f32_16x16x32_bf16 v[124:127], v[172:175], v[140:143], v[124:127]
    ds_read_b64_tr_b16 v[218:219], v14 offset:11136
    v_mfma_f32_16x16x32_bf16 v[128:131], v[176:179], v[136:139], v[128:131]
    ds_read_b64_tr_b16 v[220:221], v15 offset:9728
    v_mfma_f32_16x16x32_bf16 v[132:135], v[176:179], v[140:143], v[132:135]
    ds_read_b64_tr_b16 v[222:223], v15 offset:10880
    s_waitcnt lgkmcnt(15)
    v_mfma_f32_16x16x32_bf16 v[64:67], v[188:191], v[180:183], v[64:67]
    v_mfma_f32_16x16x32_bf16 v[68:71], v[188:191], v[184:187], v[68:71]
    s_waitcnt lgkmcnt(14)
    v_mfma_f32_16x16x32_bf16 v[72:75], v[192:195], v[180:183], v[72:75]
    v_mfma_f32_16x16x32_bf16 v[76:79], v[192:195], v[184:187], v[76:79]
    s_waitcnt lgkmcnt(12)
    v_mfma_f32_16x16x32_bf16 v[80:83], v[196:199], v[180:183], v[80:83]
    v_mfma_f32_16x16x32_bf16 v[84:87], v[196:199], v[184:187], v[84:87]
    s_waitcnt lgkmcnt(10)
    v_mfma_f32_16x16x32_bf16 v[88:91], v[200:203], v[180:183], v[88:91]
    v_mfma_f32_16x16x32_bf16 v[92:95], v[200:203], v[184:187], v[92:95]
    s_waitcnt lgkmcnt(8)
    v_mfma_f32_16x16x32_bf16 v[96:99], v[204:207], v[180:183], v[96:99]
    v_mfma_f32_16x16x32_bf16 v[100:103], v[204:207], v[184:187], v[100:103]
    s_waitcnt lgkmcnt(6)
    v_mfma_f32_16x16x32_bf16 v[104:107], v[208:211], v[180:183], v[104:107]
    v_mfma_f32_16x16x32_bf16 v[108:111], v[208:211], v[184:187], v[108:111]
    s_waitcnt lgkmcnt(4)
    v_mfma_f32_16x16x32_bf16 v[112:115], v[212:215], v[180:183], v[112:115]
    v_mfma_f32_16x16x32_bf16 v[116:119], v[212:215], v[184:187], v[116:119]
    s_waitcnt lgkmcnt(2)
    v_mfma_f32_16x16x32_bf16 v[120:123], v[216:219], v[180:183], v[120:123]
    v_mfma_f32_16x16x32_bf16 v[124:127], v[216:219], v[184:187], v[124:127]
    s_waitcnt lgkmcnt(0)
    v_mfma_f32_16x16x32_bf16 v[128:131], v[220:223], v[180:183], v[128:131]
    v_mfma_f32_16x16x32_bf16 v[132:135], v[220:223], v[184:187], v[132:135]
    s_lshl_b32 s42, s29, 9
    s_lshl_b32 s43, s21, 2
    s_add_u32 s43, s43, s20
    s_add_u32 s42, s42, s43
    s_barrier
    s_lshl_b32 s46, s20, 7
    s_add_u32 s46, s46, 144000
    v_lshlrev_b32 v7, 2, v5
    v_add_u32 v7, s46, v7
    ds_read_b32 v172, v7 offset:0
    ds_read_b32 v174, v7 offset:512
    ds_read_b32 v173, v7 offset:64
    ds_read_b32 v175, v7 offset:576
    v_lshlrev_b32 v6, 4, v2
    v_add_u32 v6, 143360, v6
    ds_read_b128 v[136:139], v6 offset:0
    ds_read_b128 v[140:143], v6 offset:64
    ds_read_b128 v[144:147], v6 offset:128
    ds_read_b128 v[148:151], v6 offset:192
    ds_read_b128 v[152:155], v6 offset:256
    ds_read_b128 v[156:159], v6 offset:320
    ds_read_b128 v[160:163], v6 offset:384
    ds_read_b128 v[164:167], v6 offset:448
    ds_read_b128 v[168:171], v6 offset:512
    s_lshl_b32 s44, s42, 10
    s_mul_i32 s45, s28, 2097152
    s_add_u32 s44, s44, s45
    s_add_u32 s44, s44, 2359296
    v_lshlrev_b32 v36, 4, v0
    s_lshl_b32 s45, s28, 18
    s_lshl_b32 s46, s29, 16
    s_add_u32 s45, s45, s46
    s_lshl_b32 s46, s43, 8
    s_add_u32 s45, s45, s46
    s_add_u32 s45, s45, 8912896
    v_lshlrev_b32 v37, 14, v2
    v_lshl_add_u32 v37, v5, 3, v37
    s_waitcnt lgkmcnt(0)
    v_mul_f32 v40, v136, v174
    v_mul_f32 v41, v137, v174
    v_mul_f32 v42, v138, v174
    v_mul_f32 v43, v139, v174
    v_fma_f32 v64, v64, v172, -v40
    v_fma_f32 v65, v65, v172, -v41
    v_fma_f32 v66, v66, v172, -v42
    v_fma_f32 v67, v67, v172, -v43
    v_mul_f32 v40, v136, v175
    v_mul_f32 v41, v137, v175
    v_mul_f32 v42, v138, v175
    v_mul_f32 v43, v139, v175
    v_fma_f32 v68, v68, v173, -v40
    v_fma_f32 v69, v69, v173, -v41
    v_fma_f32 v70, v70, v173, -v42
    v_fma_f32 v71, v71, v173, -v43
    v_cvt_pk_bf16_f32 v64, v64, v65
    v_cvt_pk_bf16_f32 v65, v66, v67
    v_cvt_pk_bf16_f32 v66, v68, v69
    v_cvt_pk_bf16_f32 v67, v70, v71
    s_nop 0
    v_permlane16_swap_b32 v64, v66
    v_permlane16_swap_b32 v65, v67
    buffer_store_dwordx4 v[64:67], v36, s[16:19], s44 offen sc1
    s_add_u32 s44, s44, 65536
    v_mul_f32 v40, v140, v174
    v_mul_f32 v41, v141, v174
    v_mul_f32 v42, v142, v174
    v_mul_f32 v43, v143, v174
    v_fma_f32 v72, v72, v172, -v40
    v_fma_f32 v73, v73, v172, -v41
    v_fma_f32 v74, v74, v172, -v42
    v_fma_f32 v75, v75, v172, -v43
    v_mul_f32 v40, v140, v175
    v_mul_f32 v41, v141, v175
    v_mul_f32 v42, v142, v175
    v_mul_f32 v43, v143, v175
    v_fma_f32 v76, v76, v173, -v40
    v_fma_f32 v77, v77, v173, -v41
    v_fma_f32 v78, v78, v173, -v42
    v_fma_f32 v79, v79, v173, -v43
    v_cvt_pk_bf16_f32 v72, v72, v73
    v_cvt_pk_bf16_f32 v73, v74, v75
    v_cvt_pk_bf16_f32 v74, v76, v77
    v_cvt_pk_bf16_f32 v75, v78, v79
    s_nop 0
    v_permlane16_swap_b32 v72, v74
    v_permlane16_swap_b32 v73, v75
    buffer_store_dwordx4 v[72:75], v36, s[16:19], s44 offen sc1
    s_add_u32 s44, s44, 65536
    v_mul_f32 v40, v144, v174
    v_mul_f32 v41, v145, v174
    v_mul_f32 v42, v146, v174
    v_mul_f32 v43, v147, v174
    v_fma_f32 v80, v80, v172, -v40
    v_fma_f32 v81, v81, v172, -v41
    v_fma_f32 v82, v82, v172, -v42
    v_fma_f32 v83, v83, v172, -v43
    v_mul_f32 v40, v144, v175
    v_mul_f32 v41, v145, v175
    v_mul_f32 v42, v146, v175
    v_mul_f32 v43, v147, v175
    v_fma_f32 v84, v84, v173, -v40
    v_fma_f32 v85, v85, v173, -v41
    v_fma_f32 v86, v86, v173, -v42
    v_fma_f32 v87, v87, v173, -v43
    v_cvt_pk_bf16_f32 v80, v80, v81
    v_cvt_pk_bf16_f32 v81, v82, v83
    v_cvt_pk_bf16_f32 v82, v84, v85
    v_cvt_pk_bf16_f32 v83, v86, v87
    s_nop 0
    v_permlane16_swap_b32 v80, v82
    v_permlane16_swap_b32 v81, v83
    buffer_store_dwordx4 v[80:83], v36, s[16:19], s44 offen sc1
    s_add_u32 s44, s44, 65536
    v_mul_f32 v40, v148, v174
    v_mul_f32 v41, v149, v174
    v_mul_f32 v42, v150, v174
    v_mul_f32 v43, v151, v174
    v_fma_f32 v88, v88, v172, -v40
    v_fma_f32 v89, v89, v172, -v41
    v_fma_f32 v90, v90, v172, -v42
    v_fma_f32 v91, v91, v172, -v43
    v_mul_f32 v40, v148, v175
    v_mul_f32 v41, v149, v175
    v_mul_f32 v42, v150, v175
    v_mul_f32 v43, v151, v175
    v_fma_f32 v92, v92, v173, -v40
    v_fma_f32 v93, v93, v173, -v41
    v_fma_f32 v94, v94, v173, -v42
    v_fma_f32 v95, v95, v173, -v43
    v_cvt_pk_bf16_f32 v88, v88, v89
    v_cvt_pk_bf16_f32 v89, v90, v91
    v_cvt_pk_bf16_f32 v90, v92, v93
    v_cvt_pk_bf16_f32 v91, v94, v95
    s_nop 0
    v_permlane16_swap_b32 v88, v90
    v_permlane16_swap_b32 v89, v91
    buffer_store_dwordx4 v[88:91], v36, s[16:19], s44 offen sc1
    s_add_u32 s44, s44, 65536
    v_mul_f32 v40, v152, v174
    v_mul_f32 v41, v153, v174
    v_mul_f32 v42, v154, v174
    v_mul_f32 v43, v155, v174
    v_fma_f32 v96, v96, v172, -v40
    v_fma_f32 v97, v97, v172, -v41
    v_fma_f32 v98, v98, v172, -v42
    v_fma_f32 v99, v99, v172, -v43
    v_mul_f32 v40, v152, v175
    v_mul_f32 v41, v153, v175
    v_mul_f32 v42, v154, v175
    v_mul_f32 v43, v155, v175
    v_fma_f32 v100, v100, v173, -v40
    v_fma_f32 v101, v101, v173, -v41
    v_fma_f32 v102, v102, v173, -v42
    v_fma_f32 v103, v103, v173, -v43
    v_cvt_pk_bf16_f32 v96, v96, v97
    v_cvt_pk_bf16_f32 v97, v98, v99
    v_cvt_pk_bf16_f32 v98, v100, v101
    v_cvt_pk_bf16_f32 v99, v102, v103
    s_nop 0
    v_permlane16_swap_b32 v96, v98
    v_permlane16_swap_b32 v97, v99
    buffer_store_dwordx4 v[96:99], v36, s[16:19], s44 offen sc1
    s_add_u32 s44, s44, 65536
    v_mul_f32 v40, v156, v174
    v_mul_f32 v41, v157, v174
    v_mul_f32 v42, v158, v174
    v_mul_f32 v43, v159, v174
    v_fma_f32 v104, v104, v172, -v40
    v_fma_f32 v105, v105, v172, -v41
    v_fma_f32 v106, v106, v172, -v42
    v_fma_f32 v107, v107, v172, -v43
    v_mul_f32 v40, v156, v175
    v_mul_f32 v41, v157, v175
    v_mul_f32 v42, v158, v175
    v_mul_f32 v43, v159, v175
    v_fma_f32 v108, v108, v173, -v40
    v_fma_f32 v109, v109, v173, -v41
    v_fma_f32 v110, v110, v173, -v42
    v_fma_f32 v111, v111, v173, -v43
    v_cvt_pk_bf16_f32 v104, v104, v105
    v_cvt_pk_bf16_f32 v105, v106, v107
    v_cvt_pk_bf16_f32 v106, v108, v109
    v_cvt_pk_bf16_f32 v107, v110, v111
    s_nop 0
    v_permlane16_swap_b32 v104, v106
    v_permlane16_swap_b32 v105, v107
    buffer_store_dwordx4 v[104:107], v36, s[16:19], s44 offen sc1
    s_add_u32 s44, s44, 65536
    v_mul_f32 v40, v160, v174
    v_mul_f32 v41, v161, v174
    v_mul_f32 v42, v162, v174
    v_mul_f32 v43, v163, v174
    v_fma_f32 v112, v112, v172, -v40
    v_fma_f32 v113, v113, v172, -v41
    v_fma_f32 v114, v114, v172, -v42
    v_fma_f32 v115, v115, v172, -v43
    v_mul_f32 v40, v160, v175
    v_mul_f32 v41, v161, v175
    v_mul_f32 v42, v162, v175
    v_mul_f32 v43, v163, v175
    v_fma_f32 v116, v116, v173, -v40
    v_fma_f32 v117, v117, v173, -v41
    v_fma_f32 v118, v118, v173, -v42
    v_fma_f32 v119, v119, v173, -v43
    v_cvt_pk_bf16_f32 v112, v112, v113
    v_cvt_pk_bf16_f32 v113, v114, v115
    v_cvt_pk_bf16_f32 v114, v116, v117
    v_cvt_pk_bf16_f32 v115, v118, v119
    s_nop 0
    v_permlane16_swap_b32 v112, v114
    v_permlane16_swap_b32 v113, v115
    buffer_store_dwordx4 v[112:115], v36, s[16:19], s44 offen sc1
    s_add_u32 s44, s44, 65536
    v_mul_f32 v40, v164, v174
    v_mul_f32 v41, v165, v174
    v_mul_f32 v42, v166, v174
    v_mul_f32 v43, v167, v174
    v_fma_f32 v120, v120, v172, -v40
    v_fma_f32 v121, v121, v172, -v41
    v_fma_f32 v122, v122, v172, -v42
    v_fma_f32 v123, v123, v172, -v43
    v_mul_f32 v40, v164, v175
    v_mul_f32 v41, v165, v175
    v_mul_f32 v42, v166, v175
    v_mul_f32 v43, v167, v175
    v_fma_f32 v124, v124, v173, -v40
    v_fma_f32 v125, v125, v173, -v41
    v_fma_f32 v126, v126, v173, -v42
    v_fma_f32 v127, v127, v173, -v43
    v_cvt_pk_bf16_f32 v120, v120, v121
    v_cvt_pk_bf16_f32 v121, v122, v123
    v_cvt_pk_bf16_f32 v122, v124, v125
    v_cvt_pk_bf16_f32 v123, v126, v127
    s_nop 0
    v_permlane16_swap_b32 v120, v122
    v_permlane16_swap_b32 v121, v123
    buffer_store_dwordx4 v[120:123], v36, s[16:19], s44 offen sc1
    s_add_u32 s44, s44, 65536
    v_mul_f32 v40, v168, v174
    v_mul_f32 v41, v169, v174
    v_mul_f32 v42, v170, v174
    v_mul_f32 v43, v171, v174
    v_fma_f32 v128, v128, v172, -v40
    v_fma_f32 v129, v129, v172, -v41
    v_fma_f32 v130, v130, v172, -v42
    v_fma_f32 v131, v131, v172, -v43
    v_mul_f32 v40, v168, v175
    v_mul_f32 v41, v169, v175
    v_mul_f32 v42, v170, v175
    v_mul_f32 v43, v171, v175
    v_fma_f32 v132, v132, v173, -v40
    v_fma_f32 v133, v133, v173, -v41
    v_fma_f32 v134, v134, v173, -v42
    v_fma_f32 v135, v135, v173, -v43
    v_cvt_pk_bf16_f32 v128, v128, v129
    v_cvt_pk_bf16_f32 v129, v130, v131
    v_cvt_pk_bf16_f32 v130, v132, v133
    v_cvt_pk_bf16_f32 v131, v134, v135
    buffer_store_dwordx2 v[128:129], v37, s[16:19], s45 offen sc1
    buffer_store_dwordx2 v[130:131], v37, s[16:19], s45 offen offset:128 sc1
    s_waitcnt vmcnt(0)
    s_barrier
    s_branch k2_entry
k1_vb:
    s_mov_b32 s26, 0
    v_add_u32 v12, s26, v8
    v_add_u32 v13, s26, v9
    v_add_u32 v14, s26, v10
    v_add_u32 v15, s26, v11
    s_barrier
    ds_read_b128 v[136:139], v12 offset:0
    ds_read_b64_tr_b16 v[144:145], v14 offset:0
    ds_read_b64_tr_b16 v[146:147], v14 offset:1152
    ds_read_b128 v[140:143], v12 offset:2048
    ds_read_b64_tr_b16 v[148:149], v14 offset:40
    ds_read_b64_tr_b16 v[150:151], v14 offset:1192
    ds_read_b64_tr_b16 v[152:153], v14 offset:72
    ds_read_b64_tr_b16 v[154:155], v14 offset:1224
    ds_read_b64_tr_b16 v[156:157], v14 offset:112
    ds_read_b64_tr_b16 v[158:159], v14 offset:1264
    ds_read_b64_tr_b16 v[160:161], v14 offset:144
    ds_read_b64_tr_b16 v[162:163], v14 offset:1296
    ds_read_b64_tr_b16 v[164:165], v14 offset:184
    ds_read_b64_tr_b16 v[166:167], v14 offset:1336
    ds_read_b64_tr_b16 v[168:169], v14 offset:216
    ds_read_b64_tr_b16 v[170:171], v14 offset:1368
    ds_read_b64_tr_b16 v[172:173], v14 offset:256
    ds_read_b64_tr_b16 v[174:175], v14 offset:1408
    ds_read_b64_tr_b16 v[176:177], v15 offset:0
    ds_read_b64_tr_b16 v[178:179], v15 offset:1152
    s_mov_b32 s27, 8
k1_cp_loopb:
    s_waitcnt lgkmcnt(15)
    v_mfma_f32_16x16x32_bf16 v[64:67], v[136:139], v[144:147], v[64:67]
    ds_read_b128 v[180:183], v13 offset:0
    ds_read_b64_tr_b16 v[188:189], v14 offset:9728
    v_mfma_f32_16x16x32_bf16 v[68:71], v[140:143], v[144:147], v[68:71]
    ds_read_b64_tr_b16 v[190:191], v14 offset:10880
    s_waitcnt lgkmcnt(15)
    v_mfma_f32_16x16x32_bf16 v[72:75], v[136:139], v[148:151], v[72:75]
    ds_read_b128 v[184:187], v13 offset:2048
    v_mfma_f32_16x16x32_bf16 v[76:79], v[140:143], v[148:151], v[76:79]
    ds_read_b64_tr_b16 v[192:193], v14 offset:9768
    v_mfma_f32_16x16x32_bf16 v[80:83], v[136:139], v[152:155], v[80:83]
    ds_read_b64_tr_b16 v[194:195], v14 offset:10920
    v_mfma_f32_16x16x32_bf16 v[84:87], v[140:143], v[152:155], v[84:87]
    ds_read_b64_tr_b16 v[196:197], v14 offset:9800
    s_waitcnt lgkmcnt(15)
    v_mfma_f32_16x16x32_bf16 v[88:91], v[136:139], v[156:159], v[88:91]
    ds_read_b64_tr_b16 v[198:199], v14 offset:10952
    v_mfma_f32_16x16x32_bf16 v[92:95], v[140:143], v[156:159], v[92:95]
    ds_read_b64_tr_b16 v[200:201], v14 offset:9840
    v_mfma_f32_16x16x32_bf16 v[96:99], v[136:139], v[160:163], v[96:99]
    ds_read_b64_tr_b16 v[202:203], v14 offset:10992
    v_mfma_f32_16x16x32_bf16 v[100:103], v[140:143], v[160:163], v[100:103]
    ds_read_b64_tr_b16 v[204:205], v14 offset:9872
    ds_read_b64_tr_b16 v[206:207], v14 offset:11024
    s_waitcnt lgkmcnt(15)
    v_mfma_f32_16x16x32_bf16 v[104:107], v[136:139], v[164:167], v[104:107]
    ds_read_b64_tr_b16 v[208:209], v14 offset:9912
    v_mfma_f32_16x16x32_bf16 v[108:111], v[140:143], v[164:167], v[108:111]
    ds_read_b64_tr_b16 v[210:211], v14 offset:11064
    v_mfma_f32_16x16x32_bf16 v[112:115], v[136:139], v[168:171], v[112:115]
    ds_read_b64_tr_b16 v[212:213], v14 offset:9944
    v_mfma_f32_16x16x32_bf16 v[116:119], v[140:143], v[168:171], v[116:119]
    ds_read_b64_tr_b16 v[214:215], v14 offset:11096
    s_waitcnt lgkmcnt(15)
    v_mfma_f32_16x16x32_bf16 v[120:123], v[136:139], v[172:175], v[120:123]
    ds_read_b64_tr_b16 v[216:217], v14 offset:9984
    v_mfma_f32_16x16x32_bf16 v[124:127], v[140:143], v[172:175], v[124:127]
    ds_read_b64_tr_b16 v[218:219], v14 offset:11136
    v_mfma_f32_16x16x32_bf16 v[128:131], v[136:139], v[176:179], v[128:131]
    ds_read_b64_tr_b16 v[220:221], v15 offset:9728
    v_mfma_f32_16x16x32_bf16 v[132:135], v[140:143], v[176:179], v[132:135]
    ds_read_b64_tr_b16 v[222:223], v15 offset:10880
    s_add_u32 s26, s26, 35840
    s_cmp_eq_u32 s26, 143360
    s_cselect_b32 s26, 0, s26
    s_barrier
    s_waitcnt lgkmcnt(15)
    v_mfma_f32_16x16x32_bf16 v[64:67], v[180:183], v[188:191], v[64:67]
    v_add_u32 v12, s26, v8
    v_add_u32 v13, s26, v9
    v_mfma_f32_16x16x32_bf16 v[68:71], v[184:187], v[188:191], v[68:71]
    v_add_u32 v14, s26, v10
    s_waitcnt lgkmcnt(14)
    v_mfma_f32_16x16x32_bf16 v[72:75], v[180:183], v[192:195], v[72:75]
    v_add_u32 v15, s26, v11
    v_mfma_f32_16x16x32_bf16 v[76:79], v[184:187], v[192:195], v[76:79]
    ds_read_b128 v[136:139], v12 offset:0
    ds_read_b64_tr_b16 v[144:145], v14 offset:0
    s_waitcnt lgkmcnt(14)
    v_mfma_f32_16x16x32_bf16 v[80:83], v[180:183], v[196:199], v[80:83]
    ds_read_b64_tr_b16 v[146:147], v14 offset:1152
    v_mfma_f32_16x16x32_bf16 v[84:87], v[184:187], v[196:199], v[84:87]
    ds_read_b128 v[140:143], v12 offset:2048
    s_waitcnt lgkmcnt(14)
    v_mfma_f32_16x16x32_bf16 v[88:91], v[180:183], v[200:203], v[88:91]
    ds_read_b64_tr_b16 v[148:149], v14 offset:40
    ds_read_b64_tr_b16 v[150:151], v14 offset:1192
    v_mfma_f32_16x16x32_bf16 v[92:95], v[184:187], v[200:203], v[92:95]
    ds_read_b64_tr_b16 v[152:153], v14 offset:72
    s_waitcnt lgkmcnt(15)
    v_mfma_f32_16x16x32_bf16 v[96:99], v[180:183], v[204:207], v[96:99]
    ds_read_b64_tr_b16 v[154:155], v14 offset:1224
    v_mfma_f32_16x16x32_bf16 v[100:103], v[184:187], v[204:207], v[100:103]
    ds_read_b64_tr_b16 v[156:157], v14 offset:112
    ds_read_b64_tr_b16 v[158:159], v14 offset:1264
    s_waitcnt lgkmcnt(15)
    v_mfma_f32_16x16x32_bf16 v[104:107], v[180:183], v[208:211], v[104:107]
    ds_read_b64_tr_b16 v[160:161], v14 offset:144
    v_mfma_f32_16x16x32_bf16 v[108:111], v[184:187], v[208:211], v[108:111]
    ds_read_b64_tr_b16 v[162:163], v14 offset:1296
    s_waitcnt lgkmcnt(15)
    v_mfma_f32_16x16x32_bf16 v[112:115], v[180:183], v[212:215], v[112:115]
    ds_read_b64_tr_b16 v[164:165], v14 offset:184
    ds_read_b64_tr_b16 v[166:167], v14 offset:1336
    v_mfma_f32_16x16x32_bf16 v[116:119], v[184:187], v[212:215], v[116:119]
    ds_read_b64_tr_b16 v[168:169], v14 offset:216
    s_waitcnt lgkmcnt(15)
    v_mfma_f32_16x16x32_bf16 v[120:123], v[180:183], v[216:219], v[120:123]
    ds_read_b64_tr_b16 v[170:171], v14 offset:1368
    v_mfma_f32_16x16x32_bf16 v[124:127], v[184:187], v[216:219], v[124:127]
    ds_read_b64_tr_b16 v[172:173], v14 offset:256
    ds_read_b64_tr_b16 v[174:175], v14 offset:1408
    v_mfma_f32_16x16x32_bf16 v[128:131], v[180:183], v[220:223], v[128:131]
    ds_read_b64_tr_b16 v[176:177], v15 offset:0
    v_mfma_f32_16x16x32_bf16 v[132:135], v[184:187], v[220:223], v[132:135]
    ds_read_b64_tr_b16 v[178:179], v15 offset:1152
    s_sub_u32 s27, s27, 1
    s_cmp_lg_u32 s27, 0
    s_cbranch_scc1 k1_cp_loopb
    s_waitcnt lgkmcnt(15)
    v_mfma_f32_16x16x32_bf16 v[64:67], v[136:139], v[144:147], v[64:67]
    ds_read_b128 v[180:183], v13 offset:0
    ds_read_b64_tr_b16 v[188:189], v14 offset:9728
    v_mfma_f32_16x16x32_bf16 v[68:71], v[140:143], v[144:147], v[68:71]
    ds_read_b64_tr_b16 v[190:191], v14 offset:10880
    s_waitcnt lgkmcnt(15)
    v_mfma_f32_16x16x32_bf16 v[72:75], v[136:139], v[148:151], v[72:75]
    ds_read_b128 v[184:187], v13 offset:2048
    v_mfma_f32_16x16x32_bf16 v[76:79], v[140:143], v[148:151], v[76:79]
    ds_read_b64_tr_b16 v[192:193], v14 offset:9768
    v_mfma_f32_16x16x32_bf16 v[80:83], v[136:139], v[152:155], v[80:83]
    ds_read_b64_tr_b16 v[194:195], v14 offset:10920
    v_mfma_f32_16x16x32_bf16 v[84:87], v[140:143], v[152:155], v[84:87]
    ds_read_b64_tr_b16 v[196:197], v14 offset:9800
    s_waitcnt lgkmcnt(15)
    v_mfma_f32_16x16x32_bf16 v[88:91], v[136:139], v[156:159], v[88:91]
    ds_read_b64_tr_b16 v[198:199], v14 offset:10952
    v_mfma_f32_16x16x32_bf16 v[92:95], v[140:143], v[156:159], v[92:95]
    ds_read_b64_tr_b16 v[200:201], v14 offset:9840
    v_mfma_f32_16x16x32_bf16 v[96:99], v[136:139], v[160:163], v[96:99]
    ds_read_b64_tr_b16 v[202:203], v14 offset:10992
    v_mfma_f32_16x16x32_bf16 v[100:103], v[140:143], v[160:163], v[100:103]
    ds_read_b64_tr_b16 v[204:205], v14 offset:9872
    ds_read_b64_tr_b16 v[206:207], v14 offset:11024
    s_waitcnt lgkmcnt(15)
    v_mfma_f32_16x16x32_bf16 v[104:107], v[136:139], v[164:167], v[104:107]
    ds_read_b64_tr_b16 v[208:209], v14 offset:9912
    v_mfma_f32_16x16x32_bf16 v[108:111], v[140:143], v[164:167], v[108:111]
    ds_read_b64_tr_b16 v[210:211], v14 offset:11064
    v_mfma_f32_16x16x32_bf16 v[112:115], v[136:139], v[168:171], v[112:115]
    ds_read_b64_tr_b16 v[212:213], v14 offset:9944
    v_mfma_f32_16x16x32_bf16 v[116:119], v[140:143], v[168:171], v[116:119]
    ds_read_b64_tr_b16 v[214:215], v14 offset:11096
    s_waitcnt lgkmcnt(15)
    v_mfma_f32_16x16x32_bf16 v[120:123], v[136:139], v[172:175], v[120:123]
    ds_read_b64_tr_b16 v[216:217], v14 offset:9984
    v_mfma_f32_16x16x32_bf16 v[124:127], v[140:143], v[172:175], v[124:127]
    ds_read_b64_tr_b16 v[218:219], v14 offset:11136
    v_mfma_f32_16x16x32_bf16 v[128:131], v[136:139], v[176:179], v[128:131]
    ds_read_b64_tr_b16 v[220:221], v15 offset:9728
    v_mfma_f32_16x16x32_bf16 v[132:135], v[140:143], v[176:179], v[132:135]
    ds_read_b64_tr_b16 v[222:223], v15 offset:10880
    s_waitcnt lgkmcnt(15)
    v_mfma_f32_16x16x32_bf16 v[64:67], v[180:183], v[188:191], v[64:67]
    v_mfma_f32_16x16x32_bf16 v[68:71], v[184:187], v[188:191], v[68:71]
    s_waitcnt lgkmcnt(14)
    v_mfma_f32_16x16x32_bf16 v[72:75], v[180:183], v[192:195], v[72:75]
    v_mfma_f32_16x16x32_bf16 v[76:79], v[184:187], v[192:195], v[76:79]
    s_waitcnt lgkmcnt(12)
    v_mfma_f32_16x16x32_bf16 v[80:83], v[180:183], v[196:199], v[80:83]
    v_mfma_f32_16x16x32_bf16 v[84:87], v[184:187], v[196:199], v[84:87]
    s_waitcnt lgkmcnt(10)
    v_mfma_f32_16x16x32_bf16 v[88:91], v[180:183], v[200:203], v[88:91]
    v_mfma_f32_16x16x32_bf16 v[92:95], v[184:187], v[200:203], v[92:95]
    s_waitcnt lgkmcnt(8)
    v_mfma_f32_16x16x32_bf16 v[96:99], v[180:183], v[204:207], v[96:99]
    v_mfma_f32_16x16x32_bf16 v[100:103], v[184:187], v[204:207], v[100:103]
    s_waitcnt lgkmcnt(6)
    v_mfma_f32_16x16x32_bf16 v[104:107], v[180:183], v[208:211], v[104:107]
    v_mfma_f32_16x16x32_bf16 v[108:111], v[184:187], v[208:211], v[108:111]
    s_waitcnt lgkmcnt(4)
    v_mfma_f32_16x16x32_bf16 v[112:115], v[180:183], v[212:215], v[112:115]
    v_mfma_f32_16x16x32_bf16 v[116:119], v[184:187], v[212:215], v[116:119]
    s_waitcnt lgkmcnt(2)
    v_mfma_f32_16x16x32_bf16 v[120:123], v[180:183], v[216:219], v[120:123]
    v_mfma_f32_16x16x32_bf16 v[124:127], v[184:187], v[216:219], v[124:127]
    s_waitcnt lgkmcnt(0)
    v_mfma_f32_16x16x32_bf16 v[128:131], v[180:183], v[220:223], v[128:131]
    v_mfma_f32_16x16x32_bf16 v[132:135], v[184:187], v[220:223], v[132:135]
    s_lshl_b32 s42, s29, 9
    s_lshl_b32 s43, s21, 2
    s_add_u32 s43, s43, s20
    s_add_u32 s42, s42, s43
    s_barrier
    s_lshl_b32 s46, s20, 7
    s_add_u32 s46, s46, 144000
    v_lshlrev_b32 v7, 4, v2
    v_add_u32 v7, s46, v7
    ds_read_b128 v[172:175], v7 offset:0
    ds_read_b128 v[180:183], v7 offset:512
    ds_read_b128 v[176:179], v7 offset:64
    ds_read_b128 v[184:187], v7 offset:576
    v_lshlrev_b32 v6, 2, v5
    v_add_u32 v6, 143360, v6
    ds_read_b32 v136, v6 offset:0
    ds_read_b32 v137, v6 offset:64
    ds_read_b32 v138, v6 offset:128
    ds_read_b32 v139, v6 offset:192
    ds_read_b32 v140, v6 offset:256
    ds_read_b32 v141, v6 offset:320
    ds_read_b32 v142, v6 offset:384
    ds_read_b32 v143, v6 offset:448
    ds_read_b32 v144, v6 offset:512
    s_lshl_b32 s44, s42, 10
    s_add_u32 s44, s44, 6553600
    s_lshl_b32 s45, s29, 6
    s_add_u32 s45, s45, s43
    s_lshl_b32 s45, s45, 10
    s_add_u32 s45, s45, 8650752
    v_lshlrev_b32 v36, 4, v0
    s_waitcnt lgkmcnt(0)
    v_mul_f32 v40, v136, v180
    v_mul_f32 v41, v136, v181
    v_mul_f32 v42, v136, v182
    v_mul_f32 v43, v136, v183
    v_fma_f32 v64, v64, v172, -v40
    v_fma_f32 v65, v65, v173, -v41
    v_fma_f32 v66, v66, v174, -v42
    v_fma_f32 v67, v67, v175, -v43
    v_mul_f32 v40, v136, v184
    v_mul_f32 v41, v136, v185
    v_mul_f32 v42, v136, v186
    v_mul_f32 v43, v136, v187
    v_fma_f32 v68, v68, v176, -v40
    v_fma_f32 v69, v69, v177, -v41
    v_fma_f32 v70, v70, v178, -v42
    v_fma_f32 v71, v71, v179, -v43
    v_cvt_pk_bf16_f32 v64, v64, v65
    v_cvt_pk_bf16_f32 v65, v66, v67
    v_cvt_pk_bf16_f32 v66, v68, v69
    v_cvt_pk_bf16_f32 v67, v70, v71
    s_nop 0
    v_permlane32_swap_b32 v64, v66
    v_permlane32_swap_b32 v65, v67
    buffer_store_dwordx4 v[64:67], v36, s[16:19], s44 offen sc1
    s_add_u32 s44, s44, 65536
    v_mul_f32 v40, v137, v180
    v_mul_f32 v41, v137, v181
    v_mul_f32 v42, v137, v182
    v_mul_f32 v43, v137, v183
    v_fma_f32 v72, v72, v172, -v40
    v_fma_f32 v73, v73, v173, -v41
    v_fma_f32 v74, v74, v174, -v42
    v_fma_f32 v75, v75, v175, -v43
    v_mul_f32 v40, v137, v184
    v_mul_f32 v41, v137, v185
    v_mul_f32 v42, v137, v186
    v_mul_f32 v43, v137, v187
    v_fma_f32 v76, v76, v176, -v40
    v_fma_f32 v77, v77, v177, -v41
    v_fma_f32 v78, v78, v178, -v42
    v_fma_f32 v79, v79, v179, -v43
    v_cvt_pk_bf16_f32 v72, v72, v73
    v_cvt_pk_bf16_f32 v73, v74, v75
    v_cvt_pk_bf16_f32 v74, v76, v77
    v_cvt_pk_bf16_f32 v75, v78, v79
    s_nop 0
    v_permlane32_swap_b32 v72, v74
    v_permlane32_swap_b32 v73, v75
    buffer_store_dwordx4 v[72:75], v36, s[16:19], s44 offen sc1
    s_add_u32 s44, s44, 65536
    v_mul_f32 v40, v138, v180
    v_mul_f32 v41, v138, v181
    v_mul_f32 v42, v138, v182
    v_mul_f32 v43, v138, v183
    v_fma_f32 v80, v80, v172, -v40
    v_fma_f32 v81, v81, v173, -v41
    v_fma_f32 v82, v82, v174, -v42
    v_fma_f32 v83, v83, v175, -v43
    v_mul_f32 v40, v138, v184
    v_mul_f32 v41, v138, v185
    v_mul_f32 v42, v138, v186
    v_mul_f32 v43, v138, v187
    v_fma_f32 v84, v84, v176, -v40
    v_fma_f32 v85, v85, v177, -v41
    v_fma_f32 v86, v86, v178, -v42
    v_fma_f32 v87, v87, v179, -v43
    v_cvt_pk_bf16_f32 v80, v80, v81
    v_cvt_pk_bf16_f32 v81, v82, v83
    v_cvt_pk_bf16_f32 v82, v84, v85
    v_cvt_pk_bf16_f32 v83, v86, v87
    s_nop 0
    v_permlane32_swap_b32 v80, v82
    v_permlane32_swap_b32 v81, v83
    buffer_store_dwordx4 v[80:83], v36, s[16:19], s44 offen sc1
    s_add_u32 s44, s44, 65536
    v_mul_f32 v40, v139, v180
    v_mul_f32 v41, v139, v181
    v_mul_f32 v42, v139, v182
    v_mul_f32 v43, v139, v183
    v_fma_f32 v88, v88, v172, -v40
    v_fma_f32 v89, v89, v173, -v41
    v_fma_f32 v90, v90, v174, -v42
    v_fma_f32 v91, v91, v175, -v43
    v_mul_f32 v40, v139, v184
    v_mul_f32 v41, v139, v185
    v_mul_f32 v42, v139, v186
    v_mul_f32 v43, v139, v187
    v_fma_f32 v92, v92, v176, -v40
    v_fma_f32 v93, v93, v177, -v41
    v_fma_f32 v94, v94, v178, -v42
    v_fma_f32 v95, v95, v179, -v43
    v_cvt_pk_bf16_f32 v88, v88, v89
    v_cvt_pk_bf16_f32 v89, v90, v91
    v_cvt_pk_bf16_f32 v90, v92, v93
    v_cvt_pk_bf16_f32 v91, v94, v95
    s_nop 0
    v_permlane32_swap_b32 v88, v90
    v_permlane32_swap_b32 v89, v91
    buffer_store_dwordx4 v[88:91], v36, s[16:19], s44 offen sc1
    s_add_u32 s44, s44, 65536
    v_mul_f32 v40, v140, v180
    v_mul_f32 v41, v140, v181
    v_mul_f32 v42, v140, v182
    v_mul_f32 v43, v140, v183
    v_fma_f32 v96, v96, v172, -v40
    v_fma_f32 v97, v97, v173, -v41
    v_fma_f32 v98, v98, v174, -v42
    v_fma_f32 v99, v99, v175, -v43
    v_mul_f32 v40, v140, v184
    v_mul_f32 v41, v140, v185
    v_mul_f32 v42, v140, v186
    v_mul_f32 v43, v140, v187
    v_fma_f32 v100, v100, v176, -v40
    v_fma_f32 v101, v101, v177, -v41
    v_fma_f32 v102, v102, v178, -v42
    v_fma_f32 v103, v103, v179, -v43
    v_cvt_pk_bf16_f32 v96, v96, v97
    v_cvt_pk_bf16_f32 v97, v98, v99
    v_cvt_pk_bf16_f32 v98, v100, v101
    v_cvt_pk_bf16_f32 v99, v102, v103
    s_nop 0
    v_permlane32_swap_b32 v96, v98
    v_permlane32_swap_b32 v97, v99
    buffer_store_dwordx4 v[96:99], v36, s[16:19], s44 offen sc1
    s_add_u32 s44, s44, 65536
    v_mul_f32 v40, v141, v180
    v_mul_f32 v41, v141, v181
    v_mul_f32 v42, v141, v182
    v_mul_f32 v43, v141, v183
    v_fma_f32 v104, v104, v172, -v40
    v_fma_f32 v105, v105, v173, -v41
    v_fma_f32 v106, v106, v174, -v42
    v_fma_f32 v107, v107, v175, -v43
    v_mul_f32 v40, v141, v184
    v_mul_f32 v41, v141, v185
    v_mul_f32 v42, v141, v186
    v_mul_f32 v43, v141, v187
    v_fma_f32 v108, v108, v176, -v40
    v_fma_f32 v109, v109, v177, -v41
    v_fma_f32 v110, v110, v178, -v42
    v_fma_f32 v111, v111, v179, -v43
    v_cvt_pk_bf16_f32 v104, v104, v105
    v_cvt_pk_bf16_f32 v105, v106, v107
    v_cvt_pk_bf16_f32 v106, v108, v109
    v_cvt_pk_bf16_f32 v107, v110, v111
    s_nop 0
    v_permlane32_swap_b32 v104, v106
    v_permlane32_swap_b32 v105, v107
    buffer_store_dwordx4 v[104:107], v36, s[16:19], s44 offen sc1
    s_add_u32 s44, s44, 65536
    v_mul_f32 v40, v142, v180
    v_mul_f32 v41, v142, v181
    v_mul_f32 v42, v142, v182
    v_mul_f32 v43, v142, v183
    v_fma_f32 v112, v112, v172, -v40
    v_fma_f32 v113, v113, v173, -v41
    v_fma_f32 v114, v114, v174, -v42
    v_fma_f32 v115, v115, v175, -v43
    v_mul_f32 v40, v142, v184
    v_mul_f32 v41, v142, v185
    v_mul_f32 v42, v142, v186
    v_mul_f32 v43, v142, v187
    v_fma_f32 v116, v116, v176, -v40
    v_fma_f32 v117, v117, v177, -v41
    v_fma_f32 v118, v118, v178, -v42
    v_fma_f32 v119, v119, v179, -v43
    v_cvt_pk_bf16_f32 v112, v112, v113
    v_cvt_pk_bf16_f32 v113, v114, v115
    v_cvt_pk_bf16_f32 v114, v116, v117
    v_cvt_pk_bf16_f32 v115, v118, v119
    s_nop 0
    v_permlane32_swap_b32 v112, v114
    v_permlane32_swap_b32 v113, v115
    buffer_store_dwordx4 v[112:115], v36, s[16:19], s44 offen sc1
    s_add_u32 s44, s44, 65536
    v_mul_f32 v40, v143, v180
    v_mul_f32 v41, v143, v181
    v_mul_f32 v42, v143, v182
    v_mul_f32 v43, v143, v183
    v_fma_f32 v120, v120, v172, -v40
    v_fma_f32 v121, v121, v173, -v41
    v_fma_f32 v122, v122, v174, -v42
    v_fma_f32 v123, v123, v175, -v43
    v_mul_f32 v40, v143, v184
    v_mul_f32 v41, v143, v185
    v_mul_f32 v42, v143, v186
    v_mul_f32 v43, v143, v187
    v_fma_f32 v124, v124, v176, -v40
    v_fma_f32 v125, v125, v177, -v41
    v_fma_f32 v126, v126, v178, -v42
    v_fma_f32 v127, v127, v179, -v43
    v_cvt_pk_bf16_f32 v120, v120, v121
    v_cvt_pk_bf16_f32 v121, v122, v123
    v_cvt_pk_bf16_f32 v122, v124, v125
    v_cvt_pk_bf16_f32 v123, v126, v127
    s_nop 0
    v_permlane32_swap_b32 v120, v122
    v_permlane32_swap_b32 v121, v123
    buffer_store_dwordx4 v[120:123], v36, s[16:19], s44 offen sc1
    s_add_u32 s44, s44, 65536
    v_mul_f32 v40, v144, v180
    v_mul_f32 v41, v144, v181
    v_mul_f32 v42, v144, v182
    v_mul_f32 v43, v144, v183
    v_fma_f32 v128, v128, v172, -v40
    v_fma_f32 v129, v129, v173, -v41
    v_fma_f32 v130, v130, v174, -v42
    v_fma_f32 v131, v131, v175, -v43
    v_mul_f32 v40, v144, v184
    v_mul_f32 v41, v144, v185
    v_mul_f32 v42, v144, v186
    v_mul_f32 v43, v144, v187
    v_fma_f32 v132, v132, v176, -v40
    v_fma_f32 v133, v133, v177, -v41
    v_fma_f32 v134, v134, v178, -v42
    v_fma_f32 v135, v135, v179, -v43
    v_cvt_pk_bf16_f32 v128, v128, v129
    v_cvt_pk_bf16_f32 v129, v130, v131
    v_cvt_pk_bf16_f32 v130, v132, v133
    v_cvt_pk_bf16_f32 v131, v134, v135
    s_nop 0
    v_permlane32_swap_b32 v128, v130
    v_permlane32_swap_b32 v129, v131
    buffer_store_dwordx4 v[128:131], v36, s[16:19], s45 offen sc1
    s_waitcnt vmcnt(0)
    s_barrier
    s_branch k2_entry
k1_loader:
    s_sub_u32 s20, s20, 4
    v_lshrrev_b32 v2, 3, v0
    v_and_b32 v3, 7, v0
    v_lshrrev_b32 v4, 4, v0
    v_mul_u32_u24 v5, 1152, v2
    v_add_u32 v6, 0, v4
    v_xor_b32 v6, v3, v6
    v_lshl_add_u32 v6, v6, 4, v5
    v_add_u32 v8, 0, v6
    v_add_u32 v6, 4, v4
    v_xor_b32 v6, v3, v6
    v_lshl_add_u32 v6, v6, 4, v5
    v_add_u32 v9, 8192, v6
    v_add_u32 v6, 0, v4
    v_xor_b32 v6, v3, v6
    v_lshl_add_u32 v6, v6, 4, v5
    v_add_u32 v10, 16384, v6
    v_add_u32 v6, 4, v4
    v_xor_b32 v6, v3, v6
    v_lshl_add_u32 v6, v6, 4, v5
    v_add_u32 v11, 24576, v6
    s_lshl_b32 s24, s21, 2
    s_add_u32 s24, s24, s20
    s_mul_i32 s24, s24, 36864
    s_lshl_b32 s31, s20, 12
    s_cmp_eq_u32 s20, 3
    s_cselect_b32 s42, 1, 0
    s_waitcnt lgkmcnt(0)
    s_mov_b32 s8, s32
    s_and_b32 s9, s33, 0xffff
    s_mov_b32 s10, 0x240000
    s_mov_b32 s11, 0x20000
    s_mov_b32 s12, s34
    s_and_b32 s13, s35, 0xffff
    s_mov_b32 s14, 0x1e6000
    s_mov_b32 s15, 0x20000
    s_add_u32 m0, s31, 0
    s_nop 0
    buffer_load_dwordx4 v8, s[8:11], s24 offen offset:0 lds
    buffer_load_dwordx4 v9, s[8:11], s24 offen offset:1024 lds
    buffer_load_dwordx4 v10, s[8:11], s24 offen offset:2048 lds
    buffer_load_dwordx4 v11, s[8:11], s24 offen offset:3072 lds
    s_add_u32 s24, s24, 128
    v_add_u32 v2, s23, v0
    v_add_u32 v2, 192, v2
    v_mul_u32_u24 v3, 6899, v2
    v_lshrrev_b32 v3, 20, v3
    v_mul_u32_u24 v4, 152, v3
    v_sub_u32 v4, v2, v4
    v_mul_u32_u24 v5, 3641, v4
    v_lshrrev_b32 v5, 16, v5
    v_mul_u32_u24 v6, 18, v5
    v_sub_u32 v6, v4, v6
    v_lshl_add_u32 v5, v3, 3, v5
    v_mul_u32_u24 v5, 3456, v5
    v_lshl_add_u32 v5, v6, 4, v5
    v_cmp_lt_u32 vcc, 143, v4
    v_mov_b32 v6, 0x40000000
    s_nop 0
    v_cndmask_b32 v15, v5, v6, vcc
    s_add_u32 m0, s41, 3072
    s_nop 0
    buffer_load_dwordx4 v15, s[12:15], s25 offen lds
    v_add_u32 v2, s23, v0
    v_add_u32 v2, 256, v2
    v_mul_u32_u24 v3, 6899, v2
    v_lshrrev_b32 v3, 20, v3
    v_mul_u32_u24 v4, 152, v3
    v_sub_u32 v4, v2, v4
    v_mul_u32_u24 v5, 3641, v4
    v_lshrrev_b32 v5, 16, v5
    v_mul_u32_u24 v6, 18, v5
    v_sub_u32 v6, v4, v6
    v_lshl_add_u32 v5, v3, 3, v5
    v_mul_u32_u24 v5, 3456, v5
    v_lshl_add_u32 v5, v6, 4, v5
    v_cmp_lt_u32 vcc, 143, v4
    v_mov_b32 v6, 0x40000000
    s_nop 0
    v_cndmask_b32 v16, v5, v6, vcc
    s_add_u32 s43, s41, 4096
    s_cmp_eq_u32 s42, 1
    s_cselect_b32 m0, 145024, s43
    s_nop 0
    buffer_load_dwordx4 v16, s[12:15], s25 offen lds
    v_add_u32 v2, s23, v0
    v_mul_u32_u24 v3, 6899, v2
    v_lshrrev_b32 v3, 20, v3
    v_mul_u32_u24 v4, 152, v3
    v_sub_u32 v4, v2, v4
    v_mul_u32_u24 v5, 3641, v4
    v_lshrrev_b32 v5, 16, v5
    v_mul_u32_u24 v6, 18, v5
    v_sub_u32 v6, v4, v6
    v_lshl_add_u32 v5, v3, 3, v5
    v_mul_u32_u24 v5, 3456, v5
    v_lshl_add_u32 v5, v6, 4, v5
    v_cmp_lt_u32 vcc, 143, v4
    v_mov_b32 v6, 0x40000000
    s_nop 0
    v_cndmask_b32 v12, v5, v6, vcc
    v_add_u32 v2, s23, v0
    v_add_u32 v2, 64, v2
    v_mul_u32_u24 v3, 6899, v2
    v_lshrrev_b32 v3, 20, v3
    v_mul_u32_u24 v4, 152, v3
    v_sub_u32 v4, v2, v4
    v_mul_u32_u24 v5, 3641, v4
    v_lshrrev_b32 v5, 16, v5
    v_mul_u32_u24 v6, 18, v5
    v_sub_u32 v6, v4, v6
    v_lshl_add_u32 v5, v3, 3, v5
    v_mul_u32_u24 v5, 3456, v5
    v_lshl_add_u32 v5, v6, 4, v5
    v_cmp_lt_u32 vcc, 143, v4
    v_mov_b32 v6, 0x40000000
    s_nop 0
    v_cndmask_b32 v13, v5, v6, vcc
    v_add_u32 v2, s23, v0
    v_add_u32 v2, 128, v2
    v_mul_u32_u24 v3, 6899, v2
    v_lshrrev_b32 v3, 20, v3
    v_mul_u32_u24 v4, 152, v3
    v_sub_u32 v4, v2, v4
    v_mul_u32_u24 v5, 3641, v4
    v_lshrrev_b32 v5, 16, v5
    v_mul_u32_u24 v6, 18, v5
    v_sub_u32 v6, v4, v6
    v_lshl_add_u32 v5, v3, 3, v5
    v_mul_u32_u24 v5, 3456, v5
    v_lshl_add_u32 v5, v6, 4, v5
    v_cmp_lt_u32 vcc, 143, v4
    v_mov_b32 v6, 0x40000000
    s_nop 0
    v_cndmask_b32 v14, v5, v6, vcc
    s_add_u32 s25, s25, 221184
    s_add_u32 m0, s31, 35840
    s_nop 0
    buffer_load_dwordx4 v8, s[8:11], s24 offen offset:0 lds
    buffer_load_dwordx4 v9, s[8:11], s24 offen offset:1024 lds
    buffer_load_dwordx4 v10, s[8:11], s24 offen offset:2048 lds
    buffer_load_dwordx4 v11, s[8:11], s24 offen offset:3072 lds
    s_add_u32 s24, s24, 128
    s_add_u32 m0, s41, 35840
    s_nop 0
    buffer_load_dwordx4 v12, s[12:15], s25 offen lds
    s_add_u32 m0, s41, 36864
    s_nop 0
    buffer_load_dwordx4 v13, s[12:15], s25 offen lds
    s_add_u32 m0, s41, 37888
    s_nop 0
    buffer_load_dwordx4 v14, s[12:15], s25 offen lds
    s_add_u32 m0, s41, 38912
    s_nop 0
    buffer_load_dwordx4 v15, s[12:15], s25 offen lds
    s_add_u32 s43, s41, 39936
    s_cmp_eq_u32 s42, 1
    s_cselect_b32 m0, 145024, s43
    s_nop 0
    buffer_load_dwordx4 v16, s[12:15], s25 offen lds
    s_add_u32 s25, s25, 221184
    s_waitcnt vmcnt(9)
    s_barrier
    s_add_u32 m0, s31, 71680
    s_nop 0
    buffer_load_dwordx4 v8, s[8:11], s24 offen offset:0 lds
    buffer_load_dwordx4 v9, s[8:11], s24 offen offset:1024 lds
    buffer_load_dwordx4 v10, s[8:11], s24 offen offset:2048 lds
    buffer_load_dwordx4 v11, s[8:11], s24 offen offset:3072 lds
    s_add_u32 s24, s24, 128
    s_add_u32 m0, s41, 71680
    s_nop 0
    buffer_load_dwordx4 v12, s[12:15], s25 offen lds
    s_add_u32 m0, s41, 72704
    s_nop 0
    buffer_load_dwordx4 v13, s[12:15], s25 offen lds
    s_add_u32 m0, s41, 73728
    s_nop 0
    buffer_load_dwordx4 v14, s[12:15], s25 offen lds
    s_add_u32 m0, s41, 74752
    s_nop 0
    buffer_load_dwordx4 v15, s[12:15], s25 offen lds
    s_add_u32 s43, s41, 75776
    s_cmp_eq_u32 s42, 1
    s_cselect_b32 m0, 145024, s43
    s_nop 0
    buffer_load_dwordx4 v16, s[12:15], s25 offen lds
    s_add_u32 s25, s25, 221184
    s_waitcnt vmcnt(9)
    s_barrier
    s_add_u32 m0, s31, 107520
    s_nop 0
    buffer_load_dwordx4 v8, s[8:11], s24 offen offset:0 lds
    buffer_load_dwordx4 v9, s[8:11], s24 offen offset:1024 lds
    buffer_load_dwordx4 v10, s[8:11], s24 offen offset:2048 lds
    buffer_load_dwordx4 v11, s[8:11], s24 offen offset:3072 lds
    s_add_u32 s24, s24, 128
    s_add_u32 m0, s41, 107520
    s_nop 0
    buffer_load_dwordx4 v12, s[12:15], s25 offen lds
    s_add_u32 m0, s41, 108544
    s_nop 0
    buffer_load_dwordx4 v13, s[12:15], s25 offen lds
    s_add_u32 m0, s41, 109568
    s_nop 0
    buffer_load_dwordx4 v14, s[12:15], s25 offen lds
    s_add_u32 m0, s41, 110592
    s_nop 0
    buffer_load_dwordx4 v15, s[12:15], s25 offen lds
    s_add_u32 s43, s41, 111616
    s_cmp_eq_u32 s42, 1
    s_cselect_b32 m0, 145024, s43
    s_nop 0
    buffer_load_dwordx4 v16, s[12:15], s25 offen lds
    s_add_u32 s25, s25, 221184
    s_waitcnt vmcnt(9)
    s_barrier
    s_add_u32 m0, s31, 0
    s_nop 0
    buffer_load_dwordx4 v8, s[8:11], s24 offen offset:0 lds
    buffer_load_dwordx4 v9, s[8:11], s24 offen offset:1024 lds
    buffer_load_dwordx4 v10, s[8:11], s24 offen offset:2048 lds
    buffer_load_dwordx4 v11, s[8:11], s24 offen offset:3072 lds
    s_add_u32 s24, s24, 128
    s_add_u32 m0, s41, 0
    s_nop 0
    buffer_load_dwordx4 v12, s[12:15], s25 offen lds
    s_add_u32 m0, s41, 1024
    s_nop 0
    buffer_load_dwordx4 v13, s[12:15], s25 offen lds
    s_add_u32 m0, s41, 2048
    s_nop 0
    buffer_load_dwordx4 v14, s[12:15], s25 offen lds
    s_add_u32 m0, s41, 3072
    s_nop 0
    buffer_load_dwordx4 v15, s[12:15], s25 offen lds
    s_add_u32 s43, s41, 4096
    s_cmp_eq_u32 s42, 1
    s_cselect_b32 m0, 145024, s43
    s_nop 0
    buffer_load_dwordx4 v16, s[12:15], s25 offen lds
    s_add_u32 s25, s25, 221184
    s_waitcnt vmcnt(9)
    s_barrier
    s_add_u32 m0, s31, 35840
    s_nop 0
    buffer_load_dwordx4 v8, s[8:11], s24 offen offset:0 lds
    buffer_load_dwordx4 v9, s[8:11], s24 offen offset:1024 lds
    buffer_load_dwordx4 v10, s[8:11], s24 offen offset:2048 lds
    buffer_load_dwordx4 v11, s[8:11], s24 offen offset:3072 lds
    s_add_u32 s24, s24, 128
    s_add_u32 m0, s41, 35840
    s_nop 0
    buffer_load_dwordx4 v12, s[12:15], s25 offen lds
    s_add_u32 m0, s41, 36864
    s_nop 0
    buffer_load_dwordx4 v13, s[12:15], s25 offen lds
    s_add_u32 m0, s41, 37888
    s_nop 0
    buffer_load_dwordx4 v14, s[12:15], s25 offen lds
    s_add_u32 m0, s41, 38912
    s_nop 0
    buffer_load_dwordx4 v15, s[12:15], s25 offen lds
    s_add_u32 s43, s41, 39936
    s_cmp_eq_u32 s42, 1
    s_cselect_b32 m0, 145024, s43
    s_nop 0
    buffer_load_dwordx4 v16, s[12:15], s25 offen lds
    s_add_u32 s25, s25, 221184
    s_waitcnt vmcnt(9)
    s_barrier
    s_add_u32 m0, s31, 71680
    s_nop 0
    buffer_load_dwordx4 v8, s[8:11], s24 offen offset:0 lds
    buffer_load_dwordx4 v9, s[8:11], s24 offen offset:1024 lds
    buffer_load_dwordx4 v10, s[8:11], s24 offen offset:2048 lds
    buffer_load_dwordx4 v11, s[8:11], s24 offen offset:3072 lds
    s_add_u32 s24, s24, 128
    s_add_u32 m0, s41, 71680
    s_nop 0
    buffer_load_dwordx4 v12, s[12:15], s25 offen lds
    s_add_u32 m0, s41, 72704
    s_nop 0
    buffer_load_dwordx4 v13, s[12:15], s25 offen lds
    s_add_u32 m0, s41, 73728
    s_nop 0
    buffer_load_dwordx4 v14, s[12:15], s25 offen lds
    s_add_u32 m0, s41, 74752
    s_nop 0
    buffer_load_dwordx4 v15, s[12:15], s25 offen lds
    s_add_u32 s43, s41, 75776
    s_cmp_eq_u32 s42, 1
    s_cselect_b32 m0, 145024, s43
    s_nop 0
    buffer_load_dwordx4 v16, s[12:15], s25 offen lds
    s_add_u32 s25, s25, 221184
    s_waitcnt vmcnt(9)
    s_barrier
    s_add_u32 m0, s31, 107520
    s_nop 0
    buffer_load_dwordx4 v8, s[8:11], s24 offen offset:0 lds
    buffer_load_dwordx4 v9, s[8:11], s24 offen offset:1024 lds
    buffer_load_dwordx4 v10, s[8:11], s24 offen offset:2048 lds
    buffer_load_dwordx4 v11, s[8:11], s24 offen offset:3072 lds
    s_add_u32 s24, s24, 128
    s_add_u32 m0, s41, 107520
    s_nop 0
    buffer_load_dwordx4 v12, s[12:15], s25 offen lds
    s_add_u32 m0, s41, 108544
    s_nop 0
    buffer_load_dwordx4 v13, s[12:15], s25 offen lds
    s_add_u32 m0, s41, 109568
    s_nop 0
    buffer_load_dwordx4 v14, s[12:15], s25 offen lds
    s_add_u32 m0, s41, 110592
    s_nop 0
    buffer_load_dwordx4 v15, s[12:15], s25 offen lds
    s_add_u32 s43, s41, 111616
    s_cmp_eq_u32 s42, 1
    s_cselect_b32 m0, 145024, s43
    s_nop 0
    buffer_load_dwordx4 v16, s[12:15], s25 offen lds
    s_add_u32 s25, s25, 221184
    s_waitcnt vmcnt(9)
    s_barrier
    s_add_u32 m0, s31, 0
    s_nop 0
    buffer_load_dwordx4 v8, s[8:11], s24 offen offset:0 lds
    buffer_load_dwordx4 v9, s[8:11], s24 offen offset:1024 lds
    buffer_load_dwordx4 v10, s[8:11], s24 offen offset:2048 lds
    buffer_load_dwordx4 v11, s[8:11], s24 offen offset:3072 lds
    s_add_u32 s24, s24, 128
    s_add_u32 m0, s41, 0
    s_nop 0
    buffer_load_dwordx4 v12, s[12:15], s25 offen lds
    s_add_u32 m0, s41, 1024
    s_nop 0
    buffer_load_dwordx4 v13, s[12:15], s25 offen lds
    s_add_u32 m0, s41, 2048
    s_nop 0
    buffer_load_dwordx4 v14, s[12:15], s25 offen lds
    s_add_u32 m0, s41, 3072
    s_nop 0
    buffer_load_dwordx4 v15, s[12:15], s25 offen lds
    s_add_u32 s43, s41, 4096
    s_cmp_eq_u32 s42, 1
    s_cselect_b32 m0, 145024, s43
    s_nop 0
    buffer_load_dwordx4 v16, s[12:15], s25 offen lds
    s_add_u32 s25, s25, 221184
    s_mov_b32 s16, s38
    s_and_b32 s17, s39, 0xffff
    s_mov_b32 s18, 0x1c06000
    s_mov_b32 s19, 0x20000
    v_mov_b32 v2, 0
    global_load_dword v3, v2, s[36:37] sc1
    s_waitcnt vmcnt(10)
    s_barrier
    s_cmp_lg_u32 s20, 0
    s_cbranch_scc1 k1_wskip
    s_mov_b32 s44, 0x20000
k1_poll:
    s_waitcnt vmcnt(0)
    v_readfirstlane_b32 s45, v3
    s_nop 0
    s_cmp_ge_u32 s45, 64
    s_cbranch_scc1 k1_polled
    global_load_dword v3, v2, s[36:37] sc1
    s_sub_u32 s44, s44, 1
    s_cmp_lg_u32 s44, 0
    s_cbranch_scc1 k1_poll
k1_polled:
    v_lshlrev_b32 v2, 4, v0
    s_lshl_b32 s44, s21, 10
    s_add_u32 s44, s44, 29163520
    buffer_load_dwordx4 v[4:7], v2, s[16:19], s44 offen sc1
    s_mul_i32 s45, s22, 576
    s_add_u32 s45, s45, 29179904
    buffer_load_dwordx4 v[8:11], v2, s[16:19], s45 offen sc1
    v_mul_u32_u24 v12, 57, v0
    v_lshrrev_b32 v12, 9, v12
    v_mul_u32_u24 v13, 9, v12
    v_sub_u32 v13, v0, v13
    v_lshlrev_b32 v14, 7, v12
    v_lshl_add_u32 v14, v13, 4, v14
    v_cmp_lt_u32 vcc, 4, v13
    v_subrev_u32 v15, 16, v14
    s_nop 0
    v_cndmask_b32 v14, v14, v15, vcc
    v_cmp_eq_u32 vcc, 4, v13
    v_lshlrev_b32 v15, 4, v12
    v_add_u32 v15, 512, v15
    v_cndmask_b32 v14, v14, v15, vcc
    v_add_u32 v14, 143360, v14
    v_lshlrev_b32 v12, 3, v0
    v_add_u32 v12, 144000, v12
    s_cmp_eq_u32 s28, 0
    s_cselect_b32 s41, 0x3eae1a93, 1.0
    s_barrier
    s_branch k1_wdone
k1_wskip:
    s_waitcnt vmcnt(0)
    s_barrier
    s_barrier
    s_barrier
    s_branch k2_entry
k1_wdone:
    s_waitcnt vmcnt(0)
    v_mul_f32 v4, s41, v4
    v_mul_f32 v5, s41, v5
    v_mul_f32 v6, s41, v6
    v_mul_f32 v7, s41, v7
    ds_write2_b32 v12, v4, v6 offset0:0 offset1:1
    ds_write2_b32 v12, v5, v7 offset0:128 offset1:129
    s_mov_b32 exec_hi, 15
    ds_write_b128 v14, v[8:11]
    s_waitcnt lgkmcnt(0)
    s_mov_b64 exec, -1
    s_barrier
    s_mul_i32 s44, s21, 12
    s_add_u32 s44, s44, s22
    s_lshl_b32 s44, s44, 7
    s_add_u32 s44, s44, 29351936
    v_mov_b32 v2, 0
    v_mov_b32 v3, 1
    s_barrier
    s_mov_b64 exec, 1
    buffer_store_dword v3, v2, s[16:19], s44 offen sc1
    s_mov_b64 exec, -1
    s_branch k2_entry
k1_pf:
    s_cmp_ge_u32 s2, 256
    s_cbranch_scc1 k1_end
    s_load_dwordx4 s[40:43], s[0:1], 0
    s_load_dwordx4 s[44:47], s[0:1], 72
    v_lshrrev_b32 v1, 6, v0
    v_and_b32 v0, 63, v0
    v_readfirstlane_b32 s20, v1
    s_sub_u32 s21, s2, 192
    s_mov_b32 s3, s20
    s_cmp_lg_u32 s20, 3
    s_cbranch_scc1 k1_h_nt
    s_getpc_b64 s[50:51]
k1_pc1:
    s_sub_u32 s50, s50, k1_pc1-sequential_preLN__sliding_block__mixer_token_mlp__prompt_kernel
    s_subb_u32 s51, s51, 0
    v_lshlrev_b32 v100, 7, v0
    v_min_u32 v100, k5_end-sequential_preLN__sliding_block__mixer_token_mlp__prompt_kernel-4, v100
    global_load_dword v101, v100, s[50:51]
    v_add_u32 v100, 8192, v100
    v_min_u32 v100, k5_end-sequential_preLN__sliding_block__mixer_token_mlp__prompt_kernel-4, v100
    global_load_dword v101, v100, s[50:51]
    v_add_u32 v100, 8192, v100
    v_min_u32 v100, k5_end-sequential_preLN__sliding_block__mixer_token_mlp__prompt_kernel-4, v100
    global_load_dword v101, v100, s[50:51]
    v_add_u32 v100, 8192, v100
    v_min_u32 v100, k5_end-sequential_preLN__sliding_block__mixer_token_mlp__prompt_kernel-4, v100
    global_load_dword v101, v100, s[50:51]
    v_add_u32 v100, 8192, v100
    v_min_u32 v100, k5_end-sequential_preLN__sliding_block__mixer_token_mlp__prompt_kernel-4, v100
    global_load_dword v101, v100, s[50:51]
    v_add_u32 v100, 8192, v100
    v_min_u32 v100, k5_end-sequential_preLN__sliding_block__mixer_token_mlp__prompt_kernel-4, v100
    global_load_dword v101, v100, s[50:51]
k1_h_nt:
    v_lshrrev_b32 v2, 3, v0
    v_and_b32 v3, 7, v0
    v_lshlrev_b32 v3, 4, v3
    s_waitcnt lgkmcnt(0)
    s_mov_b32 s16, s46
    s_and_b32 s17, s47, 0xffff
    s_mov_b32 s18, 0x1c06000
    s_mov_b32 s19, 0x20000
    s_cmp_ge_u32 s20, 4
    s_cbranch_scc1 k1_h_cs
    s_mov_b32 s8, s40
    s_and_b32 s9, s41, 0xffff
    s_mov_b32 s10, 0x240000
    s_mov_b32 s11, 0x20000
    v_mul_u32_u24 v4, 1152, v2
    v_add_u32 v4, v4, v3
    s_lshl_b32 s22, s21, 2
    s_add_u32 s22, s22, s20
    s_mul_i32 s23, s22, 9216
    buffer_load_dwordx4 v[16:19], v4, s[8:11], s23 offen offset:0
    buffer_load_dwordx4 v[20:23], v4, s[8:11], s23 offen offset:128
    buffer_load_dwordx4 v[24:27], v4, s[8:11], s23 offen offset:256
    buffer_load_dwordx4 v[28:31], v4, s[8:11], s23 offen offset:384
    buffer_load_dwordx4 v[32:35], v4, s[8:11], s23 offen offset:512
    buffer_load_dwordx4 v[36:39], v4, s[8:11], s23 offen offset:640
    buffer_load_dwordx4 v[40:43], v4, s[8:11], s23 offen offset:768
    buffer_load_dwordx4 v[44:47], v4, s[8:11], s23 offen offset:896
    buffer_load_dwordx4 v[48:51], v4, s[8:11], s23 offen offset:1024
    s_cmp_lg_u32 s20, 0
    s_cbranch_scc1 k1_h_nopoison
    v_mov_b32 v8, -1
    v_mov_b32 v9, -1
    v_mov_b32 v10, -1
    v_mov_b32 v11, -1
    v_lshlrev_b32 v5, 4, v0
    s_lshl_b32 s24, s21, 10
    s_add_u32 s24, s24, 29188096
    buffer_store_dwordx4 v[8:11], v5, s[16:19], s24 offen sc1
k1_h_nopoison:
    s_cmp_lg_u32 s20, 1
    s_cbranch_scc1 k1_h_noflag
    v_mov_b32 v8, 0
    v_mov_b32 v9, 0
    v_lshlrev_b32 v5, 3, v0
    s_lshl_b32 s24, s21, 9
    s_add_u32 s24, s24, 29253632
    buffer_store_dwordx2 v[8:9], v5, s[16:19], s24 offen sc1
    s_add_u32 s24, s24, 32768
    buffer_store_dwordx2 v[8:9], v5, s[16:19], s24 offen sc1
    s_add_u32 s24, s24, 32768
    buffer_store_dwordx2 v[8:9], v5, s[16:19], s24 offen sc1
    s_add_u32 s24, s24, 32768
    buffer_store_dwordx2 v[8:9], v5, s[16:19], s24 offen sc1
    s_add_u32 s24, s24, 32768
k1_h_noflag:
    v_mov_b32 v12, 0
    v_mov_b32 v13, 0
    v_mov_b32 v14, 0
    v_mov_b32 v15, 0
    s_waitcnt vmcnt(0)
    v_lshlrev_b32 v6, 16, v16
    v_and_b32 v7, 0xffff0000, v16
    v_pk_add_f32 v[12:13], v[12:13], v[6:7]
    v_pk_fma_f32 v[14:15], v[6:7], v[6:7], v[14:15]
    v_lshlrev_b32 v6, 16, v17
    v_and_b32 v7, 0xffff0000, v17
    v_pk_add_f32 v[12:13], v[12:13], v[6:7]
    v_pk_fma_f32 v[14:15], v[6:7], v[6:7], v[14:15]
    v_lshlrev_b32 v6, 16, v18
    v_and_b32 v7, 0xffff0000, v18
    v_pk_add_f32 v[12:13], v[12:13], v[6:7]
    v_pk_fma_f32 v[14:15], v[6:7], v[6:7], v[14:15]
    v_lshlrev_b32 v6, 16, v19
    v_and_b32 v7, 0xffff0000, v19
    v_pk_add_f32 v[12:13], v[12:13], v[6:7]
    v_pk_fma_f32 v[14:15], v[6:7], v[6:7], v[14:15]
    v_lshlrev_b32 v6, 16, v20
    v_and_b32 v7, 0xffff0000, v20
    v_pk_add_f32 v[12:13], v[12:13], v[6:7]
    v_pk_fma_f32 v[14:15], v[6:7], v[6:7], v[14:15]
    v_lshlrev_b32 v6, 16, v21
    v_and_b32 v7, 0xffff0000, v21
    v_pk_add_f32 v[12:13], v[12:13], v[6:7]
    v_pk_fma_f32 v[14:15], v[6:7], v[6:7], v[14:15]
    v_lshlrev_b32 v6, 16, v22
    v_and_b32 v7, 0xffff0000, v22
    v_pk_add_f32 v[12:13], v[12:13], v[6:7]
    v_pk_fma_f32 v[14:15], v[6:7], v[6:7], v[14:15]
    v_lshlrev_b32 v6, 16, v23
    v_and_b32 v7, 0xffff0000, v23
    v_pk_add_f32 v[12:13], v[12:13], v[6:7]
    v_pk_fma_f32 v[14:15], v[6:7], v[6:7], v[14:15]
    v_lshlrev_b32 v6, 16, v24
    v_and_b32 v7, 0xffff0000, v24
    v_pk_add_f32 v[12:13], v[12:13], v[6:7]
    v_pk_fma_f32 v[14:15], v[6:7], v[6:7], v[14:15]
    v_lshlrev_b32 v6, 16, v25
    v_and_b32 v7, 0xffff0000, v25
    v_pk_add_f32 v[12:13], v[12:13], v[6:7]
    v_pk_fma_f32 v[14:15], v[6:7], v[6:7], v[14:15]
    v_lshlrev_b32 v6, 16, v26
    v_and_b32 v7, 0xffff0000, v26
    v_pk_add_f32 v[12:13], v[12:13], v[6:7]
    v_pk_fma_f32 v[14:15], v[6:7], v[6:7], v[14:15]
    v_lshlrev_b32 v6, 16, v27
    v_and_b32 v7, 0xffff0000, v27
    v_pk_add_f32 v[12:13], v[12:13], v[6:7]
    v_pk_fma_f32 v[14:15], v[6:7], v[6:7], v[14:15]
    v_lshlrev_b32 v6, 16, v28
    v_and_b32 v7, 0xffff0000, v28
    v_pk_add_f32 v[12:13], v[12:13], v[6:7]
    v_pk_fma_f32 v[14:15], v[6:7], v[6:7], v[14:15]
    v_lshlrev_b32 v6, 16, v29
    v_and_b32 v7, 0xffff0000, v29
    v_pk_add_f32 v[12:13], v[12:13], v[6:7]
    v_pk_fma_f32 v[14:15], v[6:7], v[6:7], v[14:15]
    v_lshlrev_b32 v6, 16, v30
    v_and_b32 v7, 0xffff0000, v30
    v_pk_add_f32 v[12:13], v[12:13], v[6:7]
    v_pk_fma_f32 v[14:15], v[6:7], v[6:7], v[14:15]
    v_lshlrev_b32 v6, 16, v31
    v_and_b32 v7, 0xffff0000, v31
    v_pk_add_f32 v[12:13], v[12:13], v[6:7]
    v_pk_fma_f32 v[14:15], v[6:7], v[6:7], v[14:15]
    v_lshlrev_b32 v6, 16, v32
    v_and_b32 v7, 0xffff0000, v32
    v_pk_add_f32 v[12:13], v[12:13], v[6:7]
    v_pk_fma_f32 v[14:15], v[6:7], v[6:7], v[14:15]
    v_lshlrev_b32 v6, 16, v33
    v_and_b32 v7, 0xffff0000, v33
    v_pk_add_f32 v[12:13], v[12:13], v[6:7]
    v_pk_fma_f32 v[14:15], v[6:7], v[6:7], v[14:15]
    v_lshlrev_b32 v6, 16, v34
    v_and_b32 v7, 0xffff0000, v34
    v_pk_add_f32 v[12:13], v[12:13], v[6:7]
    v_pk_fma_f32 v[14:15], v[6:7], v[6:7], v[14:15]
    v_lshlrev_b32 v6, 16, v35
    v_and_b32 v7, 0xffff0000, v35
    v_pk_add_f32 v[12:13], v[12:13], v[6:7]
    v_pk_fma_f32 v[14:15], v[6:7], v[6:7], v[14:15]
    v_lshlrev_b32 v6, 16, v36
    v_and_b32 v7, 0xffff0000, v36
    v_pk_add_f32 v[12:13], v[12:13], v[6:7]
    v_pk_fma_f32 v[14:15], v[6:7], v[6:7], v[14:15]
    v_lshlrev_b32 v6, 16, v37
    v_and_b32 v7, 0xffff0000, v37
    v_pk_add_f32 v[12:13], v[12:13], v[6:7]
    v_pk_fma_f32 v[14:15], v[6:7], v[6:7], v[14:15]
    v_lshlrev_b32 v6, 16, v38
    v_and_b32 v7, 0xffff0000, v38
    v_pk_add_f32 v[12:13], v[12:13], v[6:7]
    v_pk_fma_f32 v[14:15], v[6:7], v[6:7], v[14:15]
    v_lshlrev_b32 v6, 16, v39
    v_and_b32 v7, 0xffff0000, v39
    v_pk_add_f32 v[12:13], v[12:13], v[6:7]
    v_pk_fma_f32 v[14:15], v[6:7], v[6:7], v[14:15]
    v_lshlrev_b32 v6, 16, v40
    v_and_b32 v7, 0xffff0000, v40
    v_pk_add_f32 v[12:13], v[12:13], v[6:7]
    v_pk_fma_f32 v[14:15], v[6:7], v[6:7], v[14:15]
    v_lshlrev_b32 v6, 16, v41
    v_and_b32 v7, 0xffff0000, v41
    v_pk_add_f32 v[12:13], v[12:13], v[6:7]
    v_pk_fma_f32 v[14:15], v[6:7], v[6:7], v[14:15]
    v_lshlrev_b32 v6, 16, v42
    v_and_b32 v7, 0xffff0000, v42
    v_pk_add_f32 v[12:13], v[12:13], v[6:7]
    v_pk_fma_f32 v[14:15], v[6:7], v[6:7], v[14:15]
    v_lshlrev_b32 v6, 16, v43
    v_and_b32 v7, 0xffff0000, v43
    v_pk_add_f32 v[12:13], v[12:13], v[6:7]
    v_pk_fma_f32 v[14:15], v[6:7], v[6:7], v[14:15]
    v_lshlrev_b32 v6, 16, v44
    v_and_b32 v7, 0xffff0000, v44
    v_pk_add_f32 v[12:13], v[12:13], v[6:7]
    v_pk_fma_f32 v[14:15], v[6:7], v[6:7], v[14:15]
    v_lshlrev_b32 v6, 16, v45
    v_and_b32 v7, 0xffff0000, v45
    v_pk_add_f32 v[12:13], v[12:13], v[6:7]
    v_pk_fma_f32 v[14:15], v[6:7], v[6:7], v[14:15]
    v_lshlrev_b32 v6, 16, v46
    v_and_b32 v7, 0xffff0000, v46
    v_pk_add_f32 v[12:13], v[12:13], v[6:7]
    v_pk_fma_f32 v[14:15], v[6:7], v[6:7], v[14:15]
    v_lshlrev_b32 v6, 16, v47
    v_and_b32 v7, 0xffff0000, v47
    v_pk_add_f32 v[12:13], v[12:13], v[6:7]
    v_pk_fma_f32 v[14:15], v[6:7], v[6:7], v[14:15]
    v_lshlrev_b32 v6, 16, v48
    v_and_b32 v7, 0xffff0000, v48
    v_pk_add_f32 v[12:13], v[12:13], v[6:7]
    v_pk_fma_f32 v[14:15], v[6:7], v[6:7], v[14:15]
    v_lshlrev_b32 v6, 16, v49
    v_and_b32 v7, 0xffff0000, v49
    v_pk_add_f32 v[12:13], v[12:13], v[6:7]
    v_pk_fma_f32 v[14:15], v[6:7], v[6:7], v[14:15]
    v_lshlrev_b32 v6, 16, v50
    v_and_b32 v7, 0xffff0000, v50
    v_pk_add_f32 v[12:13], v[12:13], v[6:7]
    v_pk_fma_f32 v[14:15], v[6:7], v[6:7], v[14:15]
    v_lshlrev_b32 v6, 16, v51
    v_and_b32 v7, 0xffff0000, v51
    v_pk_add_f32 v[12:13], v[12:13], v[6:7]
    v_pk_fma_f32 v[14:15], v[6:7], v[6:7], v[14:15]
    v_add_f32 v12, v12, v13
    v_add_f32 v13, v14, v15
    s_nop 0
    v_add_f32 v12, v12, v12 quad_perm:[1,0,3,2] row_mask:0xf bank_mask:0xf
    v_add_f32 v13, v13, v13 quad_perm:[1,0,3,2] row_mask:0xf bank_mask:0xf
    s_nop 0
    v_add_f32 v12, v12, v12 quad_perm:[2,3,0,1] row_mask:0xf bank_mask:0xf
    v_add_f32 v13, v13, v13 quad_perm:[2,3,0,1] row_mask:0xf bank_mask:0xf
    s_nop 0
    v_add_f32 v12, v12, v12 row_half_mirror row_mask:0xf bank_mask:0xf
    v_add_f32 v13, v13, v13 row_half_mirror row_mask:0xf bank_mask:0xf
    v_mul_f32 v12, 0x3ae38e39, v12
    v_mul_f32 v13, 0x3ae38e39, v13
    v_fma_f32 v13, -v12, v12, v13
    v_max_f32 v13, 0, v13
    v_add_f32 v13, 0x3727c5ac, v13
    v_rsq_f32 v14, v13
    v_lshlrev_b32 v5, 3, v2
    v_mul_f32 v15, v12, v14
    s_lshl_b32 s24, s22, 6
    s_add_u32 s24, s24, 29163520
    v_cmp_eq_u32 vcc, 0, v3
    s_nop 0
    s_and_saveexec_b64 s[26:27], vcc
    buffer_store_dwordx2 v[14:15], v5, s[16:19], s24 offen sc1
    s_mov_b64 exec, -1
    s_barrier
    s_branch k1_h_done
k1_h_cs:
    s_mov_b32 s12, s42
    s_and_b32 s13, s43, 0xffff
    s_mov_b32 s14, 0x1e6000
    s_mov_b32 s15, 0x20000
    s_sub_u32 s22, s20, 4
    s_cmp_lt_u32 s21, 27
    s_cbranch_scc1 k1_h_cs2
    s_sub_u32 s23, s21, 27
    s_lshl_b32 s23, s23, 2
    s_add_u32 s22, s22, s23
    s_lshl_b32 s22, s22, 10
    v_lshlrev_b32 v4, 4, v0
    buffer_load_dwordx4 v[16:19], v4, s[12:15], s22 offen
    s_add_u32 s22, s22, 151552
    buffer_load_dwordx4 v[16:19], v4, s[12:15], s22 offen
    s_add_u32 s22, s22, 151552
    buffer_load_dwordx4 v[16:19], v4, s[12:15], s22 offen
    s_add_u32 s22, s22, 151552
    buffer_load_dwordx4 v[16:19], v4, s[12:15], s22 offen
    s_add_u32 s22, s22, 151552
    buffer_load_dwordx4 v[16:19], v4, s[12:15], s22 offen
    s_add_u32 s22, s22, 151552
    buffer_load_dwordx4 v[16:19], v4, s[12:15], s22 offen
    s_add_u32 s22, s22, 151552
    buffer_load_dwordx4 v[16:19], v4, s[12:15], s22 offen
    s_add_u32 s22, s22, 151552
    buffer_load_dwordx4 v[16:19], v4, s[12:15], s22 offen
    s_add_u32 s22, s22, 151552
    buffer_load_dwordx4 v[16:19], v4, s[12:15], s22 offen
    s_add_u32 s22, s22, 151552
    buffer_load_dwordx4 v[16:19], v4, s[12:15], s22 offen
    s_add_u32 s22, s22, 151552
    buffer_load_dwordx4 v[16:19], v4, s[12:15], s22 offen
    s_add_u32 s22, s22, 151552
    buffer_load_dwordx4 v[16:19], v4, s[12:15], s22 offen
    s_add_u32 s22, s22, 151552
    buffer_load_dwordx4 v[16:19], v4, s[12:15], s22 offen
    s_add_u32 s22, s22, 151552
    buffer_load_dwordx4 v[16:19], v4, s[12:15], s22 offen
    s_add_u32 s22, s22, 151552
    s_branch k1_h_skip
k1_h_cs2:
    v_mul_u32_u24 v4, 3456, v2
    v_add_u32 v4, v4, v3
    s_mul_i32 s23, s22, 497664
    s_lshl_b32 s24, s21, 7
    s_add_u32 s23, s23, s24
    buffer_load_dwordx4 v[16:19], v4, s[12:15], s23 offen
    s_add_u32 s23, s23, 27648
    buffer_load_dwordx4 v[20:23], v4, s[12:15], s23 offen
    s_add_u32 s23, s23, 27648
    buffer_load_dwordx4 v[24:27], v4, s[12:15], s23 offen
    s_add_u32 s23, s23, 27648
    buffer_load_dwordx4 v[28:31], v4, s[12:15], s23 offen
    s_add_u32 s23, s23, 27648
    buffer_load_dwordx4 v[32:35], v4, s[12:15], s23 offen
    s_add_u32 s23, s23, 27648
    buffer_load_dwordx4 v[36:39], v4, s[12:15], s23 offen
    s_add_u32 s23, s23, 27648
    buffer_load_dwordx4 v[40:43], v4, s[12:15], s23 offen
    s_add_u32 s23, s23, 27648
    buffer_load_dwordx4 v[44:47], v4, s[12:15], s23 offen
    s_add_u32 s23, s23, 27648
    buffer_load_dwordx4 v[48:51], v4, s[12:15], s23 offen
    s_add_u32 s23, s23, 27648
    buffer_load_dwordx4 v[52:55], v4, s[12:15], s23 offen
    s_add_u32 s23, s23, 27648
    buffer_load_dwordx4 v[56:59], v4, s[12:15], s23 offen
    s_add_u32 s23, s23, 27648
    buffer_load_dwordx4 v[60:63], v4, s[12:15], s23 offen
    s_add_u32 s23, s23, 27648
    buffer_load_dwordx4 v[64:67], v4, s[12:15], s23 offen
    s_add_u32 s23, s23, 27648
    buffer_load_dwordx4 v[68:71], v4, s[12:15], s23 offen
    s_add_u32 s23, s23, 27648
    buffer_load_dwordx4 v[72:75], v4, s[12:15], s23 offen
    s_add_u32 s23, s23, 27648
    buffer_load_dwordx4 v[76:79], v4, s[12:15], s23 offen
    s_add_u32 s23, s23, 27648
    buffer_load_dwordx4 v[80:83], v4, s[12:15], s23 offen
    s_add_u32 s23, s23, 27648
    buffer_load_dwordx4 v[84:87], v4, s[12:15], s23 offen
    s_add_u32 s23, s23, 27648
    v_mov_b32 v8, 0
    v_mov_b32 v9, 0
    v_mov_b32 v10, 0
    v_mov_b32 v11, 0
    v_mov_b32 v12, 0
    v_mov_b32 v13, 0
    v_mov_b32 v14, 0
    v_mov_b32 v15, 0
    s_waitcnt vmcnt(17)
    v_lshlrev_b32 v6, 16, v16
    v_and_b32 v7, 0xffff0000, v16
    v_pk_add_f32 v[8:9], v[8:9], v[6:7]
    v_lshlrev_b32 v6, 16, v17
    v_and_b32 v7, 0xffff0000, v17
    v_pk_add_f32 v[10:11], v[10:11], v[6:7]
    v_lshlrev_b32 v6, 16, v18
    v_and_b32 v7, 0xffff0000, v18
    v_pk_add_f32 v[12:13], v[12:13], v[6:7]
    v_lshlrev_b32 v6, 16, v19
    v_and_b32 v7, 0xffff0000, v19
    v_pk_add_f32 v[14:15], v[14:15], v[6:7]
    s_waitcnt vmcnt(16)
    v_lshlrev_b32 v6, 16, v20
    v_and_b32 v7, 0xffff0000, v20
    v_pk_add_f32 v[8:9], v[8:9], v[6:7]
    v_lshlrev_b32 v6, 16, v21
    v_and_b32 v7, 0xffff0000, v21
    v_pk_add_f32 v[10:11], v[10:11], v[6:7]
    v_lshlrev_b32 v6, 16, v22
    v_and_b32 v7, 0xffff0000, v22
    v_pk_add_f32 v[12:13], v[12:13], v[6:7]
    v_lshlrev_b32 v6, 16, v23
    v_and_b32 v7, 0xffff0000, v23
    v_pk_add_f32 v[14:15], v[14:15], v[6:7]
    s_waitcnt vmcnt(15)
    v_lshlrev_b32 v6, 16, v24
    v_and_b32 v7, 0xffff0000, v24
    v_pk_add_f32 v[8:9], v[8:9], v[6:7]
    v_lshlrev_b32 v6, 16, v25
    v_and_b32 v7, 0xffff0000, v25
    v_pk_add_f32 v[10:11], v[10:11], v[6:7]
    v_lshlrev_b32 v6, 16, v26
    v_and_b32 v7, 0xffff0000, v26
    v_pk_add_f32 v[12:13], v[12:13], v[6:7]
    v_lshlrev_b32 v6, 16, v27
    v_and_b32 v7, 0xffff0000, v27
    v_pk_add_f32 v[14:15], v[14:15], v[6:7]
    s_waitcnt vmcnt(14)
    v_lshlrev_b32 v6, 16, v28
    v_and_b32 v7, 0xffff0000, v28
    v_pk_add_f32 v[8:9], v[8:9], v[6:7]
    v_lshlrev_b32 v6, 16, v29
    v_and_b32 v7, 0xffff0000, v29
    v_pk_add_f32 v[10:11], v[10:11], v[6:7]
    v_lshlrev_b32 v6, 16, v30
    v_and_b32 v7, 0xffff0000, v30
    v_pk_add_f32 v[12:13], v[12:13], v[6:7]
    v_lshlrev_b32 v6, 16, v31
    v_and_b32 v7, 0xffff0000, v31
    v_pk_add_f32 v[14:15], v[14:15], v[6:7]
    s_waitcnt vmcnt(13)
    v_lshlrev_b32 v6, 16, v32
    v_and_b32 v7, 0xffff0000, v32
    v_pk_add_f32 v[8:9], v[8:9], v[6:7]
    v_lshlrev_b32 v6, 16, v33
    v_and_b32 v7, 0xffff0000, v33
    v_pk_add_f32 v[10:11], v[10:11], v[6:7]
    v_lshlrev_b32 v6, 16, v34
    v_and_b32 v7, 0xffff0000, v34
    v_pk_add_f32 v[12:13], v[12:13], v[6:7]
    v_lshlrev_b32 v6, 16, v35
    v_and_b32 v7, 0xffff0000, v35
    v_pk_add_f32 v[14:15], v[14:15], v[6:7]
    s_waitcnt vmcnt(12)
    v_lshlrev_b32 v6, 16, v36
    v_and_b32 v7, 0xffff0000, v36
    v_pk_add_f32 v[8:9], v[8:9], v[6:7]
    v_lshlrev_b32 v6, 16, v37
    v_and_b32 v7, 0xffff0000, v37
    v_pk_add_f32 v[10:11], v[10:11], v[6:7]
    v_lshlrev_b32 v6, 16, v38
    v_and_b32 v7, 0xffff0000, v38
    v_pk_add_f32 v[12:13], v[12:13], v[6:7]
    v_lshlrev_b32 v6, 16, v39
    v_and_b32 v7, 0xffff0000, v39
    v_pk_add_f32 v[14:15], v[14:15], v[6:7]
    s_waitcnt vmcnt(11)
    v_lshlrev_b32 v6, 16, v40
    v_and_b32 v7, 0xffff0000, v40
    v_pk_add_f32 v[8:9], v[8:9], v[6:7]
    v_lshlrev_b32 v6, 16, v41
    v_and_b32 v7, 0xffff0000, v41
    v_pk_add_f32 v[10:11], v[10:11], v[6:7]
    v_lshlrev_b32 v6, 16, v42
    v_and_b32 v7, 0xffff0000, v42
    v_pk_add_f32 v[12:13], v[12:13], v[6:7]
    v_lshlrev_b32 v6, 16, v43
    v_and_b32 v7, 0xffff0000, v43
    v_pk_add_f32 v[14:15], v[14:15], v[6:7]
    s_waitcnt vmcnt(10)
    v_lshlrev_b32 v6, 16, v44
    v_and_b32 v7, 0xffff0000, v44
    v_pk_add_f32 v[8:9], v[8:9], v[6:7]
    v_lshlrev_b32 v6, 16, v45
    v_and_b32 v7, 0xffff0000, v45
    v_pk_add_f32 v[10:11], v[10:11], v[6:7]
    v_lshlrev_b32 v6, 16, v46
    v_and_b32 v7, 0xffff0000, v46
    v_pk_add_f32 v[12:13], v[12:13], v[6:7]
    v_lshlrev_b32 v6, 16, v47
    v_and_b32 v7, 0xffff0000, v47
    v_pk_add_f32 v[14:15], v[14:15], v[6:7]
    s_waitcnt vmcnt(9)
    v_lshlrev_b32 v6, 16, v48
    v_and_b32 v7, 0xffff0000, v48
    v_pk_add_f32 v[8:9], v[8:9], v[6:7]
    v_lshlrev_b32 v6, 16, v49
    v_and_b32 v7, 0xffff0000, v49
    v_pk_add_f32 v[10:11], v[10:11], v[6:7]
    v_lshlrev_b32 v6, 16, v50
    v_and_b32 v7, 0xffff0000, v50
    v_pk_add_f32 v[12:13], v[12:13], v[6:7]
    v_lshlrev_b32 v6, 16, v51
    v_and_b32 v7, 0xffff0000, v51
    v_pk_add_f32 v[14:15], v[14:15], v[6:7]
    s_waitcnt vmcnt(8)
    v_lshlrev_b32 v6, 16, v52
    v_and_b32 v7, 0xffff0000, v52
    v_pk_add_f32 v[8:9], v[8:9], v[6:7]
    v_lshlrev_b32 v6, 16, v53
    v_and_b32 v7, 0xffff0000, v53
    v_pk_add_f32 v[10:11], v[10:11], v[6:7]
    v_lshlrev_b32 v6, 16, v54
    v_and_b32 v7, 0xffff0000, v54
    v_pk_add_f32 v[12:13], v[12:13], v[6:7]
    v_lshlrev_b32 v6, 16, v55
    v_and_b32 v7, 0xffff0000, v55
    v_pk_add_f32 v[14:15], v[14:15], v[6:7]
    s_waitcnt vmcnt(7)
    v_lshlrev_b32 v6, 16, v56
    v_and_b32 v7, 0xffff0000, v56
    v_pk_add_f32 v[8:9], v[8:9], v[6:7]
    v_lshlrev_b32 v6, 16, v57
    v_and_b32 v7, 0xffff0000, v57
    v_pk_add_f32 v[10:11], v[10:11], v[6:7]
    v_lshlrev_b32 v6, 16, v58
    v_and_b32 v7, 0xffff0000, v58
    v_pk_add_f32 v[12:13], v[12:13], v[6:7]
    v_lshlrev_b32 v6, 16, v59
    v_and_b32 v7, 0xffff0000, v59
    v_pk_add_f32 v[14:15], v[14:15], v[6:7]
    s_waitcnt vmcnt(6)
    v_lshlrev_b32 v6, 16, v60
    v_and_b32 v7, 0xffff0000, v60
    v_pk_add_f32 v[8:9], v[8:9], v[6:7]
    v_lshlrev_b32 v6, 16, v61
    v_and_b32 v7, 0xffff0000, v61
    v_pk_add_f32 v[10:11], v[10:11], v[6:7]
    v_lshlrev_b32 v6, 16, v62
    v_and_b32 v7, 0xffff0000, v62
    v_pk_add_f32 v[12:13], v[12:13], v[6:7]
    v_lshlrev_b32 v6, 16, v63
    v_and_b32 v7, 0xffff0000, v63
    v_pk_add_f32 v[14:15], v[14:15], v[6:7]
    s_waitcnt vmcnt(5)
    v_lshlrev_b32 v6, 16, v64
    v_and_b32 v7, 0xffff0000, v64
    v_pk_add_f32 v[8:9], v[8:9], v[6:7]
    v_lshlrev_b32 v6, 16, v65
    v_and_b32 v7, 0xffff0000, v65
    v_pk_add_f32 v[10:11], v[10:11], v[6:7]
    v_lshlrev_b32 v6, 16, v66
    v_and_b32 v7, 0xffff0000, v66
    v_pk_add_f32 v[12:13], v[12:13], v[6:7]
    v_lshlrev_b32 v6, 16, v67
    v_and_b32 v7, 0xffff0000, v67
    v_pk_add_f32 v[14:15], v[14:15], v[6:7]
    s_waitcnt vmcnt(4)
    v_lshlrev_b32 v6, 16, v68
    v_and_b32 v7, 0xffff0000, v68
    v_pk_add_f32 v[8:9], v[8:9], v[6:7]
    v_lshlrev_b32 v6, 16, v69
    v_and_b32 v7, 0xffff0000, v69
    v_pk_add_f32 v[10:11], v[10:11], v[6:7]
    v_lshlrev_b32 v6, 16, v70
    v_and_b32 v7, 0xffff0000, v70
    v_pk_add_f32 v[12:13], v[12:13], v[6:7]
    v_lshlrev_b32 v6, 16, v71
    v_and_b32 v7, 0xffff0000, v71
    v_pk_add_f32 v[14:15], v[14:15], v[6:7]
    s_waitcnt vmcnt(3)
    v_lshlrev_b32 v6, 16, v72
    v_and_b32 v7, 0xffff0000, v72
    v_pk_add_f32 v[8:9], v[8:9], v[6:7]
    v_lshlrev_b32 v6, 16, v73
    v_and_b32 v7, 0xffff0000, v73
    v_pk_add_f32 v[10:11], v[10:11], v[6:7]
    v_lshlrev_b32 v6, 16, v74
    v_and_b32 v7, 0xffff0000, v74
    v_pk_add_f32 v[12:13], v[12:13], v[6:7]
    v_lshlrev_b32 v6, 16, v75
    v_and_b32 v7, 0xffff0000, v75
    v_pk_add_f32 v[14:15], v[14:15], v[6:7]
    s_waitcnt vmcnt(2)
    v_lshlrev_b32 v6, 16, v76
    v_and_b32 v7, 0xffff0000, v76
    v_pk_add_f32 v[8:9], v[8:9], v[6:7]
    v_lshlrev_b32 v6, 16, v77
    v_and_b32 v7, 0xffff0000, v77
    v_pk_add_f32 v[10:11], v[10:11], v[6:7]
    v_lshlrev_b32 v6, 16, v78
    v_and_b32 v7, 0xffff0000, v78
    v_pk_add_f32 v[12:13], v[12:13], v[6:7]
    v_lshlrev_b32 v6, 16, v79
    v_and_b32 v7, 0xffff0000, v79
    v_pk_add_f32 v[14:15], v[14:15], v[6:7]
    s_waitcnt vmcnt(1)
    v_lshlrev_b32 v6, 16, v80
    v_and_b32 v7, 0xffff0000, v80
    v_pk_add_f32 v[8:9], v[8:9], v[6:7]
    v_lshlrev_b32 v6, 16, v81
    v_and_b32 v7, 0xffff0000, v81
    v_pk_add_f32 v[10:11], v[10:11], v[6:7]
    v_lshlrev_b32 v6, 16, v82
    v_and_b32 v7, 0xffff0000, v82
    v_pk_add_f32 v[12:13], v[12:13], v[6:7]
    v_lshlrev_b32 v6, 16, v83
    v_and_b32 v7, 0xffff0000, v83
    v_pk_add_f32 v[14:15], v[14:15], v[6:7]
    s_waitcnt vmcnt(0)
    v_lshlrev_b32 v6, 16, v84
    v_and_b32 v7, 0xffff0000, v84
    v_pk_add_f32 v[8:9], v[8:9], v[6:7]
    v_lshlrev_b32 v6, 16, v85
    v_and_b32 v7, 0xffff0000, v85
    v_pk_add_f32 v[10:11], v[10:11], v[6:7]
    v_lshlrev_b32 v6, 16, v86
    v_and_b32 v7, 0xffff0000, v86
    v_pk_add_f32 v[12:13], v[12:13], v[6:7]
    v_lshlrev_b32 v6, 16, v87
    v_and_b32 v7, 0xffff0000, v87
    v_pk_add_f32 v[14:15], v[14:15], v[6:7]
    s_lshl_b32 s24, s22, 11
    v_lshlrev_b32 v5, 5, v0
    v_add_u32 v5, s24, v5
    ds_write_b128 v5, v[8:11]
    ds_write_b128 v5, v[12:15] offset:16
    s_waitcnt lgkmcnt(0)
k1_h_skip:
    s_barrier
    s_cmp_lg_u32 s20, 4
    s_cbranch_scc1 k1_h_done
    s_cmp_ge_u32 s21, 27
    s_cbranch_scc1 k1_h_done
    v_lshlrev_b32 v5, 2, v0
    ds_read_b32 v16, v5 offset:0
    ds_read_b32 v17, v5 offset:256
    ds_read_b32 v18, v5 offset:512
    ds_read_b32 v19, v5 offset:768
    ds_read_b32 v20, v5 offset:1024
    ds_read_b32 v21, v5 offset:1280
    ds_read_b32 v22, v5 offset:1536
    ds_read_b32 v23, v5 offset:1792
    ds_read_b32 v24, v5 offset:2048
    ds_read_b32 v25, v5 offset:2304
    ds_read_b32 v26, v5 offset:2560
    ds_read_b32 v27, v5 offset:2816
    ds_read_b32 v28, v5 offset:3072
    ds_read_b32 v29, v5 offset:3328
    ds_read_b32 v30, v5 offset:3584
    ds_read_b32 v31, v5 offset:3840
    s_waitcnt lgkmcnt(0)
    v_add_f32 v16, v16, v24
    v_add_f32 v17, v17, v25
    v_add_f32 v18, v18, v26
    v_add_f32 v19, v19, v27
    v_add_f32 v20, v20, v28
    v_add_f32 v21, v21, v29
    v_add_f32 v22, v22, v30
    v_add_f32 v23, v23, v31
    v_add_f32 v16, v16, v20
    v_add_f32 v17, v17, v21
    v_add_f32 v18, v18, v22
    v_add_f32 v19, v19, v23
    v_add_f32 v16, v16, v18
    v_add_f32 v17, v17, v19
    v_add_f32 v16, v16, v17
    v_mov_b32 v8, v16
    ds_read_b32 v16, v5 offset:4096
    ds_read_b32 v17, v5 offset:4352
    ds_read_b32 v18, v5 offset:4608
    ds_read_b32 v19, v5 offset:4864
    ds_read_b32 v20, v5 offset:5120
    ds_read_b32 v21, v5 offset:5376
    ds_read_b32 v22, v5 offset:5632
    ds_read_b32 v23, v5 offset:5888
    ds_read_b32 v24, v5 offset:6144
    ds_read_b32 v25, v5 offset:6400
    ds_read_b32 v26, v5 offset:6656
    ds_read_b32 v27, v5 offset:6912
    ds_read_b32 v28, v5 offset:7168
    ds_read_b32 v29, v5 offset:7424
    ds_read_b32 v30, v5 offset:7680
    ds_read_b32 v31, v5 offset:7936
    s_waitcnt lgkmcnt(0)
    v_add_f32 v16, v16, v24
    v_add_f32 v17, v17, v25
    v_add_f32 v18, v18, v26
    v_add_f32 v19, v19, v27
    v_add_f32 v20, v20, v28
    v_add_f32 v21, v21, v29
    v_add_f32 v22, v22, v30
    v_add_f32 v23, v23, v31
    v_add_f32 v16, v16, v20
    v_add_f32 v17, v17, v21
    v_add_f32 v18, v18, v22
    v_add_f32 v19, v19, v23
    v_add_f32 v16, v16, v18
    v_add_f32 v17, v17, v19
    v_add_f32 v16, v16, v17
    v_add_f32 v8, v8, v16
    s_lshl_b32 s24, s21, 8
    s_add_u32 s24, s24, 29179904
    buffer_store_dword v8, v5, s[16:19], s24 offen sc1
k1_h_done:
    s_waitcnt vmcnt(0)
    s_barrier
    s_cmp_lg_u32 s20, 0
    s_cbranch_scc1 k1_h_c0
    v_mov_b32 v2, 0
    v_mov_b32 v3, 1
    s_mov_b64 exec, 1
    global_atomic_add v2, v3, s[44:45] sc1
    s_mov_b64 exec, -1
k1_h_c0:
    v_mov_b32 v8, -1
    v_mov_b32 v9, -1
    v_mov_b32 v10, -1
    v_mov_b32 v11, -1
    v_lshlrev_b32 v5, 4, v0
    s_lshl_b32 s24, s21, 3
    s_add_u32 s24, s24, s20
    s_mul_i32 s24, s24, 4608
    s_add_u32 s24, s24, 9437184
    buffer_store_dwordx4 v[8:11], v5, s[16:19], s24 offen offset:0 sc1
    buffer_store_dwordx4 v[8:11], v5, s[16:19], s24 offen offset:1024 sc1
    buffer_store_dwordx4 v[8:11], v5, s[16:19], s24 offen offset:2048 sc1
    buffer_store_dwordx4 v[8:11], v5, s[16:19], s24 offen offset:3072 sc1
    s_add_u32 s24, s24, 4096
    s_mov_b32 exec_hi, 0
    buffer_store_dwordx4 v[8:11], v5, s[16:19], s24 offen sc1
    s_mov_b32 exec_hi, -1
    s_waitcnt vmcnt(0)
    s_barrier
    s_cmp_lg_u32 s20, 0
    s_cbranch_scc1 k1_h_c1
    v_mov_b32 v2, 128
    v_mov_b32 v3, 1
    s_mov_b64 exec, 1
    global_atomic_add v2, v3, s[44:45] sc1
    s_mov_b64 exec, -1
k1_h_c1:
    s_load_dwordx2 s[32:33], s[0:1], 16
    s_load_dwordx2 s[34:35], s[0:1], 32
    v_lshlrev_b32 v2, 4, v0
    s_sub_u32 s24, s2, 192
    s_mul_i32 s24, s24, 8
    s_add_u32 s24, s24, s20
    s_waitcnt lgkmcnt(0)
    s_mov_b32 s8, s32
    s_and_b32 s9, s33, 0xffff
    s_mov_b32 s10, 0xa2000
    s_mov_b32 s11, 0x20000
    s_lshl_b32 s25, s24, 10
    s_add_u32 s25, s25, 0
    buffer_load_dwordx4 v[4:7], v2, s[8:11], s25 offen
    s_add_u32 s25, s25, 524288
    buffer_load_dwordx4 v[4:7], v2, s[8:11], s25 offen
    s_add_u32 s25, s25, 524288
    s_mov_b32 s8, s34
    s_and_b32 s9, s35, 0xffff
    s_mov_b32 s10, 0x600000
    s_mov_b32 s11, 0x20000
    s_lshl_b32 s25, s24, 10
    s_add_u32 s25, s25, 0
    buffer_load_dwordx4 v[4:7], v2, s[8:11], s25 offen
    s_add_u32 s25, s25, 524288
    buffer_load_dwordx4 v[4:7], v2, s[8:11], s25 offen
    s_add_u32 s25, s25, 524288
    buffer_load_dwordx4 v[4:7], v2, s[8:11], s25 offen
    s_add_u32 s25, s25, 524288
    buffer_load_dwordx4 v[4:7], v2, s[8:11], s25 offen
    s_add_u32 s25, s25, 524288
    buffer_load_dwordx4 v[4:7], v2, s[8:11], s25 offen
    s_add_u32 s25, s25, 524288
    buffer_load_dwordx4 v[4:7], v2, s[8:11], s25 offen
    s_add_u32 s25, s25, 524288
    buffer_load_dwordx4 v[4:7], v2, s[8:11], s25 offen
    s_add_u32 s25, s25, 524288
    buffer_load_dwordx4 v[4:7], v2, s[8:11], s25 offen
    s_add_u32 s25, s25, 524288
    buffer_load_dwordx4 v[4:7], v2, s[8:11], s25 offen
    s_add_u32 s25, s25, 524288
    buffer_load_dwordx4 v[4:7], v2, s[8:11], s25 offen
    s_add_u32 s25, s25, 524288
    buffer_load_dwordx4 v[4:7], v2, s[8:11], s25 offen
    s_add_u32 s25, s25, 524288
    buffer_load_dwordx4 v[4:7], v2, s[8:11], s25 offen
    s_add_u32 s25, s25, 524288
    s_waitcnt vmcnt(0)
    s_branch k2_entry
k1_end:
    s_endpgm
k2_entry:
    s_load_dwordx2 s[4:5], s[0:1], 80
    s_load_dwordx2 s[6:7], s[0:1], 32
    s_load_dwordx2 s[98:99], s[0:1], 48
    s_load_dwordx2 s[86:87], s[0:1], 0
    s_load_dwordx2 s[88:89], s[0:1], 16
    s_load_dwordx2 s[100:101], s[0:1], 72
    s_mov_b32 s12, s3
    v_lshlrev_b32 v1, 4, v0
    s_and_b32 s16, s2, 7
    s_lshl_b32 s16, s16, 1
    s_bfe_u32 s15, s2, 0x10003
    s_add_u32 s16, s16, s15
    s_lshr_b32 s17, s2, 4
    s_lshl_b32 s17, s17, 2
    s_lshr_b32 s18, s12, 2
    s_and_b32 s19, s12, 3
    s_lshl_b32 s13, s16, 1
    s_add_u32 s13, s13, s18
    s_add_u32 s14, s17, s19
    s_lshl_b32 s20, s13, 6
    s_add_u32 s20, s20, s17
    s_mul_i32 s21, s19, 3
    s_add_u32 s21, s21, s20
    s_lshl_b32 s21, s21, 10
    s_add_u32 s21, s21, 4448256
    s_mul_i32 s22, s12, 3072
    s_add_u32 s23, s21, 2097152
    s_mul_i32 s25, s18, 15360
    s_mul_i32 s24, s19, 3840
    s_add_u32 s25, s25, s24
    s_add_u32 s25, s25, 27648
    s_lshl_b32 s26, s16, 14
    s_lshl_b32 s27, s17, 8
    s_add_u32 s26, s26, s27
    s_lshl_b32 s27, s12, 10
    s_add_u32 s28, s26, s27
    s_add_u32 s28, s28, 9172992
    v_and_b32 v5, 31, v0
    v_lshrrev_b32 v6, 5, v0
    s_waitcnt lgkmcnt(0)
    s_mov_b32 s8, s4
    s_and_b32 s9, s5, 0xffff
    s_mov_b32 s10, 0x1c06000
    s_mov_b32 s11, 0x20000
    v_lshlrev_b32 v2, 3, v5
    s_lshl_b32 s29, s18, 2
    v_add_u32 v2, s29, v2
    v_lshl_or_b32 v104, v6, 30, v2
    s_mov_b32 s94, s21
    s_mov_b32 s95, s22
    s_mov_b32 s76, s88
    s_and_b32 s77, s89, 0xffff
    s_mov_b32 s78, 0xa2000
    s_mov_b32 s79, 0x20000
    s_mov_b32 s80, s86
    s_and_b32 s81, s87, 0xffff
    s_mov_b32 s82, 0x240000
    s_mov_b32 s83, 0x20000
    s_lshr_b32 s84, s2, 5
    s_lshl_b32 s84, s84, 3
    s_and_b32 s85, s2, 7
    s_add_u32 s84, s84, s85
    s_bfe_u32 s85, s2, 0x20003
    s_mul_i32 s90, s85, 288
    s_lshl_b32 s91, s12, 10
    s_lshl_b32 s92, s12, 6
    v_add_u32 v112, s92, v0
    v_mul_u32_u24 v113, 6899, v112
    v_lshrrev_b32 v113, 20, v113
    v_mul_u32_u24 v114, 152, v113
    v_sub_u32 v114, v112, v114
    v_mul_u32_u24 v115, 3641, v114
    v_lshrrev_b32 v115, 16, v115
    v_mul_u32_u24 v116, 18, v115
    v_sub_u32 v116, v114, v116
    v_lshrrev_b32 v112, 2, v113
    v_mul_u32_u24 v112, 36, v112
    v_bfe_u32 v117, v113, 1, 1
    v_mad_u32_u24 v112, v117, 20, v112
    v_and_b32 v117, 1, v113
    v_lshl_add_u32 v112, v117, 2, v112
    v_lshrrev_b32 v117, 2, v115
    v_lshl_add_u32 v112, v117, 3, v112
    v_and_b32 v117, 3, v115
    v_add_u32 v112, v112, v117
    v_mul_u32_u24 v112, 1152, v112
    v_lshl_add_u32 v112, v116, 4, v112
    v_cmp_lt_u32 vcc, 143, v114
    v_mov_b32 v117, 0x40000000
    s_nop 0
    v_cndmask_b32 v76, v112, v117, vcc
    s_lshl_b32 s92, s12, 6
    v_add_u32 v112, s92, v0
    v_add_u32 v112, 512, v112
    v_mul_u32_u24 v113, 6899, v112
    v_lshrrev_b32 v113, 20, v113
    v_mul_u32_u24 v114, 152, v113
    v_sub_u32 v114, v112, v114
    v_mul_u32_u24 v115, 3641, v114
    v_lshrrev_b32 v115, 16, v115
    v_mul_u32_u24 v116, 18, v115
    v_sub_u32 v116, v114, v116
    v_lshrrev_b32 v112, 2, v113
    v_mul_u32_u24 v112, 36, v112
    v_bfe_u32 v117, v113, 1, 1
    v_mad_u32_u24 v112, v117, 20, v112
    v_and_b32 v117, 1, v113
    v_lshl_add_u32 v112, v117, 2, v112
    v_lshrrev_b32 v117, 2, v115
    v_lshl_add_u32 v112, v117, 3, v112
    v_and_b32 v117, 3, v115
    v_add_u32 v112, v112, v117
    v_mul_u32_u24 v112, 1152, v112
    v_lshl_add_u32 v112, v116, 4, v112
    v_cmp_lt_u32 vcc, 143, v114
    v_mov_b32 v117, 0x40000000
    s_nop 0
    v_cndmask_b32 v77, v112, v117, vcc
    s_lshl_b32 s92, s12, 6
    v_add_u32 v112, s92, v0
    v_add_u32 v112, 1024, v112
    v_mul_u32_u24 v113, 6899, v112
    v_lshrrev_b32 v113, 20, v113
    v_mul_u32_u24 v114, 152, v113
    v_sub_u32 v114, v112, v114
    v_mul_u32_u24 v115, 3641, v114
    v_lshrrev_b32 v115, 16, v115
    v_mul_u32_u24 v116, 18, v115
    v_sub_u32 v116, v114, v116
    v_lshrrev_b32 v112, 2, v113
    v_mul_u32_u24 v112, 36, v112
    v_bfe_u32 v117, v113, 1, 1
    v_mad_u32_u24 v112, v117, 20, v112
    v_and_b32 v117, 1, v113
    v_lshl_add_u32 v112, v117, 2, v112
    v_lshrrev_b32 v117, 2, v115
    v_lshl_add_u32 v112, v117, 3, v112
    v_and_b32 v117, 3, v115
    v_add_u32 v112, v112, v117
    v_mul_u32_u24 v112, 1152, v112
    v_lshl_add_u32 v112, v116, 4, v112
    v_lshrrev_b32 v117, 3, v113
    v_lshl_add_u32 v114, v117, 8, v114
    v_cmp_lt_u32 vcc, 143, v114
    v_mov_b32 v117, 0x40000000
    s_nop 0
    v_cndmask_b32 v78, v112, v117, vcc
    s_lshl_b32 s92, s12, 6
    v_add_u32 v112, s92, v0
    v_mul_u32_u24 v113, 6899, v112
    v_lshrrev_b32 v113, 20, v113
    v_mul_u32_u24 v114, 152, v113
    v_sub_u32 v114, v112, v114
    v_mul_u32_u24 v115, 3641, v114
    v_lshrrev_b32 v115, 16, v115
    v_mul_u32_u24 v116, 18, v115
    v_sub_u32 v116, v114, v116
    v_lshrrev_b32 v117, 1, v115
    v_lshl_add_u32 v112, v113, 2, v117
    v_mul_u32_u24 v112, 18, v112
    v_and_b32 v117, 1, v117
    v_lshlrev_b32 v117, 4, v117
    v_sub_u32 v112, v112, v117
    v_and_b32 v117, 1, v115
    v_add3_u32 v112, v112, v117, 16
    v_mul_u32_u24 v112, 1152, v112
    v_lshl_add_u32 v112, v116, 4, v112
    v_cmp_lt_u32 vcc, 143, v114
    v_mov_b32 v117, 0x40000000
    s_nop 0
    v_cndmask_b32 v79, v112, v117, vcc
    s_lshl_b32 s92, s12, 6
    v_add_u32 v112, s92, v0
    v_add_u32 v112, 512, v112
    v_mul_u32_u24 v113, 6899, v112
    v_lshrrev_b32 v113, 20, v113
    v_mul_u32_u24 v114, 152, v113
    v_sub_u32 v114, v112, v114
    v_mul_u32_u24 v115, 3641, v114
    v_lshrrev_b32 v115, 16, v115
    v_mul_u32_u24 v116, 18, v115
    v_sub_u32 v116, v114, v116
    v_lshrrev_b32 v117, 1, v115
    v_lshl_add_u32 v112, v113, 2, v117
    v_mul_u32_u24 v112, 18, v112
    v_and_b32 v117, 1, v117
    v_lshlrev_b32 v117, 4, v117
    v_sub_u32 v112, v112, v117
    v_and_b32 v117, 1, v115
    v_add3_u32 v112, v112, v117, 16
    v_mul_u32_u24 v112, 1152, v112
    v_lshl_add_u32 v112, v116, 4, v112
    v_cmp_lt_u32 vcc, 143, v114
    v_mov_b32 v117, 0x40000000
    s_nop 0
    v_cndmask_b32 v80, v112, v117, vcc
    s_lshl_b32 s92, s12, 6
    v_add_u32 v112, s92, v0
    v_add_u32 v112, 1024, v112
    v_mul_u32_u24 v113, 6899, v112
    v_lshrrev_b32 v113, 20, v113
    v_mul_u32_u24 v114, 152, v113
    v_sub_u32 v114, v112, v114
    v_mul_u32_u24 v115, 3641, v114
    v_lshrrev_b32 v115, 16, v115
    v_mul_u32_u24 v116, 18, v115
    v_sub_u32 v116, v114, v116
    v_lshrrev_b32 v117, 1, v115
    v_lshl_add_u32 v112, v113, 2, v117
    v_mul_u32_u24 v112, 18, v112
    v_and_b32 v117, 1, v117
    v_lshlrev_b32 v117, 4, v117
    v_sub_u32 v112, v112, v117
    v_and_b32 v117, 1, v115
    v_add3_u32 v112, v112, v117, 16
    v_mul_u32_u24 v112, 1152, v112
    v_lshl_add_u32 v112, v116, 4, v112
    v_lshrrev_b32 v117, 3, v113
    v_lshl_add_u32 v114, v117, 8, v114
    v_cmp_lt_u32 vcc, 143, v114
    v_mov_b32 v117, 0x40000000
    s_nop 0
    v_cndmask_b32 v81, v112, v117, vcc
    s_mul_i32 s93, s84, 36864
    s_add_u32 s93, s93, s90
    s_mul_i32 s21, s18, 12288
    s_lshl_b32 s22, s19, 10
    s_add_u32 s21, s21, s22
    v_add_u32 v4, s21, v1
    s_lshl_b32 s22, s19, 8
    s_add_u32 s22, s22, 24576
    v_add_u32 v2, s22, v2
    v_lshlrev_b32 v3, 8, v6
    v_lshl_add_u32 v3, v5, 4, v3
    v_min_u32 v7, 18, v5
    v_lshlrev_b32 v7, 4, v7
    v_lshl_add_u32 v7, v6, 6, v7
    v_add_u32 v7, 768, v7
    v_cmp_lt_u32 vcc, 15, v5
    s_nop 1
    v_cndmask_b32 v3, v3, v7, vcc
    v_mov_b32 v7, 512
    v_mov_b32 v105, 128
    v_cndmask_b32 v103, v7, v105, vcc
    s_mul_i32 s21, s18, 15360
    s_mul_i32 s22, s19, 1280
    s_add_u32 s21, s21, s22
    s_add_u32 s21, s21, 27648
    v_add_u32 v3, s21, v3
    v_add_u32 v103, v103, v3
    s_lshl_b32 s21, s12, 6
    v_add_u32 v105, s21, v0
    v_mov_b32 v88, 0
    v_mov_b32 v89, 0
    s_cmp_ge_u32 s12, 3
    s_cbranch_scc1 k2_vones
    v_lshrrev_b32 v106, 4, v105
    v_bfe_u32 v107, v105, 2, 2
    v_and_b32 v108, 3, v105
    v_lshlrev_b32 v89, 10, v106
    v_lshl_add_u32 v89, v107, 8, v89
    v_lshl_add_u32 v89, v108, 4, v89
    v_add_u32 v109, s17, v106
    v_cmp_gt_u32 vcc, 8, v109
    v_mov_b32 v109, 0x40000000
    s_nop 0
    v_cndmask_b32 v89, v89, v109, vcc
    v_mul_u32_u24 v88, 1280, v106
    v_lshl_add_u32 v88, v107, 6, v88
    v_bfe_u32 v109, v105, 1, 1
    v_mul_u32_u24 v109, 15360, v109
    v_and_b32 v108, 1, v105
    v_lshl_add_u32 v109, v108, 4, v109
    v_add_u32 v88, v88, v109
    v_add_u32 v88, 28672, v88
    s_branch k2_vonesd
k2_vones:
    s_cmp_ge_u32 s12, 5
    s_cbranch_scc1 k2_vonesd
    v_subrev_u32 v105, 192, v105
    v_min_u32 v105, 95, v105
    v_lshrrev_b32 v106, 2, v105
    v_mul_u32_u24 v106, 1280, v106
    v_and_b32 v107, 3, v105
    v_lshl_add_u32 v106, v107, 6, v106
    v_add_u32 v106, 28704, v106
    v_mov_b32 v108, 0x3f803f80
    v_mov_b32 v109, 0x3f803f80
    v_mov_b32 v110, 0x3f803f80
    v_mov_b32 v111, 0x3f803f80
    ds_write_b128 v106, v[108:111]
k2_vonesd:
    s_lshr_b32 s24, s16, 2
    s_lshl_b32 s24, s24, 6
    s_add_u32 s24, s24, s17
    s_lshl_b32 s24, s24, 10
    s_and_b32 s21, s16, 3
    s_lshl_b32 s21, s21, 6
    s_add_u32 s24, s24, s21
    s_add_u32 s24, s24, 8642560
    v_mov_b32 v61, 0
    v_mov_b32 v62, 0
    v_mov_b32 v63, 0
    v_lshlrev_b32 v7, 2, v6
    v_sub_u32 v7, v5, v7
    v_cmp_le_i32 s[32:33], 0, v7
    v_cmp_le_i32 s[34:35], 1, v7
    v_cmp_le_i32 s[36:37], 2, v7
    v_cmp_le_i32 s[38:39], 3, v7
    v_cmp_le_i32 s[40:41], 8, v7
    v_cmp_le_i32 s[42:43], 9, v7
    v_cmp_le_i32 s[44:45], 10, v7
    v_cmp_le_i32 s[46:47], 11, v7
    v_cmp_le_i32 s[48:49], 16, v7
    v_cmp_le_i32 s[50:51], 17, v7
    v_cmp_le_i32 s[52:53], 18, v7
    v_cmp_le_i32 s[54:55], 19, v7
    v_cmp_le_i32 s[56:57], 24, v7
    v_cmp_le_i32 s[58:59], 25, v7
    v_cmp_le_i32 s[60:61], 26, v7
    v_cmp_le_i32 s[62:63], 27, v7
    v_mov_b32 v108, 0xffff
    v_mov_b32 v109, 0xffff0000
    v_cndmask_b32 v8, 0, v108, s[32:33]
    v_cndmask_b32 v110, 0, v109, s[34:35]
    v_or_b32 v8, v8, v110
    v_cndmask_b32 v9, 0, v108, s[36:37]
    v_cndmask_b32 v110, 0, v109, s[38:39]
    v_or_b32 v9, v9, v110
    v_cndmask_b32 v10, 0, v108, s[40:41]
    v_cndmask_b32 v110, 0, v109, s[42:43]
    v_or_b32 v10, v10, v110
    v_cndmask_b32 v11, 0, v108, s[44:45]
    v_cndmask_b32 v110, 0, v109, s[46:47]
    v_or_b32 v11, v11, v110
    v_cndmask_b32 v12, 0, v108, s[48:49]
    v_cndmask_b32 v110, 0, v109, s[50:51]
    v_or_b32 v12, v12, v110
    v_cndmask_b32 v13, 0, v108, s[52:53]
    v_cndmask_b32 v110, 0, v109, s[54:55]
    v_or_b32 v13, v13, v110
    v_cndmask_b32 v14, 0, v108, s[56:57]
    v_cndmask_b32 v110, 0, v109, s[58:59]
    v_or_b32 v14, v14, v110
    v_cndmask_b32 v15, 0, v108, s[60:61]
    v_cndmask_b32 v110, 0, v109, s[62:63]
    v_or_b32 v15, v15, v110
    s_cmp_lg_u32 s12, 0
    s_cbranch_scc1 k2_deps
    v_min_u32 v105, 6, v0
    v_add_u32 v106, 2, v105
    v_mul_u32_u24 v107, 86, v106
    v_lshrrev_b32 v107, 8, v107
    v_mul_u32_u24 v108, 3, v107
    v_sub_u32 v106, v106, v108
    s_lshr_b32 s21, s17, 2
    v_add_u32 v106, s21, v106
    v_max_u32 v106, 2, v106
    v_subrev_u32 v106, 2, v106
    v_mul_u32_u24 v106, 12, v106
    v_lshl_add_u32 v106, v107, 2, v106
    s_lshr_b32 s21, s16, 2
    v_add_u32 v106, s21, v106
    v_lshlrev_b32 v106, 7, v106
    v_mov_b32 v107, 128
    s_mov_b32 s21, 29351936
    s_mov_b32 s22, 0x20000
k2_rpoll:
    global_load_dword v105, v107, s[100:101] sc1
    s_sub_u32 s22, s22, 1
    s_waitcnt vmcnt(0)
    v_cmp_gt_u32 vcc, 64, v105
    s_cmp_eq_u32 s22, 0
    s_cbranch_scc1 k2_dpoll
    s_cmp_lg_u64 vcc, 0
    s_cbranch_scc1 k2_rpoll
k2_dpoll:
    buffer_load_dword v105, v106, s[8:11], s21 offen sc1
    s_sub_u32 s22, s22, 1
    s_waitcnt vmcnt(0)
    v_cmp_eq_u32 vcc, 0, v105
    s_cmp_lt_i32 s22, 1
    s_cbranch_scc1 k2_deps
    s_cmp_eq_u64 vcc, 0
    s_cbranch_scc1 k2_deps
    s_sleep 2
    s_branch k2_dpoll
k2_deps:
    s_barrier
    s_mov_b32 m0, s95
    s_mul_i32 s21, s19, 3
    s_add_u32 s21, s21, s17
    s_cmp_ge_u32 s21, 8
    s_cselect_b32 s22, s94, 0x40000000
    buffer_load_dwordx4 v1, s[8:11], s22 offen offset:0 lds
    s_cmp_ge_u32 s21, 7
    s_cselect_b32 s22, s94, 0x40000000
    buffer_load_dwordx4 v1, s[8:11], s22 offen offset:1024 lds
    s_cmp_ge_u32 s21, 6
    s_cselect_b32 s22, s94, 0x40000000
    buffer_load_dwordx4 v1, s[8:11], s22 offen offset:2048 lds
    s_cmp_ge_u32 s12, 3
    s_cbranch_scc1 k2_notail
    s_lshl_b32 s21, s12, 2
    s_add_u32 s21, s21, s17
    s_cmp_ge_u32 s21, 8
    s_cselect_b32 s28, s28, 0x40000000
    s_add_u32 m0, s27, 24576
    s_nop 0
    buffer_load_dwordx4 v1, s[8:11], s28 offen lds
k2_notail:
    s_add_u32 s21, s20, s19
    s_lshl_b32 s21, s21, 10
    s_add_u32 s21, s21, 2359296
    buffer_load_dwordx4 v[64:67], v1, s[8:11], s21 offen
    s_lshl_b32 s27, s19, 8
    s_add_u32 s26, s26, s27
    s_add_u32 s26, s26, 8912896
    v_mov_b32 v68, 0
    v_mov_b32 v69, 0
    v_mov_b32 v70, 0
    v_mov_b32 v71, 0
    v_mov_b32 v72, 0
    v_mov_b32 v73, 0
    v_mov_b32 v74, 0
    v_mov_b32 v75, 0
    buffer_load_dword v68, v104, s[8:11], s26 offen
    s_waitcnt vmcnt(0)
    s_barrier
    s_cmp_lt_u32 s12, 3
    s_cselect_b32 s24, s24, 0x40000000
    buffer_load_dwordx4 v[84:87], v89, s[8:11], s24 offen
    s_mul_i32 s21, s19, 3
    s_add_u32 s21, s21, s17
    s_cmp_ge_u32 s21, 8
    s_cselect_b32 s22, s23, 0x40000000
    s_add_u32 m0, s25, 0
    s_nop 0
    buffer_load_dwordx4 v1, s[8:11], s22 offen offset:0 lds
    s_cmp_ge_u32 s21, 7
    s_cselect_b32 s22, s23, 0x40000000
    s_add_u32 m0, s25, 256
    s_nop 0
    buffer_load_dwordx4 v1, s[8:11], s22 offen offset:1024 lds
    s_cmp_ge_u32 s21, 6
    s_cselect_b32 s22, s23, 0x40000000
    s_add_u32 m0, s25, 512
    s_nop 0
    buffer_load_dwordx4 v1, s[8:11], s22 offen offset:2048 lds
    ds_read_b32 v52, v2 offset:0
    ds_read_b32 v53, v2 offset:256
    ds_read_b32 v54, v2 offset:512
    ds_read_b32 v55, v2 offset:768
    ds_read_b32 v56, v2 offset:1024
    ds_read_b32 v57, v2 offset:1280
    ds_read_b32 v58, v2 offset:1536
    ds_read_b32 v59, v2 offset:1792
    ds_read_b32 v60, v2 offset:2048
    ds_read_b128 v[16:19], v4 offset:0
    ds_read_b128 v[20:23], v4 offset:1024
    ds_read_b128 v[24:27], v4 offset:2048
    ds_read_b128 v[28:31], v4 offset:3072
    ds_read_b128 v[32:35], v4 offset:4096
    ds_read_b128 v[36:39], v4 offset:5120
    ds_read_b128 v[40:43], v4 offset:6144
    ds_read_b128 v[44:47], v4 offset:7168
    ds_read_b128 v[48:51], v4 offset:8192
    v_mov_b32 v73, v68
    s_lshl_b32 s26, s2, 3
    s_add_u32 s26, s26, s12
    s_mul_i32 s26, s26, 4096
    s_add_u32 s26, s26, 6291456
    s_cmp_ge_u32 s26, 18874368
    s_cselect_b32 s28, s98, s6
    s_cselect_b32 s29, s99, s7
    s_cselect_b32 s27, 18874368, 0
    s_sub_u32 s26, s26, s27
    s_and_b32 s29, s29, 0xffff
    s_mov_b32 s30, 0x1200000
    s_mov_b32 s31, 0x20000
    v_mov_b32 v6, v103
    v_mov_b32 v2, v76
    v_mov_b32 v4, v77
    v_mov_b32 v5, v78
    s_waitcnt lgkmcnt(8)
    v_mfma_f32_32x32x16_bf16 v[112:127], v[16:19], v[64:67], 0
    v_mfma_f32_32x32x16_bf16 v[112:127], v[52:55], v[68:71], v[112:127]
    s_add_u32 s92, s90, 0
    s_add_u32 m0, s91, 66560
    s_nop 0
    buffer_load_dwordx4 v79, s[76:79], s92 offen lds
    s_waitcnt lgkmcnt(7)
    v_mfma_f32_32x32x16_bf16 v[128:143], v[20:23], v[64:67], 0
    v_mfma_f32_32x32x16_bf16 v[128:143], v[52:55], v[72:75], v[128:143]
    s_add_u32 s92, s90, 0
    s_add_u32 m0, s91, 74752
    s_nop 0
    buffer_load_dwordx4 v80, s[76:79], s92 offen lds
    s_waitcnt lgkmcnt(6)
    v_mfma_f32_32x32x16_bf16 v[144:159], v[24:27], v[64:67], 0
    v_mfma_f32_32x32x16_bf16 v[144:159], v[54:57], v[68:71], v[144:159]
    s_add_u32 s92, s90, 0
    s_add_u32 s3, s91, 82944
    s_cmp_lt_u32 s12, 3
    s_cselect_b32 m0, s3, 58368
    s_nop 0
    buffer_load_dwordx4 v81, s[76:79], s92 offen lds
    s_waitcnt lgkmcnt(5)
    v_mfma_f32_32x32x16_bf16 v[160:175], v[28:31], v[64:67], 0
    v_mfma_f32_32x32x16_bf16 v[160:175], v[54:57], v[72:75], v[160:175]
    s_add_u32 s92, s90, 0
    s_add_u32 m0, s91, 86016
    s_nop 0
    buffer_load_dwordx4 v2, s[76:79], s92 offen lds
    s_waitcnt lgkmcnt(4)
    v_mfma_f32_32x32x16_bf16 v[176:191], v[32:35], v[64:67], 0
    v_mfma_f32_32x32x16_bf16 v[176:191], v[56:59], v[68:71], v[176:191]
    s_add_u32 s92, s90, 0
    s_add_u32 m0, s91, 94208
    s_nop 0
    buffer_load_dwordx4 v4, s[76:79], s92 offen lds
    s_waitcnt lgkmcnt(3)
    v_mfma_f32_32x32x16_bf16 v[192:207], v[36:39], v[64:67], 0
    v_mfma_f32_32x32x16_bf16 v[192:207], v[56:59], v[72:75], v[192:207]
    s_add_u32 s92, s90, 0
    s_add_u32 s3, s91, 102400
    s_cmp_lt_u32 s12, 3
    s_cselect_b32 m0, s3, 58368
    s_nop 0
    buffer_load_dwordx4 v5, s[76:79], s92 offen lds
    s_waitcnt lgkmcnt(2)
    v_mfma_f32_32x32x16_bf16 v[208:223], v[40:43], v[64:67], 0
    v_mfma_f32_32x32x16_bf16 v[208:223], v[58:61], v[68:71], v[208:223]
    s_add_u32 s92, s90, 82944
    s_add_u32 m0, s91, 105472
    s_nop 0
    buffer_load_dwordx4 v2, s[76:79], s92 offen lds
    s_waitcnt lgkmcnt(1)
    v_mfma_f32_32x32x16_bf16 v[224:239], v[44:47], v[64:67], 0
    v_mfma_f32_32x32x16_bf16 v[224:239], v[58:61], v[72:75], v[224:239]
    s_add_u32 s92, s90, 82944
    s_add_u32 m0, s91, 113664
    s_nop 0
    buffer_load_dwordx4 v4, s[76:79], s92 offen lds
    s_waitcnt lgkmcnt(0)
    v_mfma_f32_32x32x16_bf16 v[240:255], v[48:51], v[64:67], 0
    v_mfma_f32_32x32x16_bf16 v[240:255], v[60:63], v[68:71], v[240:255]
    s_add_u32 s92, s90, 82944
    s_add_u32 s3, s91, 121856
    s_cmp_lt_u32 s12, 3
    s_cselect_b32 m0, s3, 58368
    s_nop 0
    buffer_load_dwordx4 v5, s[76:79], s92 offen lds
    s_waitcnt vmcnt(9)
    s_cmp_ge_u32 s12, 3
    s_cbranch_scc1 k2_novt
    ds_write_b128 v88, v[84:87]
k2_novt:
    s_waitcnt lgkmcnt(0)
    s_barrier
    ds_read_b128 v[76:79], v3 offset:0
    ds_read_b128 v[80:83], v6 offset:0
    ds_read_b128 v[84:87], v3 offset:10240
    ds_read_b128 v[88:91], v6 offset:10240
    ds_read_b128 v[92:95], v3 offset:8960
    ds_read_b128 v[96:99], v6 offset:8960
    ds_read_b128 v[100:103], v3 offset:7680
    ds_read_b128 v[104:107], v6 offset:7680
    s_cmp_ge_u32 s14, 8
    s_cbranch_scc1 k2_allvalid
    s_nop 7
    s_cmp_ge_u32 s14, 8
    s_cbranch_scc1 k2_filled
    v_mov_b32 v112, 0xff800000
    v_mov_b32 v113, 0xff800000
    v_mov_b32 v114, 0xff800000
    v_mov_b32 v115, 0xff800000
    v_mov_b32 v116, 0xff800000
    v_mov_b32 v117, 0xff800000
    v_mov_b32 v118, 0xff800000
    v_mov_b32 v119, 0xff800000
    v_mov_b32 v120, 0xff800000
    v_mov_b32 v121, 0xff800000
    v_mov_b32 v122, 0xff800000
    v_mov_b32 v123, 0xff800000
    v_mov_b32 v124, 0xff800000
    v_mov_b32 v125, 0xff800000
    v_mov_b32 v126, 0xff800000
    v_mov_b32 v127, 0xff800000
    s_cmp_ge_u32 s14, 7
    s_cbranch_scc1 k2_filled
    v_mov_b32 v128, 0xff800000
    v_mov_b32 v129, 0xff800000
    v_mov_b32 v130, 0xff800000
    v_mov_b32 v131, 0xff800000
    v_mov_b32 v132, 0xff800000
    v_mov_b32 v133, 0xff800000
    v_mov_b32 v134, 0xff800000
    v_mov_b32 v135, 0xff800000
    v_mov_b32 v136, 0xff800000
    v_mov_b32 v137, 0xff800000
    v_mov_b32 v138, 0xff800000
    v_mov_b32 v139, 0xff800000
    v_mov_b32 v140, 0xff800000
    v_mov_b32 v141, 0xff800000
    v_mov_b32 v142, 0xff800000
    v_mov_b32 v143, 0xff800000
    s_cmp_ge_u32 s14, 6
    s_cbranch_scc1 k2_filled
    v_mov_b32 v144, 0xff800000
    v_mov_b32 v145, 0xff800000
    v_mov_b32 v146, 0xff800000
    v_mov_b32 v147, 0xff800000
    v_mov_b32 v148, 0xff800000
    v_mov_b32 v149, 0xff800000
    v_mov_b32 v150, 0xff800000
    v_mov_b32 v151, 0xff800000
    v_mov_b32 v152, 0xff800000
    v_mov_b32 v153, 0xff800000
    v_mov_b32 v154, 0xff800000
    v_mov_b32 v155, 0xff800000
    v_mov_b32 v156, 0xff800000
    v_mov_b32 v157, 0xff800000
    v_mov_b32 v158, 0xff800000
    v_mov_b32 v159, 0xff800000
    s_cmp_ge_u32 s14, 5
    s_cbranch_scc1 k2_filled
    v_mov_b32 v160, 0xff800000
    v_mov_b32 v161, 0xff800000
    v_mov_b32 v162, 0xff800000
    v_mov_b32 v163, 0xff800000
    v_mov_b32 v164, 0xff800000
    v_mov_b32 v165, 0xff800000
    v_mov_b32 v166, 0xff800000
    v_mov_b32 v167, 0xff800000
    v_mov_b32 v168, 0xff800000
    v_mov_b32 v169, 0xff800000
    v_mov_b32 v170, 0xff800000
    v_mov_b32 v171, 0xff800000
    v_mov_b32 v172, 0xff800000
    v_mov_b32 v173, 0xff800000
    v_mov_b32 v174, 0xff800000
    v_mov_b32 v175, 0xff800000
    s_cmp_ge_u32 s14, 4
    s_cbranch_scc1 k2_filled
    v_mov_b32 v176, 0xff800000
    v_mov_b32 v177, 0xff800000
    v_mov_b32 v178, 0xff800000
    v_mov_b32 v179, 0xff800000
    v_mov_b32 v180, 0xff800000
    v_mov_b32 v181, 0xff800000
    v_mov_b32 v182, 0xff800000
    v_mov_b32 v183, 0xff800000
    v_mov_b32 v184, 0xff800000
    v_mov_b32 v185, 0xff800000
    v_mov_b32 v186, 0xff800000
    v_mov_b32 v187, 0xff800000
    v_mov_b32 v188, 0xff800000
    v_mov_b32 v189, 0xff800000
    v_mov_b32 v190, 0xff800000
    v_mov_b32 v191, 0xff800000
    s_cmp_ge_u32 s14, 3
    s_cbranch_scc1 k2_filled
    v_mov_b32 v192, 0xff800000
    v_mov_b32 v193, 0xff800000
    v_mov_b32 v194, 0xff800000
    v_mov_b32 v195, 0xff800000
    v_mov_b32 v196, 0xff800000
    v_mov_b32 v197, 0xff800000
    v_mov_b32 v198, 0xff800000
    v_mov_b32 v199, 0xff800000
    v_mov_b32 v200, 0xff800000
    v_mov_b32 v201, 0xff800000
    v_mov_b32 v202, 0xff800000
    v_mov_b32 v203, 0xff800000
    v_mov_b32 v204, 0xff800000
    v_mov_b32 v205, 0xff800000
    v_mov_b32 v206, 0xff800000
    v_mov_b32 v207, 0xff800000
    s_cmp_ge_u32 s14, 2
    s_cbranch_scc1 k2_filled
    v_mov_b32 v208, 0xff800000
    v_mov_b32 v209, 0xff800000
    v_mov_b32 v210, 0xff800000
    v_mov_b32 v211, 0xff800000
    v_mov_b32 v212, 0xff800000
    v_mov_b32 v213, 0xff800000
    v_mov_b32 v214, 0xff800000
    v_mov_b32 v215, 0xff800000
    v_mov_b32 v216, 0xff800000
    v_mov_b32 v217, 0xff800000
    v_mov_b32 v218, 0xff800000
    v_mov_b32 v219, 0xff800000
    v_mov_b32 v220, 0xff800000
    v_mov_b32 v221, 0xff800000
    v_mov_b32 v222, 0xff800000
    v_mov_b32 v223, 0xff800000
    s_cmp_ge_u32 s14, 1
    s_cbranch_scc1 k2_filled
    v_mov_b32 v224, 0xff800000
    v_mov_b32 v225, 0xff800000
    v_mov_b32 v226, 0xff800000
    v_mov_b32 v227, 0xff800000
    v_mov_b32 v228, 0xff800000
    v_mov_b32 v229, 0xff800000
    v_mov_b32 v230, 0xff800000
    v_mov_b32 v231, 0xff800000
    v_mov_b32 v232, 0xff800000
    v_mov_b32 v233, 0xff800000
    v_mov_b32 v234, 0xff800000
    v_mov_b32 v235, 0xff800000
    v_mov_b32 v236, 0xff800000
    v_mov_b32 v237, 0xff800000
    v_mov_b32 v238, 0xff800000
    v_mov_b32 v239, 0xff800000
k2_filled:
k2_allvalid:
    v_max_f32 v108, v128, v129
    v_max_f32 v109, v130, v131
    v_max_f32 v110, v132, v133
    v_max_f32 v111, v134, v135
    v_max3_f32 v108, v108, v136, v137
    v_max3_f32 v109, v109, v138, v139
    v_max3_f32 v110, v110, v140, v141
    v_max3_f32 v111, v111, v142, v143
    s_add_u32 s92, s90, 165888
    s_add_u32 m0, s91, 124928
    s_nop 0
    buffer_load_dwordx4 v2, s[76:79], s92 offen lds
    v_max3_f32 v108, v108, v144, v145
    v_max3_f32 v109, v109, v146, v147
    v_max3_f32 v110, v110, v148, v149
    v_max3_f32 v111, v111, v150, v151
    v_max3_f32 v108, v108, v152, v153
    v_max3_f32 v109, v109, v154, v155
    v_max3_f32 v110, v110, v156, v157
    v_max3_f32 v111, v111, v158, v159
    s_add_u32 s92, s90, 165888
    s_add_u32 m0, s91, 133120
    s_nop 0
    buffer_load_dwordx4 v4, s[76:79], s92 offen lds
    v_max3_f32 v108, v108, v160, v161
    v_max3_f32 v109, v109, v162, v163
    v_max3_f32 v110, v110, v164, v165
    v_max3_f32 v111, v111, v166, v167
    v_max3_f32 v108, v108, v168, v169
    v_max3_f32 v109, v109, v170, v171
    v_max3_f32 v110, v110, v172, v173
    v_max3_f32 v111, v111, v174, v175
    s_add_u32 s92, s90, 165888
    s_add_u32 s3, s91, 141312
    s_cmp_lt_u32 s12, 3
    s_cselect_b32 m0, s3, 58368
    s_nop 0
    buffer_load_dwordx4 v5, s[76:79], s92 offen lds
    v_max3_f32 v108, v108, v176, v177
    v_max3_f32 v109, v109, v178, v179
    v_max3_f32 v110, v110, v180, v181
    v_max3_f32 v111, v111, v182, v183
    v_max3_f32 v108, v108, v184, v185
    v_max3_f32 v109, v109, v186, v187
    v_max3_f32 v110, v110, v188, v189
    v_max3_f32 v111, v111, v190, v191
    s_add_u32 s92, s90, 248832
    s_add_u32 m0, s91, 144384
    s_nop 0
    buffer_load_dwordx4 v2, s[76:79], s92 offen lds
    v_max3_f32 v108, v108, v192, v193
    v_max3_f32 v109, v109, v194, v195
    v_max3_f32 v110, v110, v196, v197
    v_max3_f32 v111, v111, v198, v199
    v_max3_f32 v108, v108, v200, v201
    v_max3_f32 v109, v109, v202, v203
    v_max3_f32 v110, v110, v204, v205
    v_max3_f32 v111, v111, v206, v207
    s_add_u32 s92, s90, 248832
    s_add_u32 m0, s91, 152576
    s_nop 0
    buffer_load_dwordx4 v4, s[76:79], s92 offen lds
    v_max3_f32 v108, v108, v208, v209
    v_max3_f32 v109, v109, v210, v211
    v_max3_f32 v110, v110, v212, v213
    v_max3_f32 v111, v111, v214, v215
    v_max3_f32 v108, v108, v216, v217
    v_max3_f32 v109, v109, v218, v219
    v_max3_f32 v110, v110, v220, v221
    v_max3_f32 v111, v111, v222, v223
    s_add_u32 s92, s90, 248832
    s_add_u32 s3, s91, 160768
    s_cmp_lt_u32 s12, 3
    s_cselect_b32 m0, s3, 58368
    s_nop 0
    buffer_load_dwordx4 v5, s[76:79], s92 offen lds
    v_max3_f32 v108, v108, v224, v225
    v_max3_f32 v109, v109, v226, v227
    v_max3_f32 v110, v110, v228, v229
    v_max3_f32 v111, v111, v230, v231
    v_max3_f32 v108, v108, v232, v233
    v_max3_f32 v109, v109, v234, v235
    v_max3_f32 v110, v110, v236, v237
    v_max3_f32 v111, v111, v238, v239
    s_add_u32 s92, s90, 331776
    s_add_u32 m0, s91, 0
    s_nop 0
    buffer_load_dwordx4 v2, s[76:79], s92 offen lds
    ds_read_b128 v[176:179], v3 offset:6400
    ds_read_b128 v[180:183], v6 offset:6400
    ds_read_b128 v[184:187], v3 offset:5120
    ds_read_b128 v[188:191], v6 offset:5120
    ds_read_b128 v[192:195], v3 offset:3840
    ds_read_b128 v[196:199], v6 offset:3840
    ds_read_b128 v[200:203], v3 offset:2560
    ds_read_b128 v[204:207], v6 offset:2560
    ds_read_b128 v[208:211], v3 offset:1280
    ds_read_b128 v[212:215], v6 offset:1280
    v_cndmask_b32 v112, v112, v240, s[32:33]
    v_cndmask_b32 v113, v113, v241, s[34:35]
    v_cndmask_b32 v114, v114, v242, s[36:37]
    v_cndmask_b32 v115, v115, v243, s[38:39]
    v_cndmask_b32 v116, v116, v244, s[40:41]
    v_cndmask_b32 v117, v117, v245, s[42:43]
    v_cndmask_b32 v118, v118, v246, s[44:45]
    v_cndmask_b32 v119, v119, v247, s[46:47]
    v_cndmask_b32 v120, v120, v248, s[48:49]
    v_cndmask_b32 v121, v121, v249, s[50:51]
    v_cndmask_b32 v122, v122, v250, s[52:53]
    v_cndmask_b32 v123, v123, v251, s[54:55]
    v_cndmask_b32 v124, v124, v252, s[56:57]
    v_cndmask_b32 v125, v125, v253, s[58:59]
    v_cndmask_b32 v126, v126, v254, s[60:61]
    v_cndmask_b32 v127, v127, v255, s[62:63]
    v_max3_f32 v108, v108, v112, v113
    v_max3_f32 v109, v109, v114, v115
    v_max3_f32 v110, v110, v116, v117
    v_max3_f32 v111, v111, v118, v119
    v_max3_f32 v108, v108, v120, v121
    v_max3_f32 v109, v109, v122, v123
    v_max3_f32 v110, v110, v124, v125
    v_max3_f32 v111, v111, v126, v127
    v_max3_f32 v108, v108, v109, v110
    v_max_f32 v108, v108, v111
    v_mov_b32 v109, v108
    s_nop 1
    v_permlane32_swap_b32 v108, v109
    v_max_f32 v108, v108, v109
    v_sub_f32 v160, 0, v108
    v_sub_f32 v161, 0, v108
    v_sub_f32 v162, 0, v108
    v_sub_f32 v163, 0, v108
    v_sub_f32 v164, 0, v108
    v_sub_f32 v165, 0, v108
    v_sub_f32 v166, 0, v108
    v_sub_f32 v167, 0, v108
    v_sub_f32 v168, 0, v108
    v_sub_f32 v169, 0, v108
    v_sub_f32 v170, 0, v108
    v_sub_f32 v171, 0, v108
    v_sub_f32 v172, 0, v108
    v_sub_f32 v173, 0, v108
    v_sub_f32 v174, 0, v108
    v_sub_f32 v175, 0, v108
    s_nop 1
    v_mfma_f32_32x32x16_bf16 v[128:143], v[44:47], v[64:67], v[160:175]
    v_mfma_f32_32x32x16_bf16 v[128:143], v[58:61], v[72:75], v[128:143]
    v_sub_f32 v112, v112, v108
    v_sub_f32 v113, v113, v108
    v_sub_f32 v114, v114, v108
    v_sub_f32 v115, v115, v108
    v_sub_f32 v116, v116, v108
    v_sub_f32 v117, v117, v108
    v_sub_f32 v118, v118, v108
    v_sub_f32 v119, v119, v108
    v_sub_f32 v120, v120, v108
    v_sub_f32 v121, v121, v108
    v_sub_f32 v122, v122, v108
    v_sub_f32 v123, v123, v108
    v_sub_f32 v124, v124, v108
    v_sub_f32 v125, v125, v108
    v_sub_f32 v126, v126, v108
    v_sub_f32 v127, v127, v108
    s_add_u32 s92, s90, 331776
    s_add_u32 m0, s91, 8192
    s_nop 0
    buffer_load_dwordx4 v4, s[76:79], s92 offen lds
    v_exp_f32 v112, v112
    v_exp_f32 v113, v113
    v_exp_f32 v114, v114
    v_exp_f32 v115, v115
    v_exp_f32 v116, v116
    v_exp_f32 v117, v117
    v_exp_f32 v118, v118
    v_exp_f32 v119, v119
    v_exp_f32 v120, v120
    v_exp_f32 v121, v121
    v_exp_f32 v122, v122
    v_exp_f32 v123, v123
    v_exp_f32 v124, v124
    v_exp_f32 v125, v125
    v_exp_f32 v126, v126
    v_exp_f32 v127, v127
    s_add_u32 s92, s90, 331776
    s_add_u32 s3, s91, 16384
    s_cmp_lt_u32 s12, 3
    s_cselect_b32 m0, s3, 19456
    s_nop 0
    buffer_load_dwordx4 v5, s[76:79], s92 offen lds
    v_cvt_pk_bf16_f32 v112, v112, v113
    v_cvt_pk_bf16_f32 v113, v114, v115
    v_cvt_pk_bf16_f32 v114, v116, v117
    v_cvt_pk_bf16_f32 v115, v118, v119
    v_cvt_pk_bf16_f32 v116, v120, v121
    v_cvt_pk_bf16_f32 v117, v122, v123
    v_cvt_pk_bf16_f32 v118, v124, v125
    v_cvt_pk_bf16_f32 v119, v126, v127
    v_and_b32 v120, v112, v8
    v_and_b32 v121, v113, v9
    v_and_b32 v122, v114, v10
    v_and_b32 v123, v115, v11
    v_and_b32 v124, v116, v12
    v_and_b32 v125, v117, v13
    v_and_b32 v126, v118, v14
    v_and_b32 v127, v119, v15
    v_xor_b32 v112, v112, v120
    v_xor_b32 v113, v113, v121
    v_xor_b32 v114, v114, v122
    v_xor_b32 v115, v115, v123
    v_xor_b32 v116, v116, v124
    v_xor_b32 v117, v117, v125
    v_xor_b32 v118, v118, v126
    v_xor_b32 v119, v119, v127
    s_waitcnt lgkmcnt(15)
    v_mfma_f32_32x32x16_bf16 v[240:255], v[76:79], v[112:115], 0
    v_mfma_f32_32x32x16_bf16 v[240:255], v[80:83], v[116:119], v[240:255]
    v_mfma_f32_32x32x16_bf16 v[240:255], v[84:87], v[120:123], v[240:255]
    s_waitcnt lgkmcnt(14)
    v_mfma_f32_32x32x16_bf16 v[240:255], v[88:91], v[124:127], v[240:255]
    s_waitcnt lgkmcnt(0)
    s_waitcnt vmcnt(9)
    s_barrier
    v_mfma_f32_32x32x16_bf16 v[144:159], v[40:43], v[64:67], v[160:175]
    v_mfma_f32_32x32x16_bf16 v[144:159], v[58:61], v[68:71], v[144:159]
    s_cmp_ge_u32 s14, 1
    s_cbranch_scc1 k2_pv7
    v_mov_b32 v128, 0xff800000
    v_mov_b32 v129, 0xff800000
    v_mov_b32 v130, 0xff800000
    v_mov_b32 v131, 0xff800000
    v_mov_b32 v132, 0xff800000
    v_mov_b32 v133, 0xff800000
    v_mov_b32 v134, 0xff800000
    v_mov_b32 v135, 0xff800000
    v_mov_b32 v136, 0xff800000
    v_mov_b32 v137, 0xff800000
    v_mov_b32 v138, 0xff800000
    v_mov_b32 v139, 0xff800000
    v_mov_b32 v140, 0xff800000
    v_mov_b32 v141, 0xff800000
    v_mov_b32 v142, 0xff800000
    v_mov_b32 v143, 0xff800000
k2_pv7:
    v_exp_f32 v128, v128
    v_exp_f32 v129, v129
    v_exp_f32 v130, v130
    v_exp_f32 v131, v131
    v_exp_f32 v132, v132
    v_exp_f32 v133, v133
    v_exp_f32 v134, v134
    v_exp_f32 v135, v135
    s_add_u32 s92, s90, 414720
    s_add_u32 m0, s91, 27648
    s_nop 0
    buffer_load_dwordx4 v2, s[76:79], s92 offen lds
    v_exp_f32 v136, v136
    v_exp_f32 v137, v137
    v_exp_f32 v138, v138
    v_exp_f32 v139, v139
    v_exp_f32 v140, v140
    v_exp_f32 v141, v141
    v_exp_f32 v142, v142
    v_exp_f32 v143, v143
    s_add_u32 s92, s90, 414720
    s_add_u32 m0, s91, 35840
    s_nop 0
    buffer_load_dwordx4 v4, s[76:79], s92 offen lds
    v_cvt_pk_bf16_f32 v128, v128, v129
    v_cvt_pk_bf16_f32 v129, v130, v131
    v_cvt_pk_bf16_f32 v130, v132, v133
    v_cvt_pk_bf16_f32 v131, v134, v135
    v_cvt_pk_bf16_f32 v132, v136, v137
    v_cvt_pk_bf16_f32 v133, v138, v139
    v_cvt_pk_bf16_f32 v134, v140, v141
    v_cvt_pk_bf16_f32 v135, v142, v143
    v_mfma_f32_32x32x16_bf16 v[240:255], v[92:95], v[128:131], v[240:255]
    s_nop 0
    v_mfma_f32_32x32x16_bf16 v[240:255], v[96:99], v[132:135], v[240:255]
    v_mfma_f32_32x32x16_bf16 v[128:143], v[36:39], v[64:67], v[160:175]
    v_mfma_f32_32x32x16_bf16 v[128:143], v[56:59], v[72:75], v[128:143]
    s_cmp_ge_u32 s14, 2
    s_cbranch_scc1 k2_pv6
    v_mov_b32 v144, 0xff800000
    v_mov_b32 v145, 0xff800000
    v_mov_b32 v146, 0xff800000
    v_mov_b32 v147, 0xff800000
    v_mov_b32 v148, 0xff800000
    v_mov_b32 v149, 0xff800000
    v_mov_b32 v150, 0xff800000
    v_mov_b32 v151, 0xff800000
    v_mov_b32 v152, 0xff800000
    v_mov_b32 v153, 0xff800000
    v_mov_b32 v154, 0xff800000
    v_mov_b32 v155, 0xff800000
    v_mov_b32 v156, 0xff800000
    v_mov_b32 v157, 0xff800000
    v_mov_b32 v158, 0xff800000
    v_mov_b32 v159, 0xff800000
k2_pv6:
    v_exp_f32 v144, v144
    v_exp_f32 v145, v145
    v_exp_f32 v146, v146
    v_exp_f32 v147, v147
    v_exp_f32 v148, v148
    v_exp_f32 v149, v149
    v_exp_f32 v150, v150
    v_exp_f32 v151, v151
    s_add_u32 s92, s90, 414720
    s_add_u32 s3, s91, 44032
    s_cmp_lt_u32 s12, 3
    s_cselect_b32 m0, s3, 19456
    s_nop 0
    buffer_load_dwordx4 v5, s[76:79], s92 offen lds
    v_exp_f32 v152, v152
    v_exp_f32 v153, v153
    v_exp_f32 v154, v154
    v_exp_f32 v155, v155
    v_exp_f32 v156, v156
    v_exp_f32 v157, v157
    v_exp_f32 v158, v158
    v_exp_f32 v159, v159
    s_add_u32 s92, s90, 497664
    s_add_u32 m0, s91, 47104
    s_nop 0
    buffer_load_dwordx4 v2, s[76:79], s92 offen lds
    v_cvt_pk_bf16_f32 v144, v144, v145
    v_cvt_pk_bf16_f32 v145, v146, v147
    v_cvt_pk_bf16_f32 v146, v148, v149
    v_cvt_pk_bf16_f32 v147, v150, v151
    v_cvt_pk_bf16_f32 v148, v152, v153
    v_cvt_pk_bf16_f32 v149, v154, v155
    v_cvt_pk_bf16_f32 v150, v156, v157
    v_cvt_pk_bf16_f32 v151, v158, v159
    v_mfma_f32_32x32x16_bf16 v[240:255], v[100:103], v[144:147], v[240:255]
    s_nop 0
    v_mfma_f32_32x32x16_bf16 v[240:255], v[104:107], v[148:151], v[240:255]
    v_mfma_f32_32x32x16_bf16 v[144:159], v[32:35], v[64:67], v[160:175]
    v_mfma_f32_32x32x16_bf16 v[144:159], v[56:59], v[68:71], v[144:159]
    s_cmp_ge_u32 s14, 3
    s_cbranch_scc1 k2_pv5
    v_mov_b32 v128, 0xff800000
    v_mov_b32 v129, 0xff800000
    v_mov_b32 v130, 0xff800000
    v_mov_b32 v131, 0xff800000
    v_mov_b32 v132, 0xff800000
    v_mov_b32 v133, 0xff800000
    v_mov_b32 v134, 0xff800000
    v_mov_b32 v135, 0xff800000
    v_mov_b32 v136, 0xff800000
    v_mov_b32 v137, 0xff800000
    v_mov_b32 v138, 0xff800000
    v_mov_b32 v139, 0xff800000
    v_mov_b32 v140, 0xff800000
    v_mov_b32 v141, 0xff800000
    v_mov_b32 v142, 0xff800000
    v_mov_b32 v143, 0xff800000
k2_pv5:
    v_exp_f32 v128, v128
    v_exp_f32 v129, v129
    v_exp_f32 v130, v130
    v_exp_f32 v131, v131
    v_exp_f32 v132, v132
    v_exp_f32 v133, v133
    v_exp_f32 v134, v134
    v_exp_f32 v135, v135
    s_add_u32 s92, s90, 497664
    s_add_u32 m0, s91, 55296
    s_nop 0
    buffer_load_dwordx4 v4, s[76:79], s92 offen lds
    v_exp_f32 v136, v136
    v_exp_f32 v137, v137
    v_exp_f32 v138, v138
    v_exp_f32 v139, v139
    v_exp_f32 v140, v140
    v_exp_f32 v141, v141
    v_exp_f32 v142, v142
    v_exp_f32 v143, v143
    s_add_u32 s92, s90, 497664
    s_add_u32 s3, s91, 63488
    s_cmp_lt_u32 s12, 3
    s_cselect_b32 m0, s3, 19456
    s_nop 0
    buffer_load_dwordx4 v5, s[76:79], s92 offen lds
    v_cvt_pk_bf16_f32 v128, v128, v129
    v_cvt_pk_bf16_f32 v129, v130, v131
    v_cvt_pk_bf16_f32 v130, v132, v133
    v_cvt_pk_bf16_f32 v131, v134, v135
    v_cvt_pk_bf16_f32 v132, v136, v137
    v_cvt_pk_bf16_f32 v133, v138, v139
    v_cvt_pk_bf16_f32 v134, v140, v141
    v_cvt_pk_bf16_f32 v135, v142, v143
    v_mfma_f32_32x32x16_bf16 v[240:255], v[176:179], v[128:131], v[240:255]
    s_nop 0
    v_mfma_f32_32x32x16_bf16 v[240:255], v[180:183], v[132:135], v[240:255]
    v_mfma_f32_32x32x16_bf16 v[128:143], v[28:31], v[64:67], v[160:175]
    v_mfma_f32_32x32x16_bf16 v[128:143], v[54:57], v[72:75], v[128:143]
    s_cmp_ge_u32 s14, 4
    s_cbranch_scc1 k2_pv4
    v_mov_b32 v144, 0xff800000
    v_mov_b32 v145, 0xff800000
    v_mov_b32 v146, 0xff800000
    v_mov_b32 v147, 0xff800000
    v_mov_b32 v148, 0xff800000
    v_mov_b32 v149, 0xff800000
    v_mov_b32 v150, 0xff800000
    v_mov_b32 v151, 0xff800000
    v_mov_b32 v152, 0xff800000
    v_mov_b32 v153, 0xff800000
    v_mov_b32 v154, 0xff800000
    v_mov_b32 v155, 0xff800000
    v_mov_b32 v156, 0xff800000
    v_mov_b32 v157, 0xff800000
    v_mov_b32 v158, 0xff800000
    v_mov_b32 v159, 0xff800000
k2_pv4:
    v_exp_f32 v144, v144
    v_exp_f32 v145, v145
    v_exp_f32 v146, v146
    v_exp_f32 v147, v147
    v_exp_f32 v148, v148
    v_exp_f32 v149, v149
    v_exp_f32 v150, v150
    v_exp_f32 v151, v151
    s_mov_b32 m0, 20480
    s_nop 0
    buffer_load_dwordx4 v1, s[28:31], s26 offen lds
    s_add_u32 s26, s26, 1024
    v_exp_f32 v152, v152
    v_exp_f32 v153, v153
    v_exp_f32 v154, v154
    v_exp_f32 v155, v155
    v_exp_f32 v156, v156
    v_exp_f32 v157, v157
    v_exp_f32 v158, v158
    v_exp_f32 v159, v159
    s_mov_b32 m0, 20480
    s_nop 0
    buffer_load_dwordx4 v1, s[28:31], s26 offen lds
    s_add_u32 s26, s26, 1024
    v_cvt_pk_bf16_f32 v144, v144, v145
    v_cvt_pk_bf16_f32 v145, v146, v147
    v_cvt_pk_bf16_f32 v146, v148, v149
    v_cvt_pk_bf16_f32 v147, v150, v151
    v_cvt_pk_bf16_f32 v148, v152, v153
    v_cvt_pk_bf16_f32 v149, v154, v155
    v_cvt_pk_bf16_f32 v150, v156, v157
    v_cvt_pk_bf16_f32 v151, v158, v159
    v_mfma_f32_32x32x16_bf16 v[240:255], v[184:187], v[144:147], v[240:255]
    s_nop 0
    v_mfma_f32_32x32x16_bf16 v[240:255], v[188:191], v[148:151], v[240:255]
    v_mfma_f32_32x32x16_bf16 v[144:159], v[24:27], v[64:67], v[160:175]
    v_mfma_f32_32x32x16_bf16 v[144:159], v[54:57], v[68:71], v[144:159]
    s_cmp_ge_u32 s14, 5
    s_cbranch_scc1 k2_pv3
    v_mov_b32 v128, 0xff800000
    v_mov_b32 v129, 0xff800000
    v_mov_b32 v130, 0xff800000
    v_mov_b32 v131, 0xff800000
    v_mov_b32 v132, 0xff800000
    v_mov_b32 v133, 0xff800000
    v_mov_b32 v134, 0xff800000
    v_mov_b32 v135, 0xff800000
    v_mov_b32 v136, 0xff800000
    v_mov_b32 v137, 0xff800000
    v_mov_b32 v138, 0xff800000
    v_mov_b32 v139, 0xff800000
    v_mov_b32 v140, 0xff800000
    v_mov_b32 v141, 0xff800000
    v_mov_b32 v142, 0xff800000
    v_mov_b32 v143, 0xff800000
k2_pv3:
    v_exp_f32 v128, v128
    v_exp_f32 v129, v129
    v_exp_f32 v130, v130
    v_exp_f32 v131, v131
    v_exp_f32 v132, v132
    v_exp_f32 v133, v133
    v_exp_f32 v134, v134
    v_exp_f32 v135, v135
    s_mov_b32 m0, 20480
    s_nop 0
    buffer_load_dwordx4 v1, s[28:31], s26 offen lds
    s_add_u32 s26, s26, 1024
    v_exp_f32 v136, v136
    v_exp_f32 v137, v137
    v_exp_f32 v138, v138
    v_exp_f32 v139, v139
    v_exp_f32 v140, v140
    v_exp_f32 v141, v141
    v_exp_f32 v142, v142
    v_exp_f32 v143, v143
    s_mov_b32 m0, 20480
    s_nop 0
    buffer_load_dwordx4 v1, s[28:31], s26 offen lds
    s_add_u32 s26, s26, 1024
    v_cvt_pk_bf16_f32 v128, v128, v129
    v_cvt_pk_bf16_f32 v129, v130, v131
    v_cvt_pk_bf16_f32 v130, v132, v133
    v_cvt_pk_bf16_f32 v131, v134, v135
    v_cvt_pk_bf16_f32 v132, v136, v137
    v_cvt_pk_bf16_f32 v133, v138, v139
    v_cvt_pk_bf16_f32 v134, v140, v141
    v_cvt_pk_bf16_f32 v135, v142, v143
    v_mfma_f32_32x32x16_bf16 v[240:255], v[192:195], v[128:131], v[240:255]
    s_nop 0
    v_mfma_f32_32x32x16_bf16 v[240:255], v[196:199], v[132:135], v[240:255]
    v_mfma_f32_32x32x16_bf16 v[128:143], v[20:23], v[64:67], v[160:175]
    v_mfma_f32_32x32x16_bf16 v[128:143], v[52:55], v[72:75], v[128:143]
    s_cmp_ge_u32 s14, 6
    s_cbranch_scc1 k2_pv2
    v_mov_b32 v144, 0xff800000
    v_mov_b32 v145, 0xff800000
    v_mov_b32 v146, 0xff800000
    v_mov_b32 v147, 0xff800000
    v_mov_b32 v148, 0xff800000
    v_mov_b32 v149, 0xff800000
    v_mov_b32 v150, 0xff800000
    v_mov_b32 v151, 0xff800000
    v_mov_b32 v152, 0xff800000
    v_mov_b32 v153, 0xff800000
    v_mov_b32 v154, 0xff800000
    v_mov_b32 v155, 0xff800000
    v_mov_b32 v156, 0xff800000
    v_mov_b32 v157, 0xff800000
    v_mov_b32 v158, 0xff800000
    v_mov_b32 v159, 0xff800000
k2_pv2:
    v_exp_f32 v144, v144
    v_exp_f32 v145, v145
    v_exp_f32 v146, v146
    v_exp_f32 v147, v147
    v_exp_f32 v148, v148
    v_exp_f32 v149, v149
    v_exp_f32 v150, v150
    v_exp_f32 v151, v151
    v_exp_f32 v152, v152
    v_exp_f32 v153, v153
    v_exp_f32 v154, v154
    v_exp_f32 v155, v155
    v_exp_f32 v156, v156
    v_exp_f32 v157, v157
    v_exp_f32 v158, v158
    v_exp_f32 v159, v159
    v_cvt_pk_bf16_f32 v144, v144, v145
    v_cvt_pk_bf16_f32 v145, v146, v147
    v_cvt_pk_bf16_f32 v146, v148, v149
    v_cvt_pk_bf16_f32 v147, v150, v151
    v_cvt_pk_bf16_f32 v148, v152, v153
    v_cvt_pk_bf16_f32 v149, v154, v155
    v_cvt_pk_bf16_f32 v150, v156, v157
    v_cvt_pk_bf16_f32 v151, v158, v159
    v_mfma_f32_32x32x16_bf16 v[240:255], v[200:203], v[144:147], v[240:255]
    s_nop 0
    v_mfma_f32_32x32x16_bf16 v[240:255], v[204:207], v[148:151], v[240:255]
    s_cmp_ge_u32 s14, 7
    s_cbranch_scc1 k2_pv1
    v_mov_b32 v128, 0xff800000
    v_mov_b32 v129, 0xff800000
    v_mov_b32 v130, 0xff800000
    v_mov_b32 v131, 0xff800000
    v_mov_b32 v132, 0xff800000
    v_mov_b32 v133, 0xff800000
    v_mov_b32 v134, 0xff800000
    v_mov_b32 v135, 0xff800000
    v_mov_b32 v136, 0xff800000
    v_mov_b32 v137, 0xff800000
    v_mov_b32 v138, 0xff800000
    v_mov_b32 v139, 0xff800000
    v_mov_b32 v140, 0xff800000
    v_mov_b32 v141, 0xff800000
    v_mov_b32 v142, 0xff800000
    v_mov_b32 v143, 0xff800000
k2_pv1:
    v_exp_f32 v128, v128
    v_exp_f32 v129, v129
    v_exp_f32 v130, v130
    v_exp_f32 v131, v131
    v_exp_f32 v132, v132
    v_exp_f32 v133, v133
    v_exp_f32 v134, v134
    v_exp_f32 v135, v135
    v_exp_f32 v136, v136
    v_exp_f32 v137, v137
    v_exp_f32 v138, v138
    v_exp_f32 v139, v139
    v_exp_f32 v140, v140
    v_exp_f32 v141, v141
    v_exp_f32 v142, v142
    v_exp_f32 v143, v143
    v_cvt_pk_bf16_f32 v128, v128, v129
    v_cvt_pk_bf16_f32 v129, v130, v131
    v_cvt_pk_bf16_f32 v130, v132, v133
    v_cvt_pk_bf16_f32 v131, v134, v135
    v_cvt_pk_bf16_f32 v132, v136, v137
    v_cvt_pk_bf16_f32 v133, v138, v139
    v_cvt_pk_bf16_f32 v134, v140, v141
    v_cvt_pk_bf16_f32 v135, v142, v143
    v_mfma_f32_32x32x16_bf16 v[240:255], v[208:211], v[128:131], v[240:255]
    s_nop 0
    v_mfma_f32_32x32x16_bf16 v[240:255], v[212:215], v[132:135], v[240:255]
    v_lshrrev_b32 v18, 5, v0
    v_bfe_u32 v16, v0, 4, 1
    v_lshlrev_b32 v16, 14, v16
    v_and_b32 v17, 15, v0
    v_lshl_add_u32 v16, v17, 4, v16
    v_lshl_add_u32 v17, v18, 8, v16
    v_lshlrev_b32 v16, 2, v0
    s_mul_i32 s26, s14, 36864
    s_add_u32 s26, s26, 9437184
    s_lshl_b32 s27, s13, 9
    s_add_u32 s27, s27, s26
    s_lshl_b32 s28, s13, 7
    s_add_u32 s26, s26, s28
    s_add_u32 s26, s26, 32768
    v_rcp_f32 v109, v250
    s_nop 0
    v_mul_f32 v240, v240, v109
    v_mul_f32 v241, v241, v109
    v_mul_f32 v242, v242, v109
    v_mul_f32 v243, v243, v109
    v_mul_f32 v244, v244, v109
    v_mul_f32 v245, v245, v109
    v_mul_f32 v246, v246, v109
    v_mul_f32 v247, v247, v109
    v_mul_f32 v248, v248, v109
    v_mul_f32 v249, v249, v109
    v_cvt_pk_bf16_f32 v240, v240, v241
    v_cvt_pk_bf16_f32 v241, v242, v243
    v_cvt_pk_bf16_f32 v242, v244, v245
    v_cvt_pk_bf16_f32 v243, v246, v247
    v_cvt_pk_bf16_f32 v244, v248, v249
    buffer_store_dwordx4 v[240:243], v17, s[8:11], s27 offen sc1
    s_mov_b32 exec_hi, 0
    buffer_store_dword v244, v16, s[8:11], s26 offen sc1
    s_mov_b32 exec_hi, -1
    v_mov_b32 v20, v2
    v_mov_b32 v21, v4
    v_mov_b32 v22, v5
    v_lshrrev_b32 v2, 4, v0
    v_bfe_u32 v3, v0, 2, 2
    v_and_b32 v4, 3, v0
    v_and_b32 v5, 15, v0
    s_lshr_b32 s18, s12, 1
    s_and_b32 s19, s12, 1
    v_lshl_add_u32 v6, v2, 3, v3
    v_mul_u32_u24 v29, 288, v6
    v_lshl_add_u32 v29, v4, 3, v29
    s_lshl_b32 s20, s18, 5
    v_lshl_add_u32 v28, v2, 7, v29
    v_add_u32 v28, s20, v28
    s_cmp_lg_u32 s18, 0
    s_cbranch_scc1 k2_c2
    s_mul_i32 s21, s19, 18432
    s_add_u32 s21, s21, s20
    s_add_u32 s21, s21, s93
    v_mul_u32_u24 v23, 1152, v5
    v_lshl_add_u32 v23, v2, 3, v23
    buffer_load_dwordx2 v[80:81], v23, s[80:83], s21 offen offset:0
    buffer_load_dwordx2 v[82:83], v23, s[80:83], s21 offen offset:128
    buffer_load_dwordx2 v[84:85], v23, s[80:83], s21 offen offset:256
    v_add_u32 v27, 66560, v28
    ds_read_b64_tr_b16 v[112:113], v27 offset:0
    ds_read_b64_tr_b16 v[114:115], v27 offset:1152
    ds_read_b64_tr_b16 v[116:117], v27 offset:128
    ds_read_b64_tr_b16 v[118:119], v27 offset:1280
    ds_read_b64_tr_b16 v[120:121], v27 offset:256
    ds_read_b64_tr_b16 v[122:123], v27 offset:1408
    ds_read_b64_tr_b16 v[124:125], v27 offset:9728
    ds_read_b64_tr_b16 v[126:127], v27 offset:10880
    ds_read_b64_tr_b16 v[128:129], v27 offset:9856
    ds_read_b64_tr_b16 v[130:131], v27 offset:11008
    ds_read_b64_tr_b16 v[132:133], v27 offset:9984
    ds_read_b64_tr_b16 v[134:135], v27 offset:11136
    v_add_u32 v27, 86016, v28
    ds_read_b64_tr_b16 v[136:137], v27 offset:0
    ds_read_b64_tr_b16 v[138:139], v27 offset:1152
    ds_read_b64_tr_b16 v[140:141], v27 offset:128
    ds_read_b64_tr_b16 v[142:143], v27 offset:1280
    ds_read_b64_tr_b16 v[144:145], v27 offset:256
    ds_read_b64_tr_b16 v[146:147], v27 offset:1408
    ds_read_b64_tr_b16 v[148:149], v27 offset:9728
    ds_read_b64_tr_b16 v[150:151], v27 offset:10880
    ds_read_b64_tr_b16 v[152:153], v27 offset:9856
    ds_read_b64_tr_b16 v[154:155], v27 offset:11008
    ds_read_b64_tr_b16 v[156:157], v27 offset:9984
    ds_read_b64_tr_b16 v[158:159], v27 offset:11136
    v_add_u32 v27, 105472, v28
    ds_read_b64_tr_b16 v[160:161], v27 offset:0
    ds_read_b64_tr_b16 v[162:163], v27 offset:1152
    ds_read_b64_tr_b16 v[164:165], v27 offset:128
    ds_read_b64_tr_b16 v[166:167], v27 offset:1280
    ds_read_b64_tr_b16 v[168:169], v27 offset:256
    ds_read_b64_tr_b16 v[170:171], v27 offset:1408
    ds_read_b64_tr_b16 v[172:173], v27 offset:9728
    ds_read_b64_tr_b16 v[174:175], v27 offset:10880
    ds_read_b64_tr_b16 v[176:177], v27 offset:9856
    ds_read_b64_tr_b16 v[178:179], v27 offset:11008
    ds_read_b64_tr_b16 v[180:181], v27 offset:9984
    ds_read_b64_tr_b16 v[182:183], v27 offset:11136
    s_waitcnt vmcnt(5) lgkmcnt(0)
    s_barrier
    s_add_u32 s92, s90, 580608
    s_add_u32 m0, s91, 105472
    s_nop 0
    buffer_load_dwordx4 v20, s[76:79], s92 offen lds
    s_add_u32 s92, s90, 580608
    s_add_u32 m0, s91, 113664
    s_nop 0
    buffer_load_dwordx4 v21, s[76:79], s92 offen lds
    s_add_u32 s92, s90, 580608
    s_add_u32 s3, s91, 121856
    s_cmp_lt_u32 s12, 3
    s_cselect_b32 m0, s3, 19456
    s_nop 0
    buffer_load_dwordx4 v22, s[76:79], s92 offen lds
    v_mov_b32 v64, 0
    v_mov_b32 v65, 0
    v_mov_b32 v66, 0
    v_mov_b32 v67, 0
    v_mov_b32 v68, 0
    v_mov_b32 v69, 0
    v_mov_b32 v70, 0
    v_mov_b32 v71, 0
    v_mov_b32 v72, 0
    v_mov_b32 v73, 0
    v_mov_b32 v74, 0
    v_mov_b32 v75, 0
    s_mul_i32 s23, s84, 36864
    s_add_u32 s23, s23, 9437184
    v_and_b32 v52, 31, v0
    v_lshlrev_b32 v52, 7, v52
    v_add_u32 v52, 32768, v52
    v_add_u32 v27, s91, v1
    v_add_u32 v27, 66560, v27
    s_mov_b32 s22, 0x20000
    s_cmp_lg_u32 s12, 0
    s_cbranch_scc1 k2_c3_opolled
k2_c3_opoll:
    buffer_load_dword v56, v52, s[8:11], s23 offen sc1
    s_sub_u32 s22, s22, 1
    s_waitcnt vmcnt(0)
    v_cmp_eq_u32 vcc, -1, v56
    s_cmp_eq_u32 s22, 0
    s_cbranch_scc1 k2_c3_opolled
    s_cmp_eq_u64 vcc, 0
    s_cbranch_scc1 k2_c3_opolled
    s_sleep 3
    s_branch k2_c3_opoll
k2_c3_opolled:
    s_barrier
k2_c3_oload:
    s_add_u32 s21, s23, s91
    buffer_load_dwordx4 v[32:35], v1, s[8:11], s21 offen sc1
    s_add_u32 s21, s21, 8192
    buffer_load_dwordx4 v[36:39], v1, s[8:11], s21 offen sc1
    s_add_u32 s21, s21, 8192
    buffer_load_dwordx4 v[40:43], v1, s[8:11], s21 offen sc1
    s_add_u32 s21, s21, 8192
    buffer_load_dwordx4 v[44:47], v1, s[8:11], s21 offen sc1
    s_add_u32 s21, s21, 8192
    s_cmp_lt_u32 s12, 4
    s_cselect_b32 s21, s21, 0x40000000
    buffer_load_dwordx4 v[48:51], v1, s[8:11], s21 offen sc1
    s_waitcnt vmcnt(0)
    v_max3_u32 v56, v32, v33, v34
    v_max3_u32 v57, v35, v36, v37
    v_max3_u32 v56, v56, v38, v39
    v_max3_u32 v57, v57, v40, v41
    v_max3_u32 v56, v56, v42, v43
    v_max3_u32 v57, v57, v44, v45
    v_max3_u32 v56, v56, v46, v47
    v_max3_u32 v57, v57, v48, v49
    v_max3_u32 v56, v56, v50, v51
    v_max_u32 v56, v56, v57
    v_cmp_eq_u32 vcc, -1, v56
    s_cmp_eq_u32 s22, 0
    s_cbranch_scc1 k2_c3_ovalid
    s_cmp_eq_u64 vcc, 0
    s_cbranch_scc1 k2_c3_ovalid
    s_sub_u32 s22, s22, 1
    s_sleep 3
    s_branch k2_c3_oload
k2_c3_ovalid:
    ds_write_b128 v27, v[32:35] offset:0
    ds_write_b128 v27, v[36:39] offset:8192
    ds_write_b128 v27, v[40:43] offset:16384
    ds_write_b128 v27, v[44:47] offset:24576
    s_cmp_ge_u32 s12, 4
    s_cbranch_scc1 k2_c3_o4
    ds_write_b128 v27, v[48:51] offset:32768
k2_c3_o4:
    s_lshl_b32 s21, s19, 14
    s_add_u32 s21, s21, 66560
    v_add_u32 v19, s21, v1
    s_lshl_b32 s21, s19, 6
    s_add_u32 s21, s21, 99328
    v_lshlrev_b32 v18, 2, v5
    v_lshl_add_u32 v18, v2, 9, v18
    v_add_u32 v18, s21, v18
    s_waitcnt lgkmcnt(0)
    s_barrier
    ds_read_b32 v32, v18 offset:0
    ds_read_b32 v33, v18 offset:128
    ds_read_b32 v34, v18 offset:256
    ds_read_b32 v35, v18 offset:384
    ds_read_b32 v36, v18 offset:2048
    ds_read_b32 v37, v18 offset:2176
    ds_read_b32 v38, v18 offset:2304
    ds_read_b32 v39, v18 offset:2432
    ds_read_b128 v[40:43], v19 offset:0
    s_waitcnt lgkmcnt(5)
    v_mfma_f32_16x16x32_bf16 v[64:67], v[112:115], v[32:35], v[64:67]
    ds_read_b128 v[44:47], v19 offset:1024
    v_mfma_f32_16x16x32_bf16 v[68:71], v[116:119], v[32:35], v[68:71]
    v_mfma_f32_16x16x32_bf16 v[72:75], v[120:123], v[32:35], v[72:75]
    s_waitcnt lgkmcnt(2)
    v_mfma_f32_16x16x32_bf16 v[64:67], v[124:127], v[36:39], v[64:67]
    ds_read_b128 v[48:51], v19 offset:2048
    v_mfma_f32_16x16x32_bf16 v[68:71], v[128:131], v[36:39], v[68:71]
    v_mfma_f32_16x16x32_bf16 v[72:75], v[132:135], v[36:39], v[72:75]
    s_waitcnt lgkmcnt(2)
    v_mfma_f32_16x16x32_bf16 v[64:67], v[136:139], v[40:43], v[64:67]
    ds_read_b128 v[52:55], v19 offset:3072
    v_mfma_f32_16x16x32_bf16 v[68:71], v[140:143], v[40:43], v[68:71]
    v_mfma_f32_16x16x32_bf16 v[72:75], v[144:147], v[40:43], v[72:75]
    s_waitcnt lgkmcnt(2)
    v_mfma_f32_16x16x32_bf16 v[64:67], v[148:151], v[44:47], v[64:67]
    ds_read_b128 v[56:59], v19 offset:4096
    v_add_u32 v31, 124928, v28
    ds_read_b64_tr_b16 v[208:209], v31 offset:0
    v_mfma_f32_16x16x32_bf16 v[68:71], v[152:155], v[44:47], v[68:71]
    ds_read_b64_tr_b16 v[210:211], v31 offset:1152
    ds_read_b64_tr_b16 v[212:213], v31 offset:128
    ds_read_b64_tr_b16 v[214:215], v31 offset:1280
    v_mfma_f32_16x16x32_bf16 v[72:75], v[156:159], v[44:47], v[72:75]
    ds_read_b64_tr_b16 v[216:217], v31 offset:256
    ds_read_b64_tr_b16 v[218:219], v31 offset:1408
    s_waitcnt lgkmcnt(8)
    v_mfma_f32_16x16x32_bf16 v[64:67], v[160:163], v[48:51], v[64:67]
    ds_read_b128 v[60:63], v19 offset:5120
    ds_read_b64_tr_b16 v[220:221], v31 offset:9728
    ds_read_b64_tr_b16 v[222:223], v31 offset:10880
    v_mfma_f32_16x16x32_bf16 v[68:71], v[164:167], v[48:51], v[68:71]
    ds_read_b64_tr_b16 v[224:225], v31 offset:9856
    ds_read_b64_tr_b16 v[226:227], v31 offset:11008
    v_mfma_f32_16x16x32_bf16 v[72:75], v[168:171], v[48:51], v[72:75]
    ds_read_b64_tr_b16 v[228:229], v31 offset:9984
    ds_read_b64_tr_b16 v[230:231], v31 offset:11136
    s_waitcnt lgkmcnt(14)
    v_mfma_f32_16x16x32_bf16 v[64:67], v[172:175], v[52:55], v[64:67]
    ds_read_b128 v[32:35], v19 offset:6144
    v_add_u32 v30, 144384, v28
    ds_read_b64_tr_b16 v[184:185], v30 offset:0
    v_mfma_f32_16x16x32_bf16 v[68:71], v[176:179], v[52:55], v[68:71]
    ds_read_b64_tr_b16 v[186:187], v30 offset:1152
    ds_read_b64_tr_b16 v[188:189], v30 offset:128
    ds_read_b64_tr_b16 v[190:191], v30 offset:1280
    v_mfma_f32_16x16x32_bf16 v[72:75], v[180:183], v[52:55], v[72:75]
    ds_read_b64_tr_b16 v[192:193], v30 offset:256
    ds_read_b64_tr_b16 v[194:195], v30 offset:1408
    s_waitcnt lgkmcnt(15)
    v_mfma_f32_16x16x32_bf16 v[64:67], v[208:211], v[56:59], v[64:67]
    ds_read_b128 v[36:39], v19 offset:7168
    ds_read_b64_tr_b16 v[196:197], v30 offset:9728
    ds_read_b64_tr_b16 v[198:199], v30 offset:10880
    v_mfma_f32_16x16x32_bf16 v[68:71], v[212:215], v[56:59], v[68:71]
    ds_read_b64_tr_b16 v[200:201], v30 offset:9856
    ds_read_b64_tr_b16 v[202:203], v30 offset:11008
    s_waitcnt lgkmcnt(15)
    v_mfma_f32_16x16x32_bf16 v[72:75], v[216:219], v[56:59], v[72:75]
    ds_read_b64_tr_b16 v[204:205], v30 offset:9984
    ds_read_b64_tr_b16 v[206:207], v30 offset:11136
    v_mfma_f32_16x16x32_bf16 v[64:67], v[220:223], v[60:63], v[64:67]
    ds_read_b128 v[40:43], v19 offset:8192
    v_add_u32 v31, 0, v28
    ds_read_b64_tr_b16 v[208:209], v31 offset:0
    s_waitcnt lgkmcnt(15)
    v_mfma_f32_16x16x32_bf16 v[68:71], v[224:227], v[60:63], v[68:71]
    ds_read_b64_tr_b16 v[210:211], v31 offset:1152
    ds_read_b64_tr_b16 v[212:213], v31 offset:128
    ds_read_b64_tr_b16 v[214:215], v31 offset:1280
    v_mfma_f32_16x16x32_bf16 v[72:75], v[228:231], v[60:63], v[72:75]
    ds_read_b64_tr_b16 v[216:217], v31 offset:256
    ds_read_b64_tr_b16 v[218:219], v31 offset:1408
    s_waitcnt lgkmcnt(15)
    v_mfma_f32_16x16x32_bf16 v[64:67], v[184:187], v[32:35], v[64:67]
    ds_read_b128 v[44:47], v19 offset:9216
    ds_read_b64_tr_b16 v[220:221], v31 offset:9728
    ds_read_b64_tr_b16 v[222:223], v31 offset:10880
    v_mfma_f32_16x16x32_bf16 v[68:71], v[188:191], v[32:35], v[68:71]
    ds_read_b64_tr_b16 v[224:225], v31 offset:9856
    ds_read_b64_tr_b16 v[226:227], v31 offset:11008
    s_waitcnt lgkmcnt(15)
    v_mfma_f32_16x16x32_bf16 v[72:75], v[192:195], v[32:35], v[72:75]
    ds_read_b64_tr_b16 v[228:229], v31 offset:9984
    ds_read_b64_tr_b16 v[230:231], v31 offset:11136
    v_mfma_f32_16x16x32_bf16 v[64:67], v[196:199], v[36:39], v[64:67]
    ds_read_b128 v[48:51], v19 offset:10240
    v_add_u32 v30, 27648, v28
    ds_read_b64_tr_b16 v[184:185], v30 offset:0
    s_waitcnt lgkmcnt(15)
    v_mfma_f32_16x16x32_bf16 v[68:71], v[200:203], v[36:39], v[68:71]
    ds_read_b64_tr_b16 v[186:187], v30 offset:1152
    ds_read_b64_tr_b16 v[188:189], v30 offset:128
    ds_read_b64_tr_b16 v[190:191], v30 offset:1280
    v_mfma_f32_16x16x32_bf16 v[72:75], v[204:207], v[36:39], v[72:75]
    ds_read_b64_tr_b16 v[192:193], v30 offset:256
    ds_read_b64_tr_b16 v[194:195], v30 offset:1408
    s_waitcnt lgkmcnt(15)
    v_mfma_f32_16x16x32_bf16 v[64:67], v[208:211], v[40:43], v[64:67]
    ds_read_b128 v[52:55], v19 offset:11264
    ds_read_b64_tr_b16 v[196:197], v30 offset:9728
    ds_read_b64_tr_b16 v[198:199], v30 offset:10880
    v_mfma_f32_16x16x32_bf16 v[68:71], v[212:215], v[40:43], v[68:71]
    ds_read_b64_tr_b16 v[200:201], v30 offset:9856
    ds_read_b64_tr_b16 v[202:203], v30 offset:11008
    s_waitcnt lgkmcnt(15)
    v_mfma_f32_16x16x32_bf16 v[72:75], v[216:219], v[40:43], v[72:75]
    ds_read_b64_tr_b16 v[204:205], v30 offset:9984
    ds_read_b64_tr_b16 v[206:207], v30 offset:11136
    v_mfma_f32_16x16x32_bf16 v[64:67], v[220:223], v[44:47], v[64:67]
    ds_read_b128 v[56:59], v19 offset:12288
    v_add_u32 v31, 47104, v28
    ds_read_b64_tr_b16 v[208:209], v31 offset:0
    s_waitcnt lgkmcnt(15)
    v_mfma_f32_16x16x32_bf16 v[68:71], v[224:227], v[44:47], v[68:71]
    ds_read_b64_tr_b16 v[210:211], v31 offset:1152
    ds_read_b64_tr_b16 v[212:213], v31 offset:128
    ds_read_b64_tr_b16 v[214:215], v31 offset:1280
    v_mfma_f32_16x16x32_bf16 v[72:75], v[228:231], v[44:47], v[72:75]
    ds_read_b64_tr_b16 v[216:217], v31 offset:256
    ds_read_b64_tr_b16 v[218:219], v31 offset:1408
    s_waitcnt lgkmcnt(15)
    v_mfma_f32_16x16x32_bf16 v[64:67], v[184:187], v[48:51], v[64:67]
    ds_read_b128 v[60:63], v19 offset:13312
    ds_read_b64_tr_b16 v[220:221], v31 offset:9728
    ds_read_b64_tr_b16 v[222:223], v31 offset:10880
    v_mfma_f32_16x16x32_bf16 v[68:71], v[188:191], v[48:51], v[68:71]
    ds_read_b64_tr_b16 v[224:225], v31 offset:9856
    ds_read_b64_tr_b16 v[226:227], v31 offset:11008
    s_waitcnt lgkmcnt(15)
    v_mfma_f32_16x16x32_bf16 v[72:75], v[192:195], v[48:51], v[72:75]
    ds_read_b64_tr_b16 v[228:229], v31 offset:9984
    ds_read_b64_tr_b16 v[230:231], v31 offset:11136
    v_mfma_f32_16x16x32_bf16 v[64:67], v[196:199], v[52:55], v[64:67]
    ds_read_b128 v[32:35], v19 offset:14336
    v_add_u32 v30, 105472, v28
    ds_read_b64_tr_b16 v[184:185], v30 offset:0
    s_waitcnt lgkmcnt(15)
    v_mfma_f32_16x16x32_bf16 v[68:71], v[200:203], v[52:55], v[68:71]
    ds_read_b64_tr_b16 v[186:187], v30 offset:1152
    ds_read_b64_tr_b16 v[188:189], v30 offset:128
    ds_read_b64_tr_b16 v[190:191], v30 offset:1280
    v_mfma_f32_16x16x32_bf16 v[72:75], v[204:207], v[52:55], v[72:75]
    ds_read_b64_tr_b16 v[192:193], v30 offset:256
    ds_read_b64_tr_b16 v[194:195], v30 offset:1408
    s_waitcnt lgkmcnt(15)
    v_mfma_f32_16x16x32_bf16 v[64:67], v[208:211], v[56:59], v[64:67]
    ds_read_b128 v[36:39], v19 offset:15360
    ds_read_b64_tr_b16 v[196:197], v30 offset:9728
    ds_read_b64_tr_b16 v[198:199], v30 offset:10880
    v_mfma_f32_16x16x32_bf16 v[68:71], v[212:215], v[56:59], v[68:71]
    ds_read_b64_tr_b16 v[200:201], v30 offset:9856
    ds_read_b64_tr_b16 v[202:203], v30 offset:11008
    s_waitcnt lgkmcnt(15)
    v_mfma_f32_16x16x32_bf16 v[72:75], v[216:219], v[56:59], v[72:75]
    ds_read_b64_tr_b16 v[204:205], v30 offset:9984
    ds_read_b64_tr_b16 v[206:207], v30 offset:11136
    v_mfma_f32_16x16x32_bf16 v[64:67], v[220:223], v[60:63], v[64:67]
    s_waitcnt lgkmcnt(15)
    v_mfma_f32_16x16x32_bf16 v[68:71], v[224:227], v[60:63], v[68:71]
    s_waitcnt lgkmcnt(14)
    v_mfma_f32_16x16x32_bf16 v[72:75], v[228:231], v[60:63], v[72:75]
    s_waitcnt lgkmcnt(11)
    v_mfma_f32_16x16x32_bf16 v[64:67], v[184:187], v[32:35], v[64:67]
    s_waitcnt lgkmcnt(9)
    v_mfma_f32_16x16x32_bf16 v[68:71], v[188:191], v[32:35], v[68:71]
    s_waitcnt lgkmcnt(7)
    v_mfma_f32_16x16x32_bf16 v[72:75], v[192:195], v[32:35], v[72:75]
    s_waitcnt lgkmcnt(4)
    v_mfma_f32_16x16x32_bf16 v[64:67], v[196:199], v[36:39], v[64:67]
    s_waitcnt lgkmcnt(2)
    v_mfma_f32_16x16x32_bf16 v[68:71], v[200:203], v[36:39], v[68:71]
    s_waitcnt lgkmcnt(0)
    v_mfma_f32_16x16x32_bf16 v[72:75], v[204:207], v[36:39], v[72:75]
    s_mul_i32 s21, s19, 4608
    s_add_u32 s21, s21, s20
    s_add_u32 s21, s21, 124928
    v_mul_u32_u24 v6, 288, v5
    v_lshl_add_u32 v6, v2, 3, v6
    v_add_u32 v6, s21, v6
    v_mov_b32 v12, 0
    v_mov_b32 v13, 0
    v_lshlrev_b32 v16, 16, v80
    v_and_b32 v17, 0xffff0000, v80
    v_lshlrev_b32 v18, 16, v81
    v_and_b32 v19, 0xffff0000, v81
    v_add_f32 v64, v64, v16
    v_add_f32 v65, v65, v17
    v_add_f32 v66, v66, v18
    v_add_f32 v67, v67, v19
    v_cvt_pk_bf16_f32 v80, v64, v65
    v_cvt_pk_bf16_f32 v81, v66, v67
    v_lshlrev_b32 v64, 16, v80
    v_and_b32 v65, 0xffff0000, v80
    v_lshlrev_b32 v66, 16, v81
    v_and_b32 v67, 0xffff0000, v81
    v_add_f32 v12, v12, v64
    v_fmac_f32 v13, v64, v64
    v_add_f32 v12, v12, v65
    v_fmac_f32 v13, v65, v65
    v_add_f32 v12, v12, v66
    v_fmac_f32 v13, v66, v66
    v_add_f32 v12, v12, v67
    v_fmac_f32 v13, v67, v67
    v_lshlrev_b32 v16, 16, v82
    v_and_b32 v17, 0xffff0000, v82
    v_lshlrev_b32 v18, 16, v83
    v_and_b32 v19, 0xffff0000, v83
    v_add_f32 v68, v68, v16
    v_add_f32 v69, v69, v17
    v_add_f32 v70, v70, v18
    v_add_f32 v71, v71, v19
    v_cvt_pk_bf16_f32 v82, v68, v69
    v_cvt_pk_bf16_f32 v83, v70, v71
    v_lshlrev_b32 v68, 16, v82
    v_and_b32 v69, 0xffff0000, v82
    v_lshlrev_b32 v70, 16, v83
    v_and_b32 v71, 0xffff0000, v83
    v_add_f32 v12, v12, v68
    v_fmac_f32 v13, v68, v68
    v_add_f32 v12, v12, v69
    v_fmac_f32 v13, v69, v69
    v_add_f32 v12, v12, v70
    v_fmac_f32 v13, v70, v70
    v_add_f32 v12, v12, v71
    v_fmac_f32 v13, v71, v71
    v_lshlrev_b32 v16, 16, v84
    v_and_b32 v17, 0xffff0000, v84
    v_lshlrev_b32 v18, 16, v85
    v_and_b32 v19, 0xffff0000, v85
    v_add_f32 v72, v72, v16
    v_add_f32 v73, v73, v17
    v_add_f32 v74, v74, v18
    v_add_f32 v75, v75, v19
    v_cvt_pk_bf16_f32 v84, v72, v73
    v_cvt_pk_bf16_f32 v85, v74, v75
    v_lshlrev_b32 v72, 16, v84
    v_and_b32 v73, 0xffff0000, v84
    v_lshlrev_b32 v74, 16, v85
    v_and_b32 v75, 0xffff0000, v85
    v_add_f32 v12, v12, v72
    v_fmac_f32 v13, v72, v72
    v_add_f32 v12, v12, v73
    v_fmac_f32 v13, v73, v73
    v_add_f32 v12, v12, v74
    v_fmac_f32 v13, v74, v74
    v_add_f32 v12, v12, v75
    v_fmac_f32 v13, v75, v75
    v_mov_b32 v16, v12
    v_mov_b32 v17, v13
    s_nop 0
    v_permlane16_swap_b32 v12, v16
    v_permlane16_swap_b32 v13, v17
    v_add_f32 v12, v12, v16
    v_add_f32 v13, v13, v17
    v_mov_b32 v16, v12
    v_mov_b32 v17, v13
    s_nop 0
    v_permlane32_swap_b32 v12, v16
    v_permlane32_swap_b32 v13, v17
    v_add_f32 v12, v12, v16
    v_add_f32 v13, v13, v17
    s_lshl_b32 s21, s18, 8
    s_lshl_b32 s22, s19, 7
    s_add_u32 s21, s21, s22
    s_add_u32 s21, s21, 21504
    v_lshlrev_b32 v7, 3, v5
    v_add_u32 v20, s21, v7
    ds_write_b64 v20, v[12:13]
    s_lshl_b32 s30, s84, 10
    s_add_u32 s30, s30, 29188096
    v_lshl_add_u32 v7, v2, 8, v7
    v_add_u32 v7, s22, v7
    s_waitcnt lgkmcnt(0)
    s_barrier
    s_cmp_lg_u32 s12, 0
    s_cbranch_scc1 k2_c3_nopub
    v_and_b32 v20, 31, v0
    v_lshlrev_b32 v20, 3, v20
    v_add_u32 v22, 21504, v20
    ds_read_b64 v[12:13], v22 offset:0
    ds_read_b64 v[14:15], v22 offset:256
    ds_read_b64 v[16:17], v22 offset:512
    ds_read_b64 v[18:19], v22 offset:768
    s_lshl_b32 s31, s85, 8
    s_add_u32 s31, s31, s30
    s_waitcnt lgkmcnt(0)
    v_pk_add_f32 v[12:13], v[12:13], v[14:15]
    v_pk_add_f32 v[16:17], v[16:17], v[18:19]
    v_pk_add_f32 v[12:13], v[12:13], v[16:17]
    s_mov_b32 exec_hi, 0
    buffer_store_dwordx2 v[12:13], v20, s[8:11], s31 offen sc1
    s_mov_b32 exec_hi, -1
k2_c3_nopub:
    ds_write_b64 v6, v[80:81] offset:0
    ds_write_b64 v6, v[82:83] offset:128
    ds_write_b64 v6, v[84:85] offset:256
    s_mov_b32 s44, 0x20000
k2_c3_poll:
    s_sleep 9
    buffer_load_dwordx2 v[12:13], v7, s[8:11], s30 offen sc1
    s_sub_u32 s44, s44, 1
    s_waitcnt vmcnt(0)
    v_max_u32 v16, v12, v13
    v_cmp_eq_u32 vcc, -1, v16
    s_cmp_eq_u32 s44, 0
    s_cbranch_scc1 k2_c3_polled
    s_cmp_lg_u64 vcc, 0
    s_cbranch_scc1 k2_c3_poll
k2_c3_polled:
    v_mov_b32 v16, v12
    v_mov_b32 v17, v13
    s_nop 0
    v_permlane16_swap_b32 v12, v16
    v_permlane16_swap_b32 v13, v17
    v_add_f32 v12, v12, v16
    v_add_f32 v13, v13, v17
    v_mov_b32 v16, v12
    v_mov_b32 v17, v13
    s_nop 0
    v_permlane32_swap_b32 v12, v16
    v_permlane32_swap_b32 v13, v17
    v_add_f32 v12, v12, v16
    v_add_f32 v13, v13, v17
    v_mul_f32 v12, 0x3ae38e39, v12
    v_mul_f32 v13, 0x3ae38e39, v13
    v_fma_f32 v13, -v12, v12, v13
    v_max_f32 v13, 0, v13
    v_add_f32 v16, 0x3727c5ac, v13
    v_rsq_f32 v16, v16
    s_nop 0
    v_mul_f32 v13, v13, v16
    v_mul_f32 v13, v13, v16
    v_add_f32 v13, 0x3727c5ac, v13
    v_rsq_f32 v13, v13
    s_nop 0
    v_mul_f32 v13, v13, v16
    v_mul_f32 v12, v12, v13
    v_add_u32 v6, 19456, v6
    v_fma_f32 v64, v64, v13, -v12
    v_fma_f32 v65, v65, v13, -v12
    v_fma_f32 v66, v66, v13, -v12
    v_fma_f32 v67, v67, v13, -v12
    v_cvt_pk_bf16_f32 v64, v64, v65
    v_cvt_pk_bf16_f32 v65, v66, v67
    ds_write_b64 v6, v[64:65] offset:0
    v_fma_f32 v68, v68, v13, -v12
    v_fma_f32 v69, v69, v13, -v12
    v_fma_f32 v70, v70, v13, -v12
    v_fma_f32 v71, v71, v13, -v12
    v_cvt_pk_bf16_f32 v68, v68, v69
    v_cvt_pk_bf16_f32 v69, v70, v71
    ds_write_b64 v6, v[68:69] offset:128
    v_fma_f32 v72, v72, v13, -v12
    v_fma_f32 v73, v73, v13, -v12
    v_fma_f32 v74, v74, v13, -v12
    v_fma_f32 v75, v75, v13, -v12
    v_cvt_pk_bf16_f32 v72, v72, v73
    v_cvt_pk_bf16_f32 v73, v74, v75
    ds_write_b64 v6, v[72:73] offset:256
    s_lshl_b32 s21, s12, 5
    s_add_u32 s21, s21, 144384
    v_add_u32 v22, s21, v29
    s_mul_i32 s30, s84, 6144
    s_add_u32 s30, s30, 11796480
    s_mul_i32 s31, s85, 9
    s_add_u32 s24, s31, s12
    s_mul_i32 s25, s24, 43
    s_lshr_b32 s25, s25, 8
    s_mul_i32 s25, s25, 387072
    s_add_u32 s25, s25, s30
    s_lshl_b32 s24, s24, 10
    s_add_u32 s25, s25, s24
    v_mov_b32 v24, v22
    s_lshl_b32 s93, s84, 2
    s_add_u32 s93, s93, s85
    s_mul_i32 s93, s93, 9216
    v_add_u32 v21, s91, v1
    s_waitcnt lgkmcnt(0)
    s_barrier
    v_add_u32 v22, s91, v1
    v_add_u32 v22, 124928, v22
    ds_read_b128 v[48:51], v22
    s_add_u32 s93, s93, 0
    s_cmp_lg_u32 s12, 1
    s_cbranch_scc1 k2_c3_noh8
    v_add_u32 v23, 8192, v1
    v_add_u32 v22, 133120, v1
    ds_read_b128 v[52:55], v22
    s_waitcnt lgkmcnt(0)
    buffer_store_dwordx4 v[52:55], v23, s[8:11], s93 offen sc1
k2_c3_noh8:
    s_waitcnt lgkmcnt(0)
    buffer_store_dwordx4 v[48:51], v21, s[8:11], s93 offen sc1
    v_mov_b32 v22, v24
    ds_read_b64_tr_b16 v[40:41], v22 offset:0
    ds_read_b64_tr_b16 v[42:43], v22 offset:1152
    s_waitcnt lgkmcnt(0)
    buffer_store_dwordx4 v[40:43], v1, s[8:11], s25 offen sc1
    s_cmp_lg_u32 s12, 0
    s_cbranch_scc1 k2_c3_fin
    ds_read_b64_tr_b16 v[44:45], v22 offset:256
    ds_read_b64_tr_b16 v[46:47], v22 offset:1408
    s_add_u32 s24, s31, 8
    s_mul_i32 s25, s24, 43
    s_lshr_b32 s25, s25, 8
    s_mul_i32 s25, s25, 387072
    s_add_u32 s25, s25, s30
    s_lshl_b32 s24, s24, 10
    s_add_u32 s25, s25, s24
    s_waitcnt lgkmcnt(0)
    buffer_store_dwordx4 v[44:47], v1, s[8:11], s25 offen sc1
k2_c3_fin:
    s_mov_b32 s3, s12
    s_lshl_b32 s62, s85, 3
    s_lshr_b32 s63, s84, 3
    s_add_u32 s62, s62, s63
    s_lshl_b32 s62, s62, 7
    s_add_u32 s62, s62, 29319168
    s_barrier
    s_branch k4_entry
k2_c2:
    s_mul_i32 s21, s19, 18432
    s_add_u32 s21, s21, s20
    s_add_u32 s21, s21, s93
    v_mul_u32_u24 v23, 1152, v5
    v_lshl_add_u32 v23, v2, 3, v23
    buffer_load_dwordx2 v[80:81], v23, s[80:83], s21 offen offset:0
    buffer_load_dwordx2 v[82:83], v23, s[80:83], s21 offen offset:128
    v_add_u32 v27, 66560, v28
    ds_read_b64_tr_b16 v[112:113], v27 offset:0
    ds_read_b64_tr_b16 v[114:115], v27 offset:1152
    ds_read_b64_tr_b16 v[116:117], v27 offset:128
    ds_read_b64_tr_b16 v[118:119], v27 offset:1280
    ds_read_b64_tr_b16 v[124:125], v27 offset:9728
    ds_read_b64_tr_b16 v[126:127], v27 offset:10880
    ds_read_b64_tr_b16 v[128:129], v27 offset:9856
    ds_read_b64_tr_b16 v[130:131], v27 offset:11008
    v_add_u32 v27, 86016, v28
    ds_read_b64_tr_b16 v[136:137], v27 offset:0
    ds_read_b64_tr_b16 v[138:139], v27 offset:1152
    ds_read_b64_tr_b16 v[140:141], v27 offset:128
    ds_read_b64_tr_b16 v[142:143], v27 offset:1280
    ds_read_b64_tr_b16 v[148:149], v27 offset:9728
    ds_read_b64_tr_b16 v[150:151], v27 offset:10880
    ds_read_b64_tr_b16 v[152:153], v27 offset:9856
    ds_read_b64_tr_b16 v[154:155], v27 offset:11008
    v_add_u32 v27, 105472, v28
    ds_read_b64_tr_b16 v[160:161], v27 offset:0
    ds_read_b64_tr_b16 v[162:163], v27 offset:1152
    ds_read_b64_tr_b16 v[164:165], v27 offset:128
    ds_read_b64_tr_b16 v[166:167], v27 offset:1280
    ds_read_b64_tr_b16 v[172:173], v27 offset:9728
    ds_read_b64_tr_b16 v[174:175], v27 offset:10880
    ds_read_b64_tr_b16 v[176:177], v27 offset:9856
    ds_read_b64_tr_b16 v[178:179], v27 offset:11008
    s_waitcnt vmcnt(4) lgkmcnt(0)
    s_barrier
    s_add_u32 s92, s90, 580608
    s_add_u32 m0, s91, 105472
    s_nop 0
    buffer_load_dwordx4 v20, s[76:79], s92 offen lds
    s_add_u32 s92, s90, 580608
    s_add_u32 m0, s91, 113664
    s_nop 0
    buffer_load_dwordx4 v21, s[76:79], s92 offen lds
    s_add_u32 s92, s90, 580608
    s_add_u32 s3, s91, 121856
    s_cmp_lt_u32 s12, 3
    s_cselect_b32 m0, s3, 19456
    s_nop 0
    buffer_load_dwordx4 v22, s[76:79], s92 offen lds
    v_mov_b32 v64, 0
    v_mov_b32 v65, 0
    v_mov_b32 v66, 0
    v_mov_b32 v67, 0
    v_mov_b32 v68, 0
    v_mov_b32 v69, 0
    v_mov_b32 v70, 0
    v_mov_b32 v71, 0
    s_mul_i32 s23, s84, 36864
    s_add_u32 s23, s23, 9437184
    v_and_b32 v52, 31, v0
    v_lshlrev_b32 v52, 7, v52
    v_add_u32 v52, 32768, v52
    v_add_u32 v27, s91, v1
    v_add_u32 v27, 66560, v27
    s_mov_b32 s22, 0x20000
    s_branch k2_c2_opolled
k2_c2_opoll:
    buffer_load_dword v56, v52, s[8:11], s23 offen sc1
    s_sub_u32 s22, s22, 1
    s_waitcnt vmcnt(0)
    v_cmp_eq_u32 vcc, -1, v56
    s_cmp_eq_u32 s22, 0
    s_cbranch_scc1 k2_c2_opolled
    s_cmp_eq_u64 vcc, 0
    s_cbranch_scc1 k2_c2_opolled
    s_sleep 3
    s_branch k2_c2_opoll
k2_c2_opolled:
    s_barrier
k2_c2_oload:
    s_add_u32 s21, s23, s91
    buffer_load_dwordx4 v[32:35], v1, s[8:11], s21 offen sc1
    s_add_u32 s21, s21, 8192
    buffer_load_dwordx4 v[36:39], v1, s[8:11], s21 offen sc1
    s_add_u32 s21, s21, 8192
    buffer_load_dwordx4 v[40:43], v1, s[8:11], s21 offen sc1
    s_add_u32 s21, s21, 8192
    buffer_load_dwordx4 v[44:47], v1, s[8:11], s21 offen sc1
    s_add_u32 s21, s21, 8192
    s_cmp_lt_u32 s12, 4
    s_cselect_b32 s21, s21, 0x40000000
    buffer_load_dwordx4 v[48:51], v1, s[8:11], s21 offen sc1
    s_waitcnt vmcnt(0)
    v_max3_u32 v56, v32, v33, v34
    v_max3_u32 v57, v35, v36, v37
    v_max3_u32 v56, v56, v38, v39
    v_max3_u32 v57, v57, v40, v41
    v_max3_u32 v56, v56, v42, v43
    v_max3_u32 v57, v57, v44, v45
    v_max3_u32 v56, v56, v46, v47
    v_max3_u32 v57, v57, v48, v49
    v_max3_u32 v56, v56, v50, v51
    v_max_u32 v56, v56, v57
    v_cmp_eq_u32 vcc, -1, v56
    s_cmp_eq_u32 s22, 0
    s_cbranch_scc1 k2_c2_ovalid
    s_cmp_eq_u64 vcc, 0
    s_cbranch_scc1 k2_c2_ovalid
    s_sub_u32 s22, s22, 1
    s_sleep 3
    s_branch k2_c2_oload
k2_c2_ovalid:
    ds_write_b128 v27, v[32:35] offset:0
    ds_write_b128 v27, v[36:39] offset:8192
    ds_write_b128 v27, v[40:43] offset:16384
    ds_write_b128 v27, v[44:47] offset:24576
    s_cmp_ge_u32 s12, 4
    s_cbranch_scc1 k2_c2_o4
    ds_write_b128 v27, v[48:51] offset:32768
k2_c2_o4:
    s_lshl_b32 s21, s19, 14
    s_add_u32 s21, s21, 66560
    v_add_u32 v19, s21, v1
    s_lshl_b32 s21, s19, 6
    s_add_u32 s21, s21, 99328
    v_lshlrev_b32 v18, 2, v5
    v_lshl_add_u32 v18, v2, 9, v18
    v_add_u32 v18, s21, v18
    s_waitcnt lgkmcnt(0)
    s_barrier
    ds_read_b32 v32, v18 offset:0
    ds_read_b32 v33, v18 offset:128
    ds_read_b32 v34, v18 offset:256
    ds_read_b32 v35, v18 offset:384
    ds_read_b32 v36, v18 offset:2048
    ds_read_b32 v37, v18 offset:2176
    ds_read_b32 v38, v18 offset:2304
    ds_read_b32 v39, v18 offset:2432
    ds_read_b128 v[40:43], v19 offset:0
    s_waitcnt lgkmcnt(5)
    v_mfma_f32_16x16x32_bf16 v[64:67], v[112:115], v[32:35], v[64:67]
    ds_read_b128 v[44:47], v19 offset:1024
    v_mfma_f32_16x16x32_bf16 v[68:71], v[116:119], v[32:35], v[68:71]
    s_waitcnt lgkmcnt(2)
    v_mfma_f32_16x16x32_bf16 v[64:67], v[124:127], v[36:39], v[64:67]
    ds_read_b128 v[48:51], v19 offset:2048
    v_mfma_f32_16x16x32_bf16 v[68:71], v[128:131], v[36:39], v[68:71]
    s_waitcnt lgkmcnt(2)
    v_mfma_f32_16x16x32_bf16 v[64:67], v[136:139], v[40:43], v[64:67]
    ds_read_b128 v[52:55], v19 offset:3072
    v_mfma_f32_16x16x32_bf16 v[68:71], v[140:143], v[40:43], v[68:71]
    s_waitcnt lgkmcnt(2)
    v_mfma_f32_16x16x32_bf16 v[64:67], v[148:151], v[44:47], v[64:67]
    ds_read_b128 v[56:59], v19 offset:4096
    v_add_u32 v31, 124928, v28
    ds_read_b64_tr_b16 v[208:209], v31 offset:0
    v_mfma_f32_16x16x32_bf16 v[68:71], v[152:155], v[44:47], v[68:71]
    ds_read_b64_tr_b16 v[210:211], v31 offset:1152
    ds_read_b64_tr_b16 v[212:213], v31 offset:128
    ds_read_b64_tr_b16 v[214:215], v31 offset:1280
    s_waitcnt lgkmcnt(6)
    v_mfma_f32_16x16x32_bf16 v[64:67], v[160:163], v[48:51], v[64:67]
    ds_read_b128 v[60:63], v19 offset:5120
    ds_read_b64_tr_b16 v[220:221], v31 offset:9728
    ds_read_b64_tr_b16 v[222:223], v31 offset:10880
    v_mfma_f32_16x16x32_bf16 v[68:71], v[164:167], v[48:51], v[68:71]
    ds_read_b64_tr_b16 v[224:225], v31 offset:9856
    ds_read_b64_tr_b16 v[226:227], v31 offset:11008
    s_waitcnt lgkmcnt(10)
    v_mfma_f32_16x16x32_bf16 v[64:67], v[172:175], v[52:55], v[64:67]
    ds_read_b128 v[32:35], v19 offset:6144
    v_add_u32 v30, 144384, v28
    ds_read_b64_tr_b16 v[184:185], v30 offset:0
    v_mfma_f32_16x16x32_bf16 v[68:71], v[176:179], v[52:55], v[68:71]
    ds_read_b64_tr_b16 v[186:187], v30 offset:1152
    ds_read_b64_tr_b16 v[188:189], v30 offset:128
    ds_read_b64_tr_b16 v[190:191], v30 offset:1280
    s_waitcnt lgkmcnt(12)
    v_mfma_f32_16x16x32_bf16 v[64:67], v[208:211], v[56:59], v[64:67]
    ds_read_b128 v[36:39], v19 offset:7168
    ds_read_b64_tr_b16 v[196:197], v30 offset:9728
    ds_read_b64_tr_b16 v[198:199], v30 offset:10880
    s_waitcnt lgkmcnt(13)
    v_mfma_f32_16x16x32_bf16 v[68:71], v[212:215], v[56:59], v[68:71]
    ds_read_b64_tr_b16 v[200:201], v30 offset:9856
    ds_read_b64_tr_b16 v[202:203], v30 offset:11008
    s_waitcnt lgkmcnt(12)
    v_mfma_f32_16x16x32_bf16 v[64:67], v[220:223], v[60:63], v[64:67]
    ds_read_b128 v[40:43], v19 offset:8192
    v_add_u32 v31, 0, v28
    ds_read_b64_tr_b16 v[208:209], v31 offset:0
    s_waitcnt lgkmcnt(12)
    v_mfma_f32_16x16x32_bf16 v[68:71], v[224:227], v[60:63], v[68:71]
    ds_read_b64_tr_b16 v[210:211], v31 offset:1152
    ds_read_b64_tr_b16 v[212:213], v31 offset:128
    ds_read_b64_tr_b16 v[214:215], v31 offset:1280
    s_waitcnt lgkmcnt(12)
    v_mfma_f32_16x16x32_bf16 v[64:67], v[184:187], v[32:35], v[64:67]
    ds_read_b128 v[44:47], v19 offset:9216
    ds_read_b64_tr_b16 v[220:221], v31 offset:9728
    ds_read_b64_tr_b16 v[222:223], v31 offset:10880
    s_waitcnt lgkmcnt(13)
    v_mfma_f32_16x16x32_bf16 v[68:71], v[188:191], v[32:35], v[68:71]
    ds_read_b64_tr_b16 v[224:225], v31 offset:9856
    ds_read_b64_tr_b16 v[226:227], v31 offset:11008
    s_waitcnt lgkmcnt(12)
    v_mfma_f32_16x16x32_bf16 v[64:67], v[196:199], v[36:39], v[64:67]
    ds_read_b128 v[48:51], v19 offset:10240
    v_add_u32 v30, 27648, v28
    ds_read_b64_tr_b16 v[184:185], v30 offset:0
    s_waitcnt lgkmcnt(12)
    v_mfma_f32_16x16x32_bf16 v[68:71], v[200:203], v[36:39], v[68:71]
    ds_read_b64_tr_b16 v[186:187], v30 offset:1152
    ds_read_b64_tr_b16 v[188:189], v30 offset:128
    ds_read_b64_tr_b16 v[190:191], v30 offset:1280
    s_waitcnt lgkmcnt(12)
    v_mfma_f32_16x16x32_bf16 v[64:67], v[208:211], v[40:43], v[64:67]
    ds_read_b128 v[52:55], v19 offset:11264
    ds_read_b64_tr_b16 v[196:197], v30 offset:9728
    ds_read_b64_tr_b16 v[198:199], v30 offset:10880
    s_waitcnt lgkmcnt(13)
    v_mfma_f32_16x16x32_bf16 v[68:71], v[212:215], v[40:43], v[68:71]
    ds_read_b64_tr_b16 v[200:201], v30 offset:9856
    ds_read_b64_tr_b16 v[202:203], v30 offset:11008
    s_waitcnt lgkmcnt(12)
    v_mfma_f32_16x16x32_bf16 v[64:67], v[220:223], v[44:47], v[64:67]
    ds_read_b128 v[56:59], v19 offset:12288
    v_add_u32 v31, 47104, v28
    ds_read_b64_tr_b16 v[208:209], v31 offset:0
    s_waitcnt lgkmcnt(12)
    v_mfma_f32_16x16x32_bf16 v[68:71], v[224:227], v[44:47], v[68:71]
    ds_read_b64_tr_b16 v[210:211], v31 offset:1152
    ds_read_b64_tr_b16 v[212:213], v31 offset:128
    ds_read_b64_tr_b16 v[214:215], v31 offset:1280
    s_waitcnt lgkmcnt(12)
    v_mfma_f32_16x16x32_bf16 v[64:67], v[184:187], v[48:51], v[64:67]
    ds_read_b128 v[60:63], v19 offset:13312
    ds_read_b64_tr_b16 v[220:221], v31 offset:9728
    ds_read_b64_tr_b16 v[222:223], v31 offset:10880
    s_waitcnt lgkmcnt(13)
    v_mfma_f32_16x16x32_bf16 v[68:71], v[188:191], v[48:51], v[68:71]
    ds_read_b64_tr_b16 v[224:225], v31 offset:9856
    ds_read_b64_tr_b16 v[226:227], v31 offset:11008
    s_waitcnt lgkmcnt(12)
    v_mfma_f32_16x16x32_bf16 v[64:67], v[196:199], v[52:55], v[64:67]
    ds_read_b128 v[32:35], v19 offset:14336
    v_add_u32 v30, 105472, v28
    ds_read_b64_tr_b16 v[184:185], v30 offset:0
    s_waitcnt lgkmcnt(12)
    v_mfma_f32_16x16x32_bf16 v[68:71], v[200:203], v[52:55], v[68:71]
    ds_read_b64_tr_b16 v[186:187], v30 offset:1152
    ds_read_b64_tr_b16 v[188:189], v30 offset:128
    ds_read_b64_tr_b16 v[190:191], v30 offset:1280
    s_waitcnt lgkmcnt(12)
    v_mfma_f32_16x16x32_bf16 v[64:67], v[208:211], v[56:59], v[64:67]
    ds_read_b128 v[36:39], v19 offset:15360
    ds_read_b64_tr_b16 v[196:197], v30 offset:9728
    ds_read_b64_tr_b16 v[198:199], v30 offset:10880
    s_waitcnt lgkmcnt(13)
    v_mfma_f32_16x16x32_bf16 v[68:71], v[212:215], v[56:59], v[68:71]
    ds_read_b64_tr_b16 v[200:201], v30 offset:9856
    ds_read_b64_tr_b16 v[202:203], v30 offset:11008
    s_waitcnt lgkmcnt(12)
    v_mfma_f32_16x16x32_bf16 v[64:67], v[220:223], v[60:63], v[64:67]
    s_waitcnt lgkmcnt(10)
    v_mfma_f32_16x16x32_bf16 v[68:71], v[224:227], v[60:63], v[68:71]
    s_waitcnt lgkmcnt(7)
    v_mfma_f32_16x16x32_bf16 v[64:67], v[184:187], v[32:35], v[64:67]
    s_waitcnt lgkmcnt(5)
    v_mfma_f32_16x16x32_bf16 v[68:71], v[188:191], v[32:35], v[68:71]
    s_waitcnt lgkmcnt(2)
    v_mfma_f32_16x16x32_bf16 v[64:67], v[196:199], v[36:39], v[64:67]
    s_waitcnt lgkmcnt(0)
    v_mfma_f32_16x16x32_bf16 v[68:71], v[200:203], v[36:39], v[68:71]
    s_mul_i32 s21, s19, 4608
    s_add_u32 s21, s21, s20
    s_add_u32 s21, s21, 124928
    v_mul_u32_u24 v6, 288, v5
    v_lshl_add_u32 v6, v2, 3, v6
    v_add_u32 v6, s21, v6
    v_mov_b32 v12, 0
    v_mov_b32 v13, 0
    v_lshlrev_b32 v16, 16, v80
    v_and_b32 v17, 0xffff0000, v80
    v_lshlrev_b32 v18, 16, v81
    v_and_b32 v19, 0xffff0000, v81
    v_add_f32 v64, v64, v16
    v_add_f32 v65, v65, v17
    v_add_f32 v66, v66, v18
    v_add_f32 v67, v67, v19
    v_cvt_pk_bf16_f32 v80, v64, v65
    v_cvt_pk_bf16_f32 v81, v66, v67
    v_lshlrev_b32 v64, 16, v80
    v_and_b32 v65, 0xffff0000, v80
    v_lshlrev_b32 v66, 16, v81
    v_and_b32 v67, 0xffff0000, v81
    v_add_f32 v12, v12, v64
    v_fmac_f32 v13, v64, v64
    v_add_f32 v12, v12, v65
    v_fmac_f32 v13, v65, v65
    v_add_f32 v12, v12, v66
    v_fmac_f32 v13, v66, v66
    v_add_f32 v12, v12, v67
    v_fmac_f32 v13, v67, v67
    v_lshlrev_b32 v16, 16, v82
    v_and_b32 v17, 0xffff0000, v82
    v_lshlrev_b32 v18, 16, v83
    v_and_b32 v19, 0xffff0000, v83
    v_add_f32 v68, v68, v16
    v_add_f32 v69, v69, v17
    v_add_f32 v70, v70, v18
    v_add_f32 v71, v71, v19
    v_cvt_pk_bf16_f32 v82, v68, v69
    v_cvt_pk_bf16_f32 v83, v70, v71
    v_lshlrev_b32 v68, 16, v82
    v_and_b32 v69, 0xffff0000, v82
    v_lshlrev_b32 v70, 16, v83
    v_and_b32 v71, 0xffff0000, v83
    v_add_f32 v12, v12, v68
    v_fmac_f32 v13, v68, v68
    v_add_f32 v12, v12, v69
    v_fmac_f32 v13, v69, v69
    v_add_f32 v12, v12, v70
    v_fmac_f32 v13, v70, v70
    v_add_f32 v12, v12, v71
    v_fmac_f32 v13, v71, v71
    v_mov_b32 v16, v12
    v_mov_b32 v17, v13
    s_nop 0
    v_permlane16_swap_b32 v12, v16
    v_permlane16_swap_b32 v13, v17
    v_add_f32 v12, v12, v16
    v_add_f32 v13, v13, v17
    v_mov_b32 v16, v12
    v_mov_b32 v17, v13
    s_nop 0
    v_permlane32_swap_b32 v12, v16
    v_permlane32_swap_b32 v13, v17
    v_add_f32 v12, v12, v16
    v_add_f32 v13, v13, v17
    s_lshl_b32 s21, s18, 8
    s_lshl_b32 s22, s19, 7
    s_add_u32 s21, s21, s22
    s_add_u32 s21, s21, 21504
    v_lshlrev_b32 v7, 3, v5
    v_add_u32 v20, s21, v7
    ds_write_b64 v20, v[12:13]
    s_lshl_b32 s30, s84, 10
    s_add_u32 s30, s30, 29188096
    v_lshl_add_u32 v7, v2, 8, v7
    v_add_u32 v7, s22, v7
    s_waitcnt lgkmcnt(0)
    s_barrier
    ds_write_b64 v6, v[80:81] offset:0
    ds_write_b64 v6, v[82:83] offset:128
    s_mov_b32 s44, 0x20000
k2_c2_poll:
    s_sleep 9
    buffer_load_dwordx2 v[12:13], v7, s[8:11], s30 offen sc1
    s_sub_u32 s44, s44, 1
    s_waitcnt vmcnt(0)
    v_max_u32 v16, v12, v13
    v_cmp_eq_u32 vcc, -1, v16
    s_cmp_eq_u32 s44, 0
    s_cbranch_scc1 k2_c2_polled
    s_cmp_lg_u64 vcc, 0
    s_cbranch_scc1 k2_c2_poll
k2_c2_polled:
    v_mov_b32 v16, v12
    v_mov_b32 v17, v13
    s_nop 0
    v_permlane16_swap_b32 v12, v16
    v_permlane16_swap_b32 v13, v17
    v_add_f32 v12, v12, v16
    v_add_f32 v13, v13, v17
    v_mov_b32 v16, v12
    v_mov_b32 v17, v13
    s_nop 0
    v_permlane32_swap_b32 v12, v16
    v_permlane32_swap_b32 v13, v17
    v_add_f32 v12, v12, v16
    v_add_f32 v13, v13, v17
    v_mul_f32 v12, 0x3ae38e39, v12
    v_mul_f32 v13, 0x3ae38e39, v13
    v_fma_f32 v13, -v12, v12, v13
    v_max_f32 v13, 0, v13
    v_add_f32 v16, 0x3727c5ac, v13
    v_rsq_f32 v16, v16
    s_nop 0
    v_mul_f32 v13, v13, v16
    v_mul_f32 v13, v13, v16
    v_add_f32 v13, 0x3727c5ac, v13
    v_rsq_f32 v13, v13
    s_nop 0
    v_mul_f32 v13, v13, v16
    v_mul_f32 v12, v12, v13
    v_add_u32 v6, 19456, v6
    v_fma_f32 v64, v64, v13, -v12
    v_fma_f32 v65, v65, v13, -v12
    v_fma_f32 v66, v66, v13, -v12
    v_fma_f32 v67, v67, v13, -v12
    v_cvt_pk_bf16_f32 v64, v64, v65
    v_cvt_pk_bf16_f32 v65, v66, v67
    ds_write_b64 v6, v[64:65] offset:0
    v_fma_f32 v68, v68, v13, -v12
    v_fma_f32 v69, v69, v13, -v12
    v_fma_f32 v70, v70, v13, -v12
    v_fma_f32 v71, v71, v13, -v12
    v_cvt_pk_bf16_f32 v68, v68, v69
    v_cvt_pk_bf16_f32 v69, v70, v71
    ds_write_b64 v6, v[68:69] offset:128
    s_lshl_b32 s21, s12, 5
    s_add_u32 s21, s21, 144384
    v_add_u32 v22, s21, v29
    s_mul_i32 s30, s84, 6144
    s_add_u32 s30, s30, 11796480
    s_mul_i32 s31, s85, 9
    s_add_u32 s24, s31, s12
    s_mul_i32 s25, s24, 43
    s_lshr_b32 s25, s25, 8
    s_mul_i32 s25, s25, 387072
    s_add_u32 s25, s25, s30
    s_lshl_b32 s24, s24, 10
    s_add_u32 s25, s25, s24
    v_mov_b32 v24, v22
    s_lshl_b32 s93, s84, 2
    s_add_u32 s93, s93, s85
    s_mul_i32 s93, s93, 9216
    v_add_u32 v21, s91, v1
    s_waitcnt lgkmcnt(0)
    s_barrier
    v_add_u32 v22, s91, v1
    v_add_u32 v22, 124928, v22
    ds_read_b128 v[48:51], v22
    s_add_u32 s93, s93, 0
    s_waitcnt lgkmcnt(0)
    buffer_store_dwordx4 v[48:51], v21, s[8:11], s93 offen sc1
    v_mov_b32 v22, v24
    ds_read_b64_tr_b16 v[40:41], v22 offset:0
    ds_read_b64_tr_b16 v[42:43], v22 offset:1152
    s_waitcnt lgkmcnt(0)
    buffer_store_dwordx4 v[40:43], v1, s[8:11], s25 offen sc1
    s_mov_b32 s3, s12
    s_lshl_b32 s62, s85, 3
    s_lshr_b32 s63, s84, 3
    s_add_u32 s62, s62, s63
    s_lshl_b32 s62, s62, 7
    s_add_u32 s62, s62, 29319168
    s_barrier
    s_branch k4_entry
k2_end:
    s_endpgm
k4_entry:
    s_load_dwordx4 s[32:35], s[0:1], 32
    s_load_dwordx2 s[36:37], s[0:1], 80
    s_load_dwordx2 s[38:39], s[0:1], 48
    s_mov_b32 s20, s3
    s_and_b32 s23, s2, 7
    s_mul_i32 s23, s23, 27
    s_lshr_b32 s28, s2, 3
    s_add_u32 s23, s23, s28
    s_mul_i32 s21, s23, 43691
    s_lshr_b32 s21, s21, 18
    s_mul_i32 s28, s21, 6
    s_sub_u32 s22, s23, s28
    v_lshlrev_b32 v30, 4, v0
    s_cmp_ge_u32 s20, 4
    s_cbranch_scc1 k4_loader
    s_waitcnt vmcnt(0) lgkmcnt(0)
    s_barrier
    s_cmp_ge_u32 s2, 216
    s_cbranch_scc1 k4_pf
    v_lshrrev_b32 v2, 4, v0
    v_bfe_u32 v3, v0, 2, 2
    v_and_b32 v4, 3, v0
    s_lshr_b32 s29, s20, 1
    s_and_b32 s30, s20, 1
    v_lshl_add_u32 v6, v2, 3, v3
    v_and_b32 v7, 1, v2
    v_xor_b32 v24, s29, v7
    v_lshlrev_b32 v24, 7, v24
    v_lshl_add_u32 v24, v6, 8, v24
    v_lshl_add_u32 v24, v4, 3, v24
    v_xor_b32 v25, 0, v3
    v_lshl_add_u32 v8, v25, 5, v24
    v_xor_b32 v25, 1, v3
    v_lshl_add_u32 v9, v25, 5, v24
    v_xor_b32 v25, 2, v3
    v_lshl_add_u32 v10, v25, 5, v24
    v_xor_b32 v25, 3, v3
    v_lshl_add_u32 v11, v25, 5, v24
    s_mul_i32 s31, s30, 3072
    s_add_u32 s31, s31, 98304
    v_add_u32 v12, s31, v30
    v_mov_b32 v64, 0
    v_mov_b32 v65, 0
    v_mov_b32 v66, 0
    v_mov_b32 v67, 0
    v_mov_b32 v68, 0
    v_mov_b32 v69, 0
    v_mov_b32 v70, 0
    v_mov_b32 v71, 0
    v_mov_b32 v72, 0
    v_mov_b32 v73, 0
    v_mov_b32 v74, 0
    v_mov_b32 v75, 0
    v_mov_b32 v76, 0
    v_mov_b32 v77, 0
    v_mov_b32 v78, 0
    v_mov_b32 v79, 0
    v_mov_b32 v80, 0
    v_mov_b32 v81, 0
    v_mov_b32 v82, 0
    v_mov_b32 v83, 0
    v_mov_b32 v84, 0
    v_mov_b32 v85, 0
    v_mov_b32 v86, 0
    v_mov_b32 v87, 0
    v_mov_b32 v88, 0
    v_mov_b32 v89, 0
    v_mov_b32 v90, 0
    v_mov_b32 v91, 0
    v_mov_b32 v92, 0
    v_mov_b32 v93, 0
    v_mov_b32 v94, 0
    v_mov_b32 v95, 0
    v_mov_b32 v96, 0
    v_mov_b32 v97, 0
    v_mov_b32 v98, 0
    v_mov_b32 v99, 0
    v_mov_b32 v100, 0
    v_mov_b32 v101, 0
    v_mov_b32 v102, 0
    v_mov_b32 v103, 0
    v_mov_b32 v104, 0
    v_mov_b32 v105, 0
    v_mov_b32 v106, 0
    v_mov_b32 v107, 0
    v_mov_b32 v108, 0
    v_mov_b32 v109, 0
    v_mov_b32 v110, 0
    v_mov_b32 v111, 0
    s_waitcnt lgkmcnt(0)
    s_mov_b32 s16, s34
    s_and_b32 s17, s35, 0xffff
    s_mov_b32 s18, 0x2400
    s_mov_b32 s19, 0x20000
    s_mov_b32 s12, s36
    s_and_b32 s13, s37, 0xffff
    s_mov_b32 s14, 0x1c06000
    s_mov_b32 s15, 0x20000
    s_lshl_b32 s31, s21, 8
    s_lshl_b32 s28, s29, 7
    s_add_u32 s31, s31, s28
    v_lshlrev_b32 v24, 3, v2
    buffer_load_dwordx2 v[40:41], v24, s[16:19], s31 offen offset:0
    buffer_load_dwordx2 v[42:43], v24, s[16:19], s31 offen offset:32
    buffer_load_dwordx2 v[44:45], v24, s[16:19], s31 offen offset:64
    buffer_load_dwordx2 v[46:47], v24, s[16:19], s31 offen offset:96
    s_barrier
    s_mov_b32 s26, 0
    s_mov_b32 s47, 0
    v_add_u32 v16, s26, v8
    v_add_u32 v17, s26, v9
    v_add_u32 v18, s26, v10
    v_add_u32 v19, s26, v11
    v_add_u32 v20, s47, v12
    s_barrier
    ds_read_b128 v[128:131], v20 offset:0
    ds_read_b64_tr_b16 v[112:113], v16 offset:0
    ds_read_b64_tr_b16 v[114:115], v16 offset:1024
    ds_read_b64_tr_b16 v[116:117], v17 offset:0
    ds_read_b64_tr_b16 v[118:119], v17 offset:1024
    ds_read_b64_tr_b16 v[120:121], v18 offset:0
    ds_read_b64_tr_b16 v[122:123], v18 offset:1024
    ds_read_b64_tr_b16 v[124:125], v19 offset:0
    ds_read_b64_tr_b16 v[126:127], v19 offset:1024
    ds_read_b128 v[132:135], v20 offset:1024
    ds_read_b128 v[136:139], v20 offset:2048
    s_mov_b32 s27, 31
k4_cp_loop:
    s_waitcnt lgkmcnt(8)
    v_mfma_f32_16x16x32_bf16 v[64:67], v[112:115], v[128:131], v[64:67]
    ds_read_b128 v[156:159], v20 offset:6144
    s_waitcnt lgkmcnt(7)
    v_mfma_f32_16x16x32_bf16 v[76:79], v[116:119], v[128:131], v[76:79]
    ds_read_b64_tr_b16 v[140:141], v16 offset:8192
    s_waitcnt lgkmcnt(6)
    v_mfma_f32_16x16x32_bf16 v[88:91], v[120:123], v[128:131], v[88:91]
    ds_read_b64_tr_b16 v[142:143], v16 offset:9216
    s_waitcnt lgkmcnt(5)
    v_mfma_f32_16x16x32_bf16 v[100:103], v[124:127], v[128:131], v[100:103]
    ds_read_b64_tr_b16 v[144:145], v17 offset:8192
    s_waitcnt lgkmcnt(5)
    v_mfma_f32_16x16x32_bf16 v[68:71], v[112:115], v[132:135], v[68:71]
    ds_read_b64_tr_b16 v[146:147], v17 offset:9216
    v_mfma_f32_16x16x32_bf16 v[80:83], v[116:119], v[132:135], v[80:83]
    ds_read_b64_tr_b16 v[148:149], v18 offset:8192
    v_mfma_f32_16x16x32_bf16 v[92:95], v[120:123], v[132:135], v[92:95]
    ds_read_b64_tr_b16 v[150:151], v18 offset:9216
    v_mfma_f32_16x16x32_bf16 v[104:107], v[124:127], v[132:135], v[104:107]
    ds_read_b64_tr_b16 v[152:153], v19 offset:8192
    s_waitcnt lgkmcnt(8)
    v_mfma_f32_16x16x32_bf16 v[72:75], v[112:115], v[136:139], v[72:75]
    ds_read_b64_tr_b16 v[154:155], v19 offset:9216
    v_mfma_f32_16x16x32_bf16 v[84:87], v[116:119], v[136:139], v[84:87]
    ds_read_b128 v[160:163], v20 offset:7168
    v_mfma_f32_16x16x32_bf16 v[96:99], v[120:123], v[136:139], v[96:99]
    ds_read_b128 v[164:167], v20 offset:8192
    v_mfma_f32_16x16x32_bf16 v[108:111], v[124:127], v[136:139], v[108:111]
    s_add_u32 s26, s26, 16384
    s_cmp_eq_u32 s26, 98304
    s_cselect_b32 s26, 0, s26
    s_add_u32 s47, s47, 12288
    s_cmp_eq_u32 s47, 49152
    s_cselect_b32 s47, 0, s47
    s_barrier
    s_waitcnt lgkmcnt(8)
    v_mfma_f32_16x16x32_bf16 v[64:67], v[140:143], v[156:159], v[64:67]
    v_add_u32 v16, s26, v8
    v_add_u32 v17, s26, v9
    s_waitcnt lgkmcnt(6)
    v_mfma_f32_16x16x32_bf16 v[76:79], v[144:147], v[156:159], v[76:79]
    v_add_u32 v18, s26, v10
    s_waitcnt lgkmcnt(4)
    v_mfma_f32_16x16x32_bf16 v[88:91], v[148:151], v[156:159], v[88:91]
    v_add_u32 v19, s26, v11
    s_waitcnt lgkmcnt(2)
    v_mfma_f32_16x16x32_bf16 v[100:103], v[152:155], v[156:159], v[100:103]
    v_add_u32 v20, s47, v12
    ds_read_b128 v[128:131], v20 offset:0
    s_waitcnt lgkmcnt(2)
    v_mfma_f32_16x16x32_bf16 v[68:71], v[140:143], v[160:163], v[68:71]
    ds_read_b64_tr_b16 v[112:113], v16 offset:0
    v_mfma_f32_16x16x32_bf16 v[80:83], v[144:147], v[160:163], v[80:83]
    ds_read_b64_tr_b16 v[114:115], v16 offset:1024
    v_mfma_f32_16x16x32_bf16 v[92:95], v[148:151], v[160:163], v[92:95]
    ds_read_b64_tr_b16 v[116:117], v17 offset:0
    ds_read_b64_tr_b16 v[118:119], v17 offset:1024
    v_mfma_f32_16x16x32_bf16 v[104:107], v[152:155], v[160:163], v[104:107]
    ds_read_b64_tr_b16 v[120:121], v18 offset:0
    s_waitcnt lgkmcnt(6)
    v_mfma_f32_16x16x32_bf16 v[72:75], v[140:143], v[164:167], v[72:75]
    ds_read_b64_tr_b16 v[122:123], v18 offset:1024
    v_mfma_f32_16x16x32_bf16 v[84:87], v[144:147], v[164:167], v[84:87]
    ds_read_b64_tr_b16 v[124:125], v19 offset:0
    ds_read_b64_tr_b16 v[126:127], v19 offset:1024
    v_mfma_f32_16x16x32_bf16 v[96:99], v[148:151], v[164:167], v[96:99]
    ds_read_b128 v[132:135], v20 offset:1024
    v_mfma_f32_16x16x32_bf16 v[108:111], v[152:155], v[164:167], v[108:111]
    ds_read_b128 v[136:139], v20 offset:2048
    s_sub_u32 s27, s27, 1
    s_cmp_lg_u32 s27, 0
    s_cbranch_scc1 k4_cp_loop
    s_waitcnt lgkmcnt(8)
    v_mfma_f32_16x16x32_bf16 v[64:67], v[112:115], v[128:131], v[64:67]
    ds_read_b128 v[156:159], v20 offset:6144
    s_waitcnt lgkmcnt(7)
    v_mfma_f32_16x16x32_bf16 v[76:79], v[116:119], v[128:131], v[76:79]
    ds_read_b64_tr_b16 v[140:141], v16 offset:8192
    s_waitcnt lgkmcnt(6)
    v_mfma_f32_16x16x32_bf16 v[88:91], v[120:123], v[128:131], v[88:91]
    ds_read_b64_tr_b16 v[142:143], v16 offset:9216
    s_waitcnt lgkmcnt(5)
    v_mfma_f32_16x16x32_bf16 v[100:103], v[124:127], v[128:131], v[100:103]
    ds_read_b64_tr_b16 v[144:145], v17 offset:8192
    s_waitcnt lgkmcnt(5)
    v_mfma_f32_16x16x32_bf16 v[68:71], v[112:115], v[132:135], v[68:71]
    ds_read_b64_tr_b16 v[146:147], v17 offset:9216
    v_mfma_f32_16x16x32_bf16 v[80:83], v[116:119], v[132:135], v[80:83]
    ds_read_b64_tr_b16 v[148:149], v18 offset:8192
    v_mfma_f32_16x16x32_bf16 v[92:95], v[120:123], v[132:135], v[92:95]
    ds_read_b64_tr_b16 v[150:151], v18 offset:9216
    v_mfma_f32_16x16x32_bf16 v[104:107], v[124:127], v[132:135], v[104:107]
    ds_read_b64_tr_b16 v[152:153], v19 offset:8192
    s_waitcnt lgkmcnt(8)
    v_mfma_f32_16x16x32_bf16 v[72:75], v[112:115], v[136:139], v[72:75]
    ds_read_b64_tr_b16 v[154:155], v19 offset:9216
    v_mfma_f32_16x16x32_bf16 v[84:87], v[116:119], v[136:139], v[84:87]
    ds_read_b128 v[160:163], v20 offset:7168
    v_mfma_f32_16x16x32_bf16 v[96:99], v[120:123], v[136:139], v[96:99]
    ds_read_b128 v[164:167], v20 offset:8192
    v_mfma_f32_16x16x32_bf16 v[108:111], v[124:127], v[136:139], v[108:111]
    s_waitcnt lgkmcnt(8)
    v_mfma_f32_16x16x32_bf16 v[64:67], v[140:143], v[156:159], v[64:67]
    s_waitcnt lgkmcnt(6)
    v_mfma_f32_16x16x32_bf16 v[76:79], v[144:147], v[156:159], v[76:79]
    s_waitcnt lgkmcnt(4)
    v_mfma_f32_16x16x32_bf16 v[88:91], v[148:151], v[156:159], v[88:91]
    s_waitcnt lgkmcnt(2)
    v_mfma_f32_16x16x32_bf16 v[100:103], v[152:155], v[156:159], v[100:103]
    s_waitcnt lgkmcnt(1)
    v_mfma_f32_16x16x32_bf16 v[68:71], v[140:143], v[160:163], v[68:71]
    v_mfma_f32_16x16x32_bf16 v[80:83], v[144:147], v[160:163], v[80:83]
    v_mfma_f32_16x16x32_bf16 v[92:95], v[148:151], v[160:163], v[92:95]
    v_mfma_f32_16x16x32_bf16 v[104:107], v[152:155], v[160:163], v[104:107]
    s_waitcnt lgkmcnt(0)
    v_mfma_f32_16x16x32_bf16 v[72:75], v[140:143], v[164:167], v[72:75]
    v_mfma_f32_16x16x32_bf16 v[84:87], v[144:147], v[164:167], v[84:87]
    v_mfma_f32_16x16x32_bf16 v[96:99], v[148:151], v[164:167], v[96:99]
    v_mfma_f32_16x16x32_bf16 v[108:111], v[152:155], v[164:167], v[108:111]
    s_barrier
    s_waitcnt vmcnt(0)
    v_lshlrev_b32 v112, 16, v40
    v_and_b32 v113, 0xffff0000, v40
    v_lshlrev_b32 v114, 16, v41
    v_and_b32 v115, 0xffff0000, v41
    v_lshlrev_b32 v116, 16, v42
    v_and_b32 v117, 0xffff0000, v42
    v_lshlrev_b32 v118, 16, v43
    v_and_b32 v119, 0xffff0000, v43
    v_lshlrev_b32 v120, 16, v44
    v_and_b32 v121, 0xffff0000, v44
    v_lshlrev_b32 v122, 16, v45
    v_and_b32 v123, 0xffff0000, v45
    v_lshlrev_b32 v124, 16, v46
    v_and_b32 v125, 0xffff0000, v46
    v_lshlrev_b32 v126, 16, v47
    v_and_b32 v127, 0xffff0000, v47
    s_mov_b32 s40, 0xc0135761
    s_mov_b32 s41, 0xbdd2d3e8
    s_mov_b32 s42, s41
    s_mov_b32 s43, s41
    v_mov_b32 v26, s40
    v_mov_b32 v27, s40
    s_lshl_b32 s31, s21, 1
    s_add_u32 s31, s31, s29
    s_mul_i32 s31, s31, 73728
    s_lshl_b32 s28, s22, 1
    s_add_u32 s28, s28, s30
    s_mul_i32 s28, s28, 3072
    s_add_u32 s31, s31, s28
    s_add_u32 s31, s31, 14155776
    v_pk_add_f32 v[64:65], v[64:65], v[112:113]
    v_pk_add_f32 v[66:67], v[66:67], v[114:115]
    v_pk_add_f32 v[76:77], v[76:77], v[116:117]
    v_pk_add_f32 v[78:79], v[78:79], v[118:119]
    v_pk_mul_f32 v[128:129], v[64:65], v[64:65]
    v_pk_mul_f32 v[130:131], v[66:67], v[66:67]
    v_pk_mul_f32 v[132:133], v[76:77], v[76:77]
    v_pk_mul_f32 v[134:135], v[78:79], v[78:79]
    v_pk_fma_f32 v[128:129], v[128:129], s[42:43], v[26:27]
    v_pk_fma_f32 v[130:131], v[130:131], s[42:43], v[26:27]
    v_pk_fma_f32 v[132:133], v[132:133], s[42:43], v[26:27]
    v_pk_fma_f32 v[134:135], v[134:135], s[42:43], v[26:27]
    v_pk_mul_f32 v[128:129], v[128:129], v[64:65]
    v_pk_mul_f32 v[130:131], v[130:131], v[66:67]
    v_pk_mul_f32 v[132:133], v[132:133], v[76:77]
    v_pk_mul_f32 v[134:135], v[134:135], v[78:79]
    v_exp_f32 v128, v128
    v_exp_f32 v129, v129
    v_exp_f32 v130, v130
    v_exp_f32 v131, v131
    v_exp_f32 v132, v132
    v_exp_f32 v133, v133
    v_exp_f32 v134, v134
    v_exp_f32 v135, v135
    v_pk_add_f32 v[128:129], v[128:129], 1.0 op_sel_hi:[1,0]
    v_pk_add_f32 v[130:131], v[130:131], 1.0 op_sel_hi:[1,0]
    v_pk_add_f32 v[132:133], v[132:133], 1.0 op_sel_hi:[1,0]
    v_pk_add_f32 v[134:135], v[134:135], 1.0 op_sel_hi:[1,0]
    v_rcp_f32 v128, v128
    v_rcp_f32 v129, v129
    v_rcp_f32 v130, v130
    v_rcp_f32 v131, v131
    v_rcp_f32 v132, v132
    v_rcp_f32 v133, v133
    v_rcp_f32 v134, v134
    v_rcp_f32 v135, v135
    v_pk_mul_f32 v[64:65], v[64:65], v[128:129]
    v_pk_mul_f32 v[66:67], v[66:67], v[130:131]
    v_pk_mul_f32 v[76:77], v[76:77], v[132:133]
    v_pk_mul_f32 v[78:79], v[78:79], v[134:135]
    v_cvt_pk_bf16_f32 v136, v64, v65
    v_cvt_pk_bf16_f32 v137, v66, v67
    v_cvt_pk_bf16_f32 v138, v76, v77
    v_cvt_pk_bf16_f32 v139, v78, v79
    buffer_store_dwordx4 v[136:139], v30, s[12:15], s31 offen offset:0 sc1
    v_pk_add_f32 v[68:69], v[68:69], v[112:113]
    v_pk_add_f32 v[70:71], v[70:71], v[114:115]
    v_pk_add_f32 v[80:81], v[80:81], v[116:117]
    v_pk_add_f32 v[82:83], v[82:83], v[118:119]
    v_pk_mul_f32 v[128:129], v[68:69], v[68:69]
    v_pk_mul_f32 v[130:131], v[70:71], v[70:71]
    v_pk_mul_f32 v[132:133], v[80:81], v[80:81]
    v_pk_mul_f32 v[134:135], v[82:83], v[82:83]
    v_pk_fma_f32 v[128:129], v[128:129], s[42:43], v[26:27]
    v_pk_fma_f32 v[130:131], v[130:131], s[42:43], v[26:27]
    v_pk_fma_f32 v[132:133], v[132:133], s[42:43], v[26:27]
    v_pk_fma_f32 v[134:135], v[134:135], s[42:43], v[26:27]
    v_pk_mul_f32 v[128:129], v[128:129], v[68:69]
    v_pk_mul_f32 v[130:131], v[130:131], v[70:71]
    v_pk_mul_f32 v[132:133], v[132:133], v[80:81]
    v_pk_mul_f32 v[134:135], v[134:135], v[82:83]
    v_exp_f32 v128, v128
    v_exp_f32 v129, v129
    v_exp_f32 v130, v130
    v_exp_f32 v131, v131
    v_exp_f32 v132, v132
    v_exp_f32 v133, v133
    v_exp_f32 v134, v134
    v_exp_f32 v135, v135
    v_pk_add_f32 v[128:129], v[128:129], 1.0 op_sel_hi:[1,0]
    v_pk_add_f32 v[130:131], v[130:131], 1.0 op_sel_hi:[1,0]
    v_pk_add_f32 v[132:133], v[132:133], 1.0 op_sel_hi:[1,0]
    v_pk_add_f32 v[134:135], v[134:135], 1.0 op_sel_hi:[1,0]
    v_rcp_f32 v128, v128
    v_rcp_f32 v129, v129
    v_rcp_f32 v130, v130
    v_rcp_f32 v131, v131
    v_rcp_f32 v132, v132
    v_rcp_f32 v133, v133
    v_rcp_f32 v134, v134
    v_rcp_f32 v135, v135
    v_pk_mul_f32 v[68:69], v[68:69], v[128:129]
    v_pk_mul_f32 v[70:71], v[70:71], v[130:131]
    v_pk_mul_f32 v[80:81], v[80:81], v[132:133]
    v_pk_mul_f32 v[82:83], v[82:83], v[134:135]
    v_cvt_pk_bf16_f32 v140, v68, v69
    v_cvt_pk_bf16_f32 v141, v70, v71
    v_cvt_pk_bf16_f32 v142, v80, v81
    v_cvt_pk_bf16_f32 v143, v82, v83
    buffer_store_dwordx4 v[140:143], v30, s[12:15], s31 offen offset:1024 sc1
    v_pk_add_f32 v[72:73], v[72:73], v[112:113]
    v_pk_add_f32 v[74:75], v[74:75], v[114:115]
    v_pk_add_f32 v[84:85], v[84:85], v[116:117]
    v_pk_add_f32 v[86:87], v[86:87], v[118:119]
    v_pk_mul_f32 v[128:129], v[72:73], v[72:73]
    v_pk_mul_f32 v[130:131], v[74:75], v[74:75]
    v_pk_mul_f32 v[132:133], v[84:85], v[84:85]
    v_pk_mul_f32 v[134:135], v[86:87], v[86:87]
    v_pk_fma_f32 v[128:129], v[128:129], s[42:43], v[26:27]
    v_pk_fma_f32 v[130:131], v[130:131], s[42:43], v[26:27]
    v_pk_fma_f32 v[132:133], v[132:133], s[42:43], v[26:27]
    v_pk_fma_f32 v[134:135], v[134:135], s[42:43], v[26:27]
    v_pk_mul_f32 v[128:129], v[128:129], v[72:73]
    v_pk_mul_f32 v[130:131], v[130:131], v[74:75]
    v_pk_mul_f32 v[132:133], v[132:133], v[84:85]
    v_pk_mul_f32 v[134:135], v[134:135], v[86:87]
    v_exp_f32 v128, v128
    v_exp_f32 v129, v129
    v_exp_f32 v130, v130
    v_exp_f32 v131, v131
    v_exp_f32 v132, v132
    v_exp_f32 v133, v133
    v_exp_f32 v134, v134
    v_exp_f32 v135, v135
    v_pk_add_f32 v[128:129], v[128:129], 1.0 op_sel_hi:[1,0]
    v_pk_add_f32 v[130:131], v[130:131], 1.0 op_sel_hi:[1,0]
    v_pk_add_f32 v[132:133], v[132:133], 1.0 op_sel_hi:[1,0]
    v_pk_add_f32 v[134:135], v[134:135], 1.0 op_sel_hi:[1,0]
    v_rcp_f32 v128, v128
    v_rcp_f32 v129, v129
    v_rcp_f32 v130, v130
    v_rcp_f32 v131, v131
    v_rcp_f32 v132, v132
    v_rcp_f32 v133, v133
    v_rcp_f32 v134, v134
    v_rcp_f32 v135, v135
    v_pk_mul_f32 v[72:73], v[72:73], v[128:129]
    v_pk_mul_f32 v[74:75], v[74:75], v[130:131]
    v_pk_mul_f32 v[84:85], v[84:85], v[132:133]
    v_pk_mul_f32 v[86:87], v[86:87], v[134:135]
    v_cvt_pk_bf16_f32 v136, v72, v73
    v_cvt_pk_bf16_f32 v137, v74, v75
    v_cvt_pk_bf16_f32 v138, v84, v85
    v_cvt_pk_bf16_f32 v139, v86, v87
    buffer_store_dwordx4 v[136:139], v30, s[12:15], s31 offen offset:2048 sc1
    s_add_u32 s31, s31, 36864
    v_pk_add_f32 v[88:89], v[88:89], v[120:121]
    v_pk_add_f32 v[90:91], v[90:91], v[122:123]
    v_pk_add_f32 v[100:101], v[100:101], v[124:125]
    v_pk_add_f32 v[102:103], v[102:103], v[126:127]
    v_pk_mul_f32 v[128:129], v[88:89], v[88:89]
    v_pk_mul_f32 v[130:131], v[90:91], v[90:91]
    v_pk_mul_f32 v[132:133], v[100:101], v[100:101]
    v_pk_mul_f32 v[134:135], v[102:103], v[102:103]
    v_pk_fma_f32 v[128:129], v[128:129], s[42:43], v[26:27]
    v_pk_fma_f32 v[130:131], v[130:131], s[42:43], v[26:27]
    v_pk_fma_f32 v[132:133], v[132:133], s[42:43], v[26:27]
    v_pk_fma_f32 v[134:135], v[134:135], s[42:43], v[26:27]
    v_pk_mul_f32 v[128:129], v[128:129], v[88:89]
    v_pk_mul_f32 v[130:131], v[130:131], v[90:91]
    v_pk_mul_f32 v[132:133], v[132:133], v[100:101]
    v_pk_mul_f32 v[134:135], v[134:135], v[102:103]
    v_exp_f32 v128, v128
    v_exp_f32 v129, v129
    v_exp_f32 v130, v130
    v_exp_f32 v131, v131
    v_exp_f32 v132, v132
    v_exp_f32 v133, v133
    v_exp_f32 v134, v134
    v_exp_f32 v135, v135
    v_pk_add_f32 v[128:129], v[128:129], 1.0 op_sel_hi:[1,0]
    v_pk_add_f32 v[130:131], v[130:131], 1.0 op_sel_hi:[1,0]
    v_pk_add_f32 v[132:133], v[132:133], 1.0 op_sel_hi:[1,0]
    v_pk_add_f32 v[134:135], v[134:135], 1.0 op_sel_hi:[1,0]
    v_rcp_f32 v128, v128
    v_rcp_f32 v129, v129
    v_rcp_f32 v130, v130
    v_rcp_f32 v131, v131
    v_rcp_f32 v132, v132
    v_rcp_f32 v133, v133
    v_rcp_f32 v134, v134
    v_rcp_f32 v135, v135
    v_pk_mul_f32 v[88:89], v[88:89], v[128:129]
    v_pk_mul_f32 v[90:91], v[90:91], v[130:131]
    v_pk_mul_f32 v[100:101], v[100:101], v[132:133]
    v_pk_mul_f32 v[102:103], v[102:103], v[134:135]
    v_cvt_pk_bf16_f32 v140, v88, v89
    v_cvt_pk_bf16_f32 v141, v90, v91
    v_cvt_pk_bf16_f32 v142, v100, v101
    v_cvt_pk_bf16_f32 v143, v102, v103
    buffer_store_dwordx4 v[140:143], v30, s[12:15], s31 offen offset:0 sc1
    v_pk_add_f32 v[92:93], v[92:93], v[120:121]
    v_pk_add_f32 v[94:95], v[94:95], v[122:123]
    v_pk_add_f32 v[104:105], v[104:105], v[124:125]
    v_pk_add_f32 v[106:107], v[106:107], v[126:127]
    v_pk_mul_f32 v[128:129], v[92:93], v[92:93]
    v_pk_mul_f32 v[130:131], v[94:95], v[94:95]
    v_pk_mul_f32 v[132:133], v[104:105], v[104:105]
    v_pk_mul_f32 v[134:135], v[106:107], v[106:107]
    v_pk_fma_f32 v[128:129], v[128:129], s[42:43], v[26:27]
    v_pk_fma_f32 v[130:131], v[130:131], s[42:43], v[26:27]
    v_pk_fma_f32 v[132:133], v[132:133], s[42:43], v[26:27]
    v_pk_fma_f32 v[134:135], v[134:135], s[42:43], v[26:27]
    v_pk_mul_f32 v[128:129], v[128:129], v[92:93]
    v_pk_mul_f32 v[130:131], v[130:131], v[94:95]
    v_pk_mul_f32 v[132:133], v[132:133], v[104:105]
    v_pk_mul_f32 v[134:135], v[134:135], v[106:107]
    v_exp_f32 v128, v128
    v_exp_f32 v129, v129
    v_exp_f32 v130, v130
    v_exp_f32 v131, v131
    v_exp_f32 v132, v132
    v_exp_f32 v133, v133
    v_exp_f32 v134, v134
    v_exp_f32 v135, v135
    v_pk_add_f32 v[128:129], v[128:129], 1.0 op_sel_hi:[1,0]
    v_pk_add_f32 v[130:131], v[130:131], 1.0 op_sel_hi:[1,0]
    v_pk_add_f32 v[132:133], v[132:133], 1.0 op_sel_hi:[1,0]
    v_pk_add_f32 v[134:135], v[134:135], 1.0 op_sel_hi:[1,0]
    v_rcp_f32 v128, v128
    v_rcp_f32 v129, v129
    v_rcp_f32 v130, v130
    v_rcp_f32 v131, v131
    v_rcp_f32 v132, v132
    v_rcp_f32 v133, v133
    v_rcp_f32 v134, v134
    v_rcp_f32 v135, v135
    v_pk_mul_f32 v[92:93], v[92:93], v[128:129]
    v_pk_mul_f32 v[94:95], v[94:95], v[130:131]
    v_pk_mul_f32 v[104:105], v[104:105], v[132:133]
    v_pk_mul_f32 v[106:107], v[106:107], v[134:135]
    v_cvt_pk_bf16_f32 v136, v92, v93
    v_cvt_pk_bf16_f32 v137, v94, v95
    v_cvt_pk_bf16_f32 v138, v104, v105
    v_cvt_pk_bf16_f32 v139, v106, v107
    buffer_store_dwordx4 v[136:139], v30, s[12:15], s31 offen offset:1024 sc1
    v_pk_add_f32 v[96:97], v[96:97], v[120:121]
    v_pk_add_f32 v[98:99], v[98:99], v[122:123]
    v_pk_add_f32 v[108:109], v[108:109], v[124:125]
    v_pk_add_f32 v[110:111], v[110:111], v[126:127]
    v_pk_mul_f32 v[128:129], v[96:97], v[96:97]
    v_pk_mul_f32 v[130:131], v[98:99], v[98:99]
    v_pk_mul_f32 v[132:133], v[108:109], v[108:109]
    v_pk_mul_f32 v[134:135], v[110:111], v[110:111]
    v_pk_fma_f32 v[128:129], v[128:129], s[42:43], v[26:27]
    v_pk_fma_f32 v[130:131], v[130:131], s[42:43], v[26:27]
    v_pk_fma_f32 v[132:133], v[132:133], s[42:43], v[26:27]
    v_pk_fma_f32 v[134:135], v[134:135], s[42:43], v[26:27]
    v_pk_mul_f32 v[128:129], v[128:129], v[96:97]
    v_pk_mul_f32 v[130:131], v[130:131], v[98:99]
    v_pk_mul_f32 v[132:133], v[132:133], v[108:109]
    v_pk_mul_f32 v[134:135], v[134:135], v[110:111]
    v_exp_f32 v128, v128
    v_exp_f32 v129, v129
    v_exp_f32 v130, v130
    v_exp_f32 v131, v131
    v_exp_f32 v132, v132
    v_exp_f32 v133, v133
    v_exp_f32 v134, v134
    v_exp_f32 v135, v135
    v_pk_add_f32 v[128:129], v[128:129], 1.0 op_sel_hi:[1,0]
    v_pk_add_f32 v[130:131], v[130:131], 1.0 op_sel_hi:[1,0]
    v_pk_add_f32 v[132:133], v[132:133], 1.0 op_sel_hi:[1,0]
    v_pk_add_f32 v[134:135], v[134:135], 1.0 op_sel_hi:[1,0]
    v_rcp_f32 v128, v128
    v_rcp_f32 v129, v129
    v_rcp_f32 v130, v130
    v_rcp_f32 v131, v131
    v_rcp_f32 v132, v132
    v_rcp_f32 v133, v133
    v_rcp_f32 v134, v134
    v_rcp_f32 v135, v135
    v_pk_mul_f32 v[96:97], v[96:97], v[128:129]
    v_pk_mul_f32 v[98:99], v[98:99], v[130:131]
    v_pk_mul_f32 v[108:109], v[108:109], v[132:133]
    v_pk_mul_f32 v[110:111], v[110:111], v[134:135]
    v_cvt_pk_bf16_f32 v140, v96, v97
    v_cvt_pk_bf16_f32 v141, v98, v99
    v_cvt_pk_bf16_f32 v142, v108, v109
    v_cvt_pk_bf16_f32 v143, v110, v111
    buffer_store_dwordx4 v[140:143], v30, s[12:15], s31 offen offset:2048 sc1
    s_add_u32 s31, s31, 36864
    s_waitcnt vmcnt(0)
    s_branch k5_entry
k4_loader:
    s_sub_u32 s20, s20, 4
    v_lshrrev_b32 v2, 4, v0
    v_and_b32 v3, 15, v0
    v_lshlrev_b32 v4, 1, v2
    v_xor_b32 v4, v3, v4
    v_lshlrev_b32 v4, 4, v4
    v_mul_u32_u24 v5, 9216, v2
    v_add_u32 v8, v4, v5
    v_xor_b32 v4, 128, v4
    v_add_u32 v6, v4, v5
    v_add_u32 v9, 35840, v8
    v_add_u32 v10, 71680, v6
    v_add_u32 v11, 107520, v6
    s_mov_b32 s44, 0
    s_lshl_b32 s24, s44, 2
    s_add_u32 s24, s24, s20
    s_mul_i32 s24, s24, 147456
    s_lshl_b32 s28, s21, 8
    s_add_u32 s24, s24, s28
    s_lshl_b32 s25, s22, 7
    s_lshl_b32 s28, s44, 2
    s_add_u32 s25, s25, s28
    s_add_u32 s25, s25, s20
    s_mul_i32 s25, s25, 3072
    s_add_u32 s25, s25, 11796480
    s_lshl_b32 s29, s20, 12
    s_mul_i32 s30, s20, 3072
    s_add_u32 s30, s30, 98304
    s_mov_b32 s26, 0
    s_mov_b32 s48, 0
    s_waitcnt lgkmcnt(0)
    s_mov_b32 s8, s32
    s_and_b32 s9, s33, 0xffff
    s_mov_b32 s10, 0x1200000
    s_mov_b32 s11, 0x20000
    s_mov_b32 s12, s36
    s_and_b32 s13, s37, 0xffff
    s_mov_b32 s14, 0x1c06000
    s_mov_b32 s15, 0x20000
    s_cmp_lt_u32 s2, 216
    s_cbranch_scc1 k4_ld_main
    s_waitcnt vmcnt(0)
    s_barrier
    s_cmp_lg_u32 s20, 0
    s_cbranch_scc1 k4_pf
    v_mov_b32 v34, 1
    v_lshlrev_b32 v35, 12, v0
    s_mov_b64 exec, 0xff
    buffer_atomic_add v34, v35, s[12:15], s62 offen sc1
    s_mov_b64 exec, -1
    s_branch k4_pf
k4_ld_main:
    s_lshl_b32 s56, s22, 1
    s_add_u32 s57, s56, 1
    s_mul_i32 s56, s56, 86
    s_lshr_b32 s56, s56, 8
    s_mul_i32 s57, s57, 86
    s_lshr_b32 s57, s57, 8
    s_sub_u32 s57, s57, s56
    s_lshl_b32 s57, s57, 10
    s_lshl_b32 s56, s56, 10
    s_add_u32 s56, s56, 29319168
    s_and_b32 s58, s2, 7
    s_lshl_b32 s58, s58, 12
    s_add_u32 s56, s56, s58
    v_and_b32 v32, 7, v0
    v_lshlrev_b32 v32, 7, v32
    v_bfe_u32 v33, v0, 3, 1
    v_mul_u32_u24 v33, s57, v33
    v_add_u32 v32, v32, v33
    s_waitcnt vmcnt(0)
    s_barrier
    s_cmp_eq_u32 s20, 0
    s_cselect_b32 s55, -1, 0
    s_cbranch_scc0 k4_nosig
    v_mov_b32 v34, 1
    v_lshlrev_b32 v35, 12, v0
    s_mov_b64 exec, 0xff
    buffer_atomic_add v34, v35, s[12:15], s62 offen sc1
    s_mov_b64 exec, -1
k4_nosig:
    s_add_u32 m0, s26, s29
    s_nop 0
    buffer_load_dwordx4 v8, s[8:11], s24 offen offset:0 lds
    buffer_load_dwordx4 v9, s[8:11], s24 offen offset:1024 lds
    buffer_load_dwordx4 v10, s[8:11], s24 offen offset:2048 lds
    buffer_load_dwordx4 v11, s[8:11], s24 offen offset:3072 lds
    s_add_u32 s24, s24, 589824
    s_add_u32 s26, s26, 16384
    s_cmp_eq_u32 s26, 98304
    s_cselect_b32 s26, 0, s26
    s_add_u32 m0, s26, s29
    s_nop 0
    buffer_load_dwordx4 v8, s[8:11], s24 offen offset:0 lds
    buffer_load_dwordx4 v9, s[8:11], s24 offen offset:1024 lds
    buffer_load_dwordx4 v10, s[8:11], s24 offen offset:2048 lds
    buffer_load_dwordx4 v11, s[8:11], s24 offen offset:3072 lds
    s_add_u32 s24, s24, 589824
    s_add_u32 s26, s26, 16384
    s_cmp_eq_u32 s26, 98304
    s_cselect_b32 s26, 0, s26
    s_add_u32 m0, s26, s29
    s_nop 0
    buffer_load_dwordx4 v8, s[8:11], s24 offen offset:0 lds
    buffer_load_dwordx4 v9, s[8:11], s24 offen offset:1024 lds
    buffer_load_dwordx4 v10, s[8:11], s24 offen offset:2048 lds
    buffer_load_dwordx4 v11, s[8:11], s24 offen offset:3072 lds
    s_add_u32 s24, s24, 589824
    s_add_u32 s26, s26, 16384
    s_cmp_eq_u32 s26, 98304
    s_cselect_b32 s26, 0, s26
    s_add_u32 m0, s26, s29
    s_nop 0
    buffer_load_dwordx4 v8, s[8:11], s24 offen offset:0 lds
    buffer_load_dwordx4 v9, s[8:11], s24 offen offset:1024 lds
    buffer_load_dwordx4 v10, s[8:11], s24 offen offset:2048 lds
    buffer_load_dwordx4 v11, s[8:11], s24 offen offset:3072 lds
    s_add_u32 s24, s24, 589824
    s_add_u32 s26, s26, 16384
    s_cmp_eq_u32 s26, 98304
    s_cselect_b32 s26, 0, s26
    s_add_u32 m0, s26, s29
    s_nop 0
    buffer_load_dwordx4 v8, s[8:11], s24 offen offset:0 lds
    buffer_load_dwordx4 v9, s[8:11], s24 offen offset:1024 lds
    buffer_load_dwordx4 v10, s[8:11], s24 offen offset:2048 lds
    buffer_load_dwordx4 v11, s[8:11], s24 offen offset:3072 lds
    s_add_u32 s24, s24, 589824
    s_add_u32 s26, s26, 16384
    s_cmp_eq_u32 s26, 98304
    s_cselect_b32 s26, 0, s26
    s_add_u32 m0, s26, s29
    s_nop 0
    buffer_load_dwordx4 v8, s[8:11], s24 offen offset:0 lds
    buffer_load_dwordx4 v9, s[8:11], s24 offen offset:1024 lds
    buffer_load_dwordx4 v10, s[8:11], s24 offen offset:2048 lds
    buffer_load_dwordx4 v11, s[8:11], s24 offen offset:3072 lds
    s_add_u32 s24, s24, 589824
    s_add_u32 s26, s26, 16384
    s_cmp_eq_u32 s26, 98304
    s_cselect_b32 s26, 0, s26
    s_mov_b32 s54, 0xffff
    s_mov_b32 s53, 3
    s_and_b32 s52, s55, s54
    s_cbranch_scc0 k4_rdy0
    s_mov_b32 s58, 0x20000
k4_poll0:
    buffer_load_dword v33, v32, s[12:15], s56 offen sc1
    s_sub_u32 s58, s58, 1
    s_waitcnt vmcnt(0)
    v_cmp_gt_u32 vcc, 8, v33
    s_cmp_eq_u32 s58, 0
    s_cbranch_scc1 k4_rdy0
    s_mov_b32 s55, vcc_lo
    s_and_b32 s52, s55, s54
    s_cbranch_scc0 k4_rdy0
    s_sleep 12
    s_branch k4_poll0
k4_rdy0:
    s_barrier
    s_add_u32 m0, s48, s30
    s_nop 0
    buffer_load_dwordx4 v30, s[12:15], s25 offen offset:0 lds
    buffer_load_dwordx4 v30, s[12:15], s25 offen offset:1024 lds
    buffer_load_dwordx4 v30, s[12:15], s25 offen offset:2048 lds
    s_add_u32 s25, s25, 12288
    s_add_u32 s48, s48, 12288
    s_cmp_eq_u32 s48, 49152
    s_cselect_b32 s48, 0, s48
    s_add_u32 m0, s48, s30
    s_nop 0
    buffer_load_dwordx4 v30, s[12:15], s25 offen offset:0 lds
    buffer_load_dwordx4 v30, s[12:15], s25 offen offset:1024 lds
    buffer_load_dwordx4 v30, s[12:15], s25 offen offset:2048 lds
    s_add_u32 s25, s25, 12288
    s_add_u32 s48, s48, 12288
    s_cmp_eq_u32 s48, 49152
    s_cselect_b32 s48, 0, s48
    s_add_u32 m0, s48, s30
    s_nop 0
    buffer_load_dwordx4 v30, s[12:15], s25 offen offset:0 lds
    buffer_load_dwordx4 v30, s[12:15], s25 offen offset:1024 lds
    buffer_load_dwordx4 v30, s[12:15], s25 offen offset:2048 lds
    s_add_u32 s25, s25, 12288
    s_add_u32 s48, s48, 12288
    s_cmp_eq_u32 s48, 49152
    s_cselect_b32 s48, 0, s48
    s_waitcnt vmcnt(6)
    s_barrier
    s_add_u32 m0, s48, s30
    s_nop 0
    buffer_load_dwordx4 v30, s[12:15], s25 offen offset:0 lds
    buffer_load_dwordx4 v30, s[12:15], s25 offen offset:1024 lds
    buffer_load_dwordx4 v30, s[12:15], s25 offen offset:2048 lds
    s_add_u32 s25, s25, 12288
    s_add_u32 s48, s48, 12288
    s_cmp_eq_u32 s48, 49152
    s_cselect_b32 s48, 0, s48
    s_waitcnt vmcnt(6)
    s_barrier
    s_waitcnt vmcnt(3)
    s_barrier
    s_add_u32 m0, s26, s29
    s_nop 0
    buffer_load_dwordx4 v8, s[8:11], s24 offen offset:0 lds
    buffer_load_dwordx4 v9, s[8:11], s24 offen offset:1024 lds
    buffer_load_dwordx4 v10, s[8:11], s24 offen offset:2048 lds
    buffer_load_dwordx4 v11, s[8:11], s24 offen offset:3072 lds
    s_add_u32 s24, s24, 589824
    s_add_u32 s26, s26, 16384
    s_cmp_eq_u32 s26, 98304
    s_cselect_b32 s26, 0, s26
    s_add_u32 m0, s48, s30
    s_nop 0
    buffer_load_dwordx4 v30, s[12:15], s25 offen offset:0 lds
    buffer_load_dwordx4 v30, s[12:15], s25 offen offset:1024 lds
    buffer_load_dwordx4 v30, s[12:15], s25 offen offset:2048 lds
    s_add_u32 s25, s25, 12288
    s_add_u32 s48, s48, 12288
    s_cmp_eq_u32 s48, 49152
    s_cselect_b32 s48, 0, s48
    s_waitcnt vmcnt(7)
    s_barrier
    s_add_u32 m0, s26, s29
    s_nop 0
    buffer_load_dwordx4 v8, s[8:11], s24 offen offset:0 lds
    buffer_load_dwordx4 v9, s[8:11], s24 offen offset:1024 lds
    buffer_load_dwordx4 v10, s[8:11], s24 offen offset:2048 lds
    buffer_load_dwordx4 v11, s[8:11], s24 offen offset:3072 lds
    s_add_u32 s24, s24, 589824
    s_add_u32 s26, s26, 16384
    s_cmp_eq_u32 s26, 98304
    s_cselect_b32 s26, 0, s26
    s_add_u32 m0, s48, s30
    s_nop 0
    buffer_load_dwordx4 v30, s[12:15], s25 offen offset:0 lds
    buffer_load_dwordx4 v30, s[12:15], s25 offen offset:1024 lds
    buffer_load_dwordx4 v30, s[12:15], s25 offen offset:2048 lds
    s_add_u32 s25, s25, 12288
    s_add_u32 s48, s48, 12288
    s_cmp_eq_u32 s48, 49152
    s_cselect_b32 s48, 0, s48
    s_waitcnt vmcnt(7)
    s_barrier
    s_add_u32 m0, s26, s29
    s_nop 0
    buffer_load_dwordx4 v8, s[8:11], s24 offen offset:0 lds
    buffer_load_dwordx4 v9, s[8:11], s24 offen offset:1024 lds
    buffer_load_dwordx4 v10, s[8:11], s24 offen offset:2048 lds
    buffer_load_dwordx4 v11, s[8:11], s24 offen offset:3072 lds
    s_add_u32 s24, s24, 589824
    s_add_u32 s26, s26, 16384
    s_cmp_eq_u32 s26, 98304
    s_cselect_b32 s26, 0, s26
    s_add_u32 m0, s48, s30
    s_nop 0
    buffer_load_dwordx4 v30, s[12:15], s25 offen offset:0 lds
    buffer_load_dwordx4 v30, s[12:15], s25 offen offset:1024 lds
    buffer_load_dwordx4 v30, s[12:15], s25 offen offset:2048 lds
    s_add_u32 s25, s25, 12288
    s_add_u32 s48, s48, 12288
    s_cmp_eq_u32 s48, 49152
    s_cselect_b32 s48, 0, s48
    s_mov_b32 s27, 23
k4_ld_loop:
    s_waitcnt vmcnt(7)
    s_barrier
    s_add_u32 m0, s26, s29
    s_nop 0
    buffer_load_dwordx4 v8, s[8:11], s24 offen offset:0 lds
    buffer_load_dwordx4 v9, s[8:11], s24 offen offset:1024 lds
    buffer_load_dwordx4 v10, s[8:11], s24 offen offset:2048 lds
    buffer_load_dwordx4 v11, s[8:11], s24 offen offset:3072 lds
    s_add_u32 s24, s24, 589824
    s_add_u32 s26, s26, 16384
    s_cmp_eq_u32 s26, 98304
    s_cselect_b32 s26, 0, s26
    s_add_u32 m0, s48, s30
    s_nop 0
    buffer_load_dwordx4 v30, s[12:15], s25 offen offset:0 lds
    buffer_load_dwordx4 v30, s[12:15], s25 offen offset:1024 lds
    buffer_load_dwordx4 v30, s[12:15], s25 offen offset:2048 lds
    s_add_u32 s25, s25, 12288
    s_add_u32 s48, s48, 12288
    s_cmp_eq_u32 s48, 49152
    s_cselect_b32 s48, 0, s48
    s_sub_u32 s27, s27, 1
    s_cmp_lg_u32 s27, 0
    s_cbranch_scc1 k4_ld_loop
    s_waitcnt vmcnt(7)
    s_barrier
    s_add_u32 m0, s48, s30
    s_nop 0
    buffer_load_dwordx4 v30, s[12:15], s25 offen offset:0 lds
    buffer_load_dwordx4 v30, s[12:15], s25 offen offset:1024 lds
    buffer_load_dwordx4 v30, s[12:15], s25 offen offset:2048 lds
    s_add_u32 s25, s25, 12288
    s_add_u32 s48, s48, 12288
    s_cmp_eq_u32 s48, 49152
    s_cselect_b32 s48, 0, s48
    s_waitcnt vmcnt(3)
    s_barrier
    s_add_u32 m0, s48, s30
    s_nop 0
    buffer_load_dwordx4 v30, s[12:15], s25 offen offset:0 lds
    buffer_load_dwordx4 v30, s[12:15], s25 offen offset:1024 lds
    buffer_load_dwordx4 v30, s[12:15], s25 offen offset:2048 lds
    s_add_u32 s25, s25, 12288
    s_add_u32 s48, s48, 12288
    s_cmp_eq_u32 s48, 49152
    s_cselect_b32 s48, 0, s48
    s_waitcnt vmcnt(3)
    s_barrier
    s_waitcnt vmcnt(0)
    s_barrier
    s_mul_i32 s60, s21, 57
    s_lshr_b32 s60, s60, 9
    s_mul_i32 s60, s60, 9
    s_sub_u32 s60, s21, s60
    s_mul_i32 s59, s23, 128
    s_add_u32 s59, s59, 29286400
    s_barrier
    s_branch k5_entry
k4_pf:
    s_mov_b32 s20, s3
    s_load_dwordx2 s[32:33], s[0:1], 32
    s_load_dwordx2 s[34:35], s[0:1], 48
    v_lshlrev_b32 v2, 4, v0
    s_sub_u32 s24, s2, 216
    s_mul_i32 s24, s24, 8
    s_add_u32 s24, s24, s20
    s_waitcnt lgkmcnt(0)
    s_mov_b32 s8, s32
    s_and_b32 s9, s33, 0xffff
    s_mov_b32 s10, 0x1200000
    s_mov_b32 s11, 0x20000
    s_lshl_b32 s25, s24, 10
    s_add_u32 s25, s25, 14680064
    buffer_load_dwordx4 v[4:7], v2, s[8:11], s25 offen
    s_add_u32 s25, s25, 327680
    buffer_load_dwordx4 v[4:7], v2, s[8:11], s25 offen
    s_add_u32 s25, s25, 327680
    buffer_load_dwordx4 v[4:7], v2, s[8:11], s25 offen
    s_add_u32 s25, s25, 327680
    buffer_load_dwordx4 v[4:7], v2, s[8:11], s25 offen
    s_add_u32 s25, s25, 327680
    buffer_load_dwordx4 v[4:7], v2, s[8:11], s25 offen
    s_add_u32 s25, s25, 327680
    buffer_load_dwordx4 v[4:7], v2, s[8:11], s25 offen
    s_add_u32 s25, s25, 327680
    buffer_load_dwordx4 v[4:7], v2, s[8:11], s25 offen
    s_add_u32 s25, s25, 327680
    buffer_load_dwordx4 v[4:7], v2, s[8:11], s25 offen
    s_add_u32 s25, s25, 327680
    buffer_load_dwordx4 v[4:7], v2, s[8:11], s25 offen
    s_add_u32 s25, s25, 327680
    buffer_load_dwordx4 v[4:7], v2, s[8:11], s25 offen
    s_add_u32 s25, s25, 327680
    buffer_load_dwordx4 v[4:7], v2, s[8:11], s25 offen
    s_add_u32 s25, s25, 327680
    buffer_load_dwordx4 v[4:7], v2, s[8:11], s25 offen
    s_add_u32 s25, s25, 327680
    buffer_load_dwordx4 v[4:7], v2, s[8:11], s25 offen
    s_add_u32 s25, s25, 327680
    s_mov_b32 s8, s34
    s_and_b32 s9, s35, 0xffff
    s_mov_b32 s10, 0x1200000
    s_mov_b32 s11, 0x20000
    s_lshl_b32 s25, s24, 10
    s_add_u32 s25, s25, 0
    buffer_load_dwordx4 v[4:7], v2, s[8:11], s25 offen
    s_add_u32 s25, s25, 327680
    buffer_load_dwordx4 v[4:7], v2, s[8:11], s25 offen
    s_add_u32 s25, s25, 327680
    buffer_load_dwordx4 v[4:7], v2, s[8:11], s25 offen
    s_add_u32 s25, s25, 327680
    buffer_load_dwordx4 v[4:7], v2, s[8:11], s25 offen
    s_add_u32 s25, s25, 327680
    buffer_load_dwordx4 v[4:7], v2, s[8:11], s25 offen
    s_add_u32 s25, s25, 327680
    buffer_load_dwordx4 v[4:7], v2, s[8:11], s25 offen
    s_add_u32 s25, s25, 327680
    buffer_load_dwordx4 v[4:7], v2, s[8:11], s25 offen
    s_add_u32 s25, s25, 327680
    buffer_load_dwordx4 v[4:7], v2, s[8:11], s25 offen
    s_add_u32 s25, s25, 327680
    buffer_load_dwordx4 v[4:7], v2, s[8:11], s25 offen
    s_add_u32 s25, s25, 327680
    buffer_load_dwordx4 v[4:7], v2, s[8:11], s25 offen
    s_add_u32 s25, s25, 327680
    buffer_load_dwordx4 v[4:7], v2, s[8:11], s25 offen
    s_add_u32 s25, s25, 327680
    buffer_load_dwordx4 v[4:7], v2, s[8:11], s25 offen
    s_add_u32 s25, s25, 327680
    buffer_load_dwordx4 v[4:7], v2, s[8:11], s25 offen
    s_add_u32 s25, s25, 327680
    buffer_load_dwordx4 v[4:7], v2, s[8:11], s25 offen
    s_add_u32 s25, s25, 327680
    buffer_load_dwordx4 v[4:7], v2, s[8:11], s25 offen
    s_add_u32 s25, s25, 327680
    buffer_load_dwordx4 v[4:7], v2, s[8:11], s25 offen
    s_add_u32 s25, s25, 327680
    buffer_load_dwordx4 v[4:7], v2, s[8:11], s25 offen
    s_add_u32 s25, s25, 327680
    buffer_load_dwordx4 v[4:7], v2, s[8:11], s25 offen
    s_add_u32 s25, s25, 327680
    buffer_load_dwordx4 v[4:7], v2, s[8:11], s25 offen
    s_add_u32 s25, s25, 327680
    buffer_load_dwordx4 v[4:7], v2, s[8:11], s25 offen
    s_add_u32 s25, s25, 327680
    buffer_load_dwordx4 v[4:7], v2, s[8:11], s25 offen
    s_add_u32 s25, s25, 327680
    buffer_load_dwordx4 v[4:7], v2, s[8:11], s25 offen
    s_add_u32 s25, s25, 327680
    buffer_load_dwordx4 v[4:7], v2, s[8:11], s25 offen
    s_add_u32 s25, s25, 327680
    buffer_load_dwordx4 v[4:7], v2, s[8:11], s25 offen
    s_add_u32 s25, s25, 327680
    buffer_load_dwordx4 v[4:7], v2, s[8:11], s25 offen
    s_add_u32 s25, s25, 327680
    buffer_load_dwordx4 v[4:7], v2, s[8:11], s25 offen
    s_add_u32 s25, s25, 327680
    buffer_load_dwordx4 v[4:7], v2, s[8:11], s25 offen
    s_add_u32 s25, s25, 327680
    buffer_load_dwordx4 v[4:7], v2, s[8:11], s25 offen
    s_add_u32 s25, s25, 327680
    buffer_load_dwordx4 v[4:7], v2, s[8:11], s25 offen
    s_add_u32 s25, s25, 327680
    buffer_load_dwordx4 v[4:7], v2, s[8:11], s25 offen
    s_add_u32 s25, s25, 327680
    buffer_load_dwordx4 v[4:7], v2, s[8:11], s25 offen
    s_add_u32 s25, s25, 327680
    buffer_load_dwordx4 v[4:7], v2, s[8:11], s25 offen
    s_add_u32 s25, s25, 327680
    s_waitcnt vmcnt(24)
    buffer_load_dwordx4 v[4:7], v2, s[8:11], s25 offen
    s_add_u32 s25, s25, 327680
    buffer_load_dwordx4 v[4:7], v2, s[8:11], s25 offen
    s_add_u32 s25, s25, 327680
    buffer_load_dwordx4 v[4:7], v2, s[8:11], s25 offen
    s_add_u32 s25, s25, 327680
    buffer_load_dwordx4 v[4:7], v2, s[8:11], s25 offen
    s_add_u32 s25, s25, 327680
    buffer_load_dwordx4 v[4:7], v2, s[8:11], s25 offen
    s_add_u32 s25, s25, 327680
    buffer_load_dwordx4 v[4:7], v2, s[8:11], s25 offen
    s_add_u32 s25, s25, 327680
    buffer_load_dwordx4 v[4:7], v2, s[8:11], s25 offen
    s_add_u32 s25, s25, 327680
    buffer_load_dwordx4 v[4:7], v2, s[8:11], s25 offen
    s_add_u32 s25, s25, 327680
    buffer_load_dwordx4 v[4:7], v2, s[8:11], s25 offen
    s_add_u32 s25, s25, 327680
    buffer_load_dwordx4 v[4:7], v2, s[8:11], s25 offen
    s_add_u32 s25, s25, 327680
    buffer_load_dwordx4 v[4:7], v2, s[8:11], s25 offen
    s_add_u32 s25, s25, 327680
    buffer_load_dwordx4 v[4:7], v2, s[8:11], s25 offen
    s_add_u32 s25, s25, 327680
    buffer_load_dwordx4 v[4:7], v2, s[8:11], s25 offen
    s_add_u32 s25, s25, 327680
    buffer_load_dwordx4 v[4:7], v2, s[8:11], s25 offen
    s_add_u32 s25, s25, 327680
    buffer_load_dwordx4 v[4:7], v2, s[8:11], s25 offen
    s_add_u32 s25, s25, 327680
    buffer_load_dwordx4 v[4:7], v2, s[8:11], s25 offen
    s_add_u32 s25, s25, 327680
    buffer_load_dwordx4 v[4:7], v2, s[8:11], s25 offen
    s_add_u32 s25, s25, 327680
    buffer_load_dwordx4 v[4:7], v2, s[8:11], s25 offen
    s_add_u32 s25, s25, 327680
    buffer_load_dwordx4 v[4:7], v2, s[8:11], s25 offen
    s_add_u32 s25, s25, 327680
    buffer_load_dwordx4 v[4:7], v2, s[8:11], s25 offen
    s_add_u32 s25, s25, 327680
    buffer_load_dwordx4 v[4:7], v2, s[8:11], s25 offen
    s_add_u32 s25, s25, 327680
    buffer_load_dwordx4 v[4:7], v2, s[8:11], s25 offen
    s_add_u32 s25, s25, 327680
    buffer_load_dwordx4 v[4:7], v2, s[8:11], s25 offen
    s_add_u32 s25, s25, 327680
    buffer_load_dwordx4 v[4:7], v2, s[8:11], s25 offen
    s_add_u32 s25, s25, 327680
    buffer_load_dwordx4 v[4:7], v2, s[8:11], s25 offen
    s_add_u32 s25, s25, 327680
    buffer_load_dwordx4 v[4:7], v2, s[8:11], s25 offen
    s_add_u32 s25, s25, 327680
    s_waitcnt vmcnt(0)
    s_mov_b32 s3, s20
    s_mov_b32 s60, 0
    s_mov_b32 s59, 0x40000000
    s_branch k5_entry
k4_end:
    s_endpgm
k5_entry:
    s_load_dwordx4 s[32:35], s[0:1], 48
    s_load_dwordx2 s[36:37], s[0:1], 80
    s_load_dwordx2 s[38:39], s[0:1], 64
    s_mov_b32 s20, s3
    s_bfe_u32 s23, s2, 0x20001
    s_bfe_u32 s22, s2, 0x20003
    s_and_b32 s21, s2, 1
    s_lshl_b32 s21, s21, 3
    s_lshr_b32 s28, s2, 5
    s_add_u32 s21, s21, s28
    v_lshlrev_b32 v30, 4, v0
    s_cmp_ge_u32 s20, 4
    s_cbranch_scc1 k5_loader
    s_barrier
    v_lshrrev_b32 v2, 4, v0
    v_bfe_u32 v3, v0, 2, 2
    v_and_b32 v4, 3, v0
    v_mov_b32 v8, v30
    v_lshl_add_u32 v6, v2, 2, v3
    v_and_b32 v7, 7, v6
    v_lshlrev_b32 v24, 8, v6
    v_lshl_add_u32 v24, v4, 3, v24
    v_add_u32 v24, 73728, v24
    s_lshl_b32 s31, s20, 1
    s_add_u32 s31, s31, 0
    v_xor_b32 v25, s31, v7
    v_lshl_add_u32 v9, v25, 5, v24
    s_lshl_b32 s31, s20, 1
    s_add_u32 s31, s31, 1
    v_xor_b32 v25, s31, v7
    v_lshl_add_u32 v10, v25, 5, v24
    v_mov_b32 v64, 0
    v_mov_b32 v65, 0
    v_mov_b32 v66, 0
    v_mov_b32 v67, 0
    v_mov_b32 v68, 0
    v_mov_b32 v69, 0
    v_mov_b32 v70, 0
    v_mov_b32 v71, 0
    v_mov_b32 v72, 0
    v_mov_b32 v73, 0
    v_mov_b32 v74, 0
    v_mov_b32 v75, 0
    v_mov_b32 v76, 0
    v_mov_b32 v77, 0
    v_mov_b32 v78, 0
    v_mov_b32 v79, 0
    v_mov_b32 v80, 0
    v_mov_b32 v81, 0
    v_mov_b32 v82, 0
    v_mov_b32 v83, 0
    v_mov_b32 v84, 0
    v_mov_b32 v85, 0
    v_mov_b32 v86, 0
    v_mov_b32 v87, 0
    v_mov_b32 v88, 0
    v_mov_b32 v89, 0
    v_mov_b32 v90, 0
    v_mov_b32 v91, 0
    v_mov_b32 v92, 0
    v_mov_b32 v93, 0
    v_mov_b32 v94, 0
    v_mov_b32 v95, 0
    v_mov_b32 v96, 0
    v_mov_b32 v97, 0
    v_mov_b32 v98, 0
    v_mov_b32 v99, 0
    v_mov_b32 v100, 0
    v_mov_b32 v101, 0
    v_mov_b32 v102, 0
    v_mov_b32 v103, 0
    v_mov_b32 v104, 0
    v_mov_b32 v105, 0
    v_mov_b32 v106, 0
    v_mov_b32 v107, 0
    v_mov_b32 v108, 0
    v_mov_b32 v109, 0
    v_mov_b32 v110, 0
    v_mov_b32 v111, 0
    v_mov_b32 v112, 0
    v_mov_b32 v113, 0
    v_mov_b32 v114, 0
    v_mov_b32 v115, 0
    v_mov_b32 v116, 0
    v_mov_b32 v117, 0
    v_mov_b32 v118, 0
    v_mov_b32 v119, 0
    v_mov_b32 v120, 0
    v_mov_b32 v121, 0
    v_mov_b32 v122, 0
    v_mov_b32 v123, 0
    v_mov_b32 v124, 0
    v_mov_b32 v125, 0
    v_mov_b32 v126, 0
    v_mov_b32 v127, 0
    v_mov_b32 v128, 0
    v_mov_b32 v129, 0
    v_mov_b32 v130, 0
    v_mov_b32 v131, 0
    v_mov_b32 v132, 0
    v_mov_b32 v133, 0
    v_mov_b32 v134, 0
    v_mov_b32 v135, 0
    s_waitcnt lgkmcnt(0)
    s_mov_b32 s16, s34
    s_and_b32 s17, s35, 0xffff
    s_mov_b32 s18, 0x1000
    s_mov_b32 s19, 0x20000
    s_mov_b32 s12, s36
    s_and_b32 s13, s37, 0xffff
    s_mov_b32 s14, 0x1c06000
    s_mov_b32 s15, 0x20000
    s_mov_b32 s44, s38
    s_and_b32 s45, s39, 0xffff
    s_mov_b32 s46, 0x240000
    s_mov_b32 s47, 0x20000
    s_lshl_b32 s31, s21, 8
    s_lshl_b32 s28, s23, 6
    s_add_u32 s31, s31, s28
    v_and_b32 v26, 15, v0
    v_lshlrev_b32 v24, 1, v26
    buffer_load_ushort v40, v24, s[16:19], s31 offen offset:0
    buffer_load_ushort v41, v24, s[16:19], s31 offen offset:32
    s_barrier
    s_mov_b32 s26, 0
    s_mov_b32 s42, 0
    v_add_u32 v12, s42, v8
    v_add_u32 v13, s26, v9
    v_add_u32 v14, s26, v10
    s_barrier
    ds_read_b128 v[136:139], v12 offset:0
    ds_read_b64_tr_b16 v[172:173], v13 offset:0
    ds_read_b64_tr_b16 v[174:175], v13 offset:4096
    ds_read_b64_tr_b16 v[176:177], v14 offset:0
    ds_read_b64_tr_b16 v[178:179], v14 offset:4096
    ds_read_b128 v[140:143], v12 offset:1024
    ds_read_b128 v[144:147], v12 offset:2048
    ds_read_b128 v[148:151], v12 offset:3072
    ds_read_b128 v[152:155], v12 offset:4096
    ds_read_b128 v[156:159], v12 offset:5120
    ds_read_b128 v[160:163], v12 offset:6144
    ds_read_b128 v[164:167], v12 offset:7168
    ds_read_b128 v[168:171], v12 offset:8192
    s_mov_b32 s27, 17
k5_cp_loop:
    s_waitcnt lgkmcnt(10)
    v_mfma_f32_16x16x32_bf16 v[64:67], v[136:139], v[172:175], v[64:67]
    ds_read_b128 v[180:183], v12 offset:9216
    s_waitcnt lgkmcnt(9)
    v_mfma_f32_16x16x32_bf16 v[68:71], v[136:139], v[176:179], v[68:71]
    ds_read_b64_tr_b16 v[216:217], v13 offset:8192
    s_waitcnt lgkmcnt(9)
    v_mfma_f32_16x16x32_bf16 v[72:75], v[140:143], v[172:175], v[72:75]
    ds_read_b64_tr_b16 v[218:219], v13 offset:12288
    v_mfma_f32_16x16x32_bf16 v[76:79], v[140:143], v[176:179], v[76:79]
    s_waitcnt lgkmcnt(9)
    v_mfma_f32_16x16x32_bf16 v[80:83], v[144:147], v[172:175], v[80:83]
    ds_read_b64_tr_b16 v[220:221], v14 offset:8192
    v_mfma_f32_16x16x32_bf16 v[84:87], v[144:147], v[176:179], v[84:87]
    ds_read_b64_tr_b16 v[222:223], v14 offset:12288
    s_waitcnt lgkmcnt(10)
    v_mfma_f32_16x16x32_bf16 v[88:91], v[148:151], v[172:175], v[88:91]
    ds_read_b128 v[184:187], v12 offset:10240
    v_mfma_f32_16x16x32_bf16 v[92:95], v[148:151], v[176:179], v[92:95]
    s_waitcnt lgkmcnt(10)
    v_mfma_f32_16x16x32_bf16 v[96:99], v[152:155], v[172:175], v[96:99]
    ds_read_b128 v[188:191], v12 offset:11264
    v_mfma_f32_16x16x32_bf16 v[100:103], v[152:155], v[176:179], v[100:103]
    ds_read_b128 v[192:195], v12 offset:12288
    s_waitcnt lgkmcnt(11)
    v_mfma_f32_16x16x32_bf16 v[104:107], v[156:159], v[172:175], v[104:107]
    v_mfma_f32_16x16x32_bf16 v[108:111], v[156:159], v[176:179], v[108:111]
    ds_read_b128 v[196:199], v12 offset:13312
    s_waitcnt lgkmcnt(11)
    v_mfma_f32_16x16x32_bf16 v[112:115], v[160:163], v[172:175], v[112:115]
    ds_read_b128 v[200:203], v12 offset:14336
    v_mfma_f32_16x16x32_bf16 v[116:119], v[160:163], v[176:179], v[116:119]
    ds_read_b128 v[204:207], v12 offset:15360
    s_waitcnt lgkmcnt(12)
    v_mfma_f32_16x16x32_bf16 v[120:123], v[164:167], v[172:175], v[120:123]
    v_mfma_f32_16x16x32_bf16 v[124:127], v[164:167], v[176:179], v[124:127]
    ds_read_b128 v[208:211], v12 offset:16384
    s_waitcnt lgkmcnt(12)
    v_mfma_f32_16x16x32_bf16 v[128:131], v[168:171], v[172:175], v[128:131]
    ds_read_b128 v[212:215], v12 offset:17408
    v_mfma_f32_16x16x32_bf16 v[132:135], v[168:171], v[176:179], v[132:135]
    s_add_u32 s26, s26, 16384
    s_cmp_eq_u32 s26, 81920
    s_cselect_b32 s26, 0, s26
    s_add_u32 s42, s42, 18432
    s_cmp_eq_u32 s42, 73728
    s_cselect_b32 s42, 0, s42
    s_barrier
    s_waitcnt lgkmcnt(10)
    v_mfma_f32_16x16x32_bf16 v[64:67], v[180:183], v[216:219], v[64:67]
    v_add_u32 v12, s42, v8
    s_waitcnt lgkmcnt(8)
    v_mfma_f32_16x16x32_bf16 v[68:71], v[180:183], v[220:223], v[68:71]
    v_add_u32 v13, s26, v9
    s_waitcnt lgkmcnt(7)
    v_mfma_f32_16x16x32_bf16 v[72:75], v[184:187], v[216:219], v[72:75]
    v_add_u32 v14, s26, v10
    v_mfma_f32_16x16x32_bf16 v[76:79], v[184:187], v[220:223], v[76:79]
    ds_read_b128 v[136:139], v12 offset:0
    s_waitcnt lgkmcnt(7)
    v_mfma_f32_16x16x32_bf16 v[80:83], v[188:191], v[216:219], v[80:83]
    ds_read_b64_tr_b16 v[172:173], v13 offset:0
    v_mfma_f32_16x16x32_bf16 v[84:87], v[188:191], v[220:223], v[84:87]
    ds_read_b64_tr_b16 v[174:175], v13 offset:4096
    s_waitcnt lgkmcnt(8)
    v_mfma_f32_16x16x32_bf16 v[88:91], v[192:195], v[216:219], v[88:91]
    ds_read_b64_tr_b16 v[176:177], v14 offset:0
    v_mfma_f32_16x16x32_bf16 v[92:95], v[192:195], v[220:223], v[92:95]
    ds_read_b64_tr_b16 v[178:179], v14 offset:4096
    s_waitcnt lgkmcnt(9)
    v_mfma_f32_16x16x32_bf16 v[96:99], v[196:199], v[216:219], v[96:99]
    v_mfma_f32_16x16x32_bf16 v[100:103], v[196:199], v[220:223], v[100:103]
    ds_read_b128 v[140:143], v12 offset:1024
    s_waitcnt lgkmcnt(9)
    v_mfma_f32_16x16x32_bf16 v[104:107], v[200:203], v[216:219], v[104:107]
    ds_read_b128 v[144:147], v12 offset:2048
    v_mfma_f32_16x16x32_bf16 v[108:111], v[200:203], v[220:223], v[108:111]
    ds_read_b128 v[148:151], v12 offset:3072
    s_waitcnt lgkmcnt(10)
    v_mfma_f32_16x16x32_bf16 v[112:115], v[204:207], v[216:219], v[112:115]
    ds_read_b128 v[152:155], v12 offset:4096
    v_mfma_f32_16x16x32_bf16 v[116:119], v[204:207], v[220:223], v[116:119]
    ds_read_b128 v[156:159], v12 offset:5120
    s_waitcnt lgkmcnt(11)
    v_mfma_f32_16x16x32_bf16 v[120:123], v[208:211], v[216:219], v[120:123]
    ds_read_b128 v[160:163], v12 offset:6144
    v_mfma_f32_16x16x32_bf16 v[124:127], v[208:211], v[220:223], v[124:127]
    ds_read_b128 v[164:167], v12 offset:7168
    s_waitcnt lgkmcnt(12)
    v_mfma_f32_16x16x32_bf16 v[128:131], v[212:215], v[216:219], v[128:131]
    ds_read_b128 v[168:171], v12 offset:8192
    v_mfma_f32_16x16x32_bf16 v[132:135], v[212:215], v[220:223], v[132:135]
    s_sub_u32 s27, s27, 1
    s_cmp_lg_u32 s27, 0
    s_cbranch_scc1 k5_cp_loop
    s_waitcnt lgkmcnt(10)
    v_mfma_f32_16x16x32_bf16 v[64:67], v[136:139], v[172:175], v[64:67]
    ds_read_b128 v[180:183], v12 offset:9216
    s_waitcnt lgkmcnt(9)
    v_mfma_f32_16x16x32_bf16 v[68:71], v[136:139], v[176:179], v[68:71]
    ds_read_b64_tr_b16 v[216:217], v13 offset:8192
    s_waitcnt lgkmcnt(9)
    v_mfma_f32_16x16x32_bf16 v[72:75], v[140:143], v[172:175], v[72:75]
    ds_read_b64_tr_b16 v[218:219], v13 offset:12288
    v_mfma_f32_16x16x32_bf16 v[76:79], v[140:143], v[176:179], v[76:79]
    s_waitcnt lgkmcnt(9)
    v_mfma_f32_16x16x32_bf16 v[80:83], v[144:147], v[172:175], v[80:83]
    ds_read_b64_tr_b16 v[220:221], v14 offset:8192
    v_mfma_f32_16x16x32_bf16 v[84:87], v[144:147], v[176:179], v[84:87]
    ds_read_b64_tr_b16 v[222:223], v14 offset:12288
    s_waitcnt lgkmcnt(10)
    v_mfma_f32_16x16x32_bf16 v[88:91], v[148:151], v[172:175], v[88:91]
    ds_read_b128 v[184:187], v12 offset:10240
    v_mfma_f32_16x16x32_bf16 v[92:95], v[148:151], v[176:179], v[92:95]
    s_waitcnt lgkmcnt(10)
    v_mfma_f32_16x16x32_bf16 v[96:99], v[152:155], v[172:175], v[96:99]
    ds_read_b128 v[188:191], v12 offset:11264
    v_mfma_f32_16x16x32_bf16 v[100:103], v[152:155], v[176:179], v[100:103]
    ds_read_b128 v[192:195], v12 offset:12288
    s_waitcnt lgkmcnt(11)
    v_mfma_f32_16x16x32_bf16 v[104:107], v[156:159], v[172:175], v[104:107]
    v_mfma_f32_16x16x32_bf16 v[108:111], v[156:159], v[176:179], v[108:111]
    ds_read_b128 v[196:199], v12 offset:13312
    s_waitcnt lgkmcnt(11)
    v_mfma_f32_16x16x32_bf16 v[112:115], v[160:163], v[172:175], v[112:115]
    ds_read_b128 v[200:203], v12 offset:14336
    v_mfma_f32_16x16x32_bf16 v[116:119], v[160:163], v[176:179], v[116:119]
    ds_read_b128 v[204:207], v12 offset:15360
    s_waitcnt lgkmcnt(12)
    v_mfma_f32_16x16x32_bf16 v[120:123], v[164:167], v[172:175], v[120:123]
    v_mfma_f32_16x16x32_bf16 v[124:127], v[164:167], v[176:179], v[124:127]
    ds_read_b128 v[208:211], v12 offset:16384
    s_waitcnt lgkmcnt(12)
    v_mfma_f32_16x16x32_bf16 v[128:131], v[168:171], v[172:175], v[128:131]
    ds_read_b128 v[212:215], v12 offset:17408
    v_mfma_f32_16x16x32_bf16 v[132:135], v[168:171], v[176:179], v[132:135]
    s_waitcnt lgkmcnt(10)
    v_mfma_f32_16x16x32_bf16 v[64:67], v[180:183], v[216:219], v[64:67]
    s_waitcnt lgkmcnt(8)
    v_mfma_f32_16x16x32_bf16 v[68:71], v[180:183], v[220:223], v[68:71]
    s_waitcnt lgkmcnt(7)
    v_mfma_f32_16x16x32_bf16 v[72:75], v[184:187], v[216:219], v[72:75]
    v_mfma_f32_16x16x32_bf16 v[76:79], v[184:187], v[220:223], v[76:79]
    s_waitcnt lgkmcnt(6)
    v_mfma_f32_16x16x32_bf16 v[80:83], v[188:191], v[216:219], v[80:83]
    v_mfma_f32_16x16x32_bf16 v[84:87], v[188:191], v[220:223], v[84:87]
    s_waitcnt lgkmcnt(5)
    v_mfma_f32_16x16x32_bf16 v[88:91], v[192:195], v[216:219], v[88:91]
    v_mfma_f32_16x16x32_bf16 v[92:95], v[192:195], v[220:223], v[92:95]
    s_waitcnt lgkmcnt(4)
    v_mfma_f32_16x16x32_bf16 v[96:99], v[196:199], v[216:219], v[96:99]
    v_mfma_f32_16x16x32_bf16 v[100:103], v[196:199], v[220:223], v[100:103]
    s_waitcnt lgkmcnt(3)
    v_mfma_f32_16x16x32_bf16 v[104:107], v[200:203], v[216:219], v[104:107]
    v_mfma_f32_16x16x32_bf16 v[108:111], v[200:203], v[220:223], v[108:111]
    s_waitcnt lgkmcnt(2)
    v_mfma_f32_16x16x32_bf16 v[112:115], v[204:207], v[216:219], v[112:115]
    v_mfma_f32_16x16x32_bf16 v[116:119], v[204:207], v[220:223], v[116:119]
    s_waitcnt lgkmcnt(1)
    v_mfma_f32_16x16x32_bf16 v[120:123], v[208:211], v[216:219], v[120:123]
    v_mfma_f32_16x16x32_bf16 v[124:127], v[208:211], v[220:223], v[124:127]
    s_waitcnt lgkmcnt(0)
    v_mfma_f32_16x16x32_bf16 v[128:131], v[212:215], v[216:219], v[128:131]
    v_mfma_f32_16x16x32_bf16 v[132:135], v[212:215], v[220:223], v[132:135]
    s_lshl_b32 s50, s21, 2
    s_add_u32 s50, s50, s22
    s_mul_i32 s51, s50, 151552
    s_add_u32 s51, s51, 19464192
    s_lshl_b32 s53, s50, 9
    s_add_u32 s53, s53, 29253632
    s_cmp_eq_u32 s20, s23
    s_cbranch_scc1 k5_own
    s_lshl_b32 s52, s20, 2
    s_add_u32 s52, s52, s23
    s_mul_i32 s52, s52, 9472
    s_add_u32 s52, s52, s51
    v_cvt_pk_bf16_f32 v64, v64, v65
    v_cvt_pk_bf16_f32 v65, v66, v67
    v_cvt_pk_bf16_f32 v66, v68, v69
    v_cvt_pk_bf16_f32 v67, v70, v71
    buffer_store_dwordx4 v[64:67], v30, s[12:15], s52 offen offset:0 sc1
    v_cvt_pk_bf16_f32 v72, v72, v73
    v_cvt_pk_bf16_f32 v73, v74, v75
    v_cvt_pk_bf16_f32 v74, v76, v77
    v_cvt_pk_bf16_f32 v75, v78, v79
    buffer_store_dwordx4 v[72:75], v30, s[12:15], s52 offen offset:1024 sc1
    v_cvt_pk_bf16_f32 v80, v80, v81
    v_cvt_pk_bf16_f32 v81, v82, v83
    v_cvt_pk_bf16_f32 v82, v84, v85
    v_cvt_pk_bf16_f32 v83, v86, v87
    buffer_store_dwordx4 v[80:83], v30, s[12:15], s52 offen offset:2048 sc1
    v_cvt_pk_bf16_f32 v88, v88, v89
    v_cvt_pk_bf16_f32 v89, v90, v91
    v_cvt_pk_bf16_f32 v90, v92, v93
    v_cvt_pk_bf16_f32 v91, v94, v95
    buffer_store_dwordx4 v[88:91], v30, s[12:15], s52 offen offset:3072 sc1
    v_cvt_pk_bf16_f32 v96, v96, v97
    v_cvt_pk_bf16_f32 v97, v98, v99
    v_cvt_pk_bf16_f32 v98, v100, v101
    v_cvt_pk_bf16_f32 v99, v102, v103
    s_add_u32 s52, s52, 4096
    buffer_store_dwordx4 v[96:99], v30, s[12:15], s52 offen offset:0 sc1
    v_cvt_pk_bf16_f32 v104, v104, v105
    v_cvt_pk_bf16_f32 v105, v106, v107
    v_cvt_pk_bf16_f32 v106, v108, v109
    v_cvt_pk_bf16_f32 v107, v110, v111
    buffer_store_dwordx4 v[104:107], v30, s[12:15], s52 offen offset:1024 sc1
    v_cvt_pk_bf16_f32 v112, v112, v113
    v_cvt_pk_bf16_f32 v113, v114, v115
    v_cvt_pk_bf16_f32 v114, v116, v117
    v_cvt_pk_bf16_f32 v115, v118, v119
    buffer_store_dwordx4 v[112:115], v30, s[12:15], s52 offen offset:2048 sc1
    v_cvt_pk_bf16_f32 v120, v120, v121
    v_cvt_pk_bf16_f32 v121, v122, v123
    v_cvt_pk_bf16_f32 v122, v124, v125
    v_cvt_pk_bf16_f32 v123, v126, v127
    buffer_store_dwordx4 v[120:123], v30, s[12:15], s52 offen offset:3072 sc1
    v_cvt_pk_bf16_f32 v128, v128, v129
    v_cvt_pk_bf16_f32 v129, v130, v131
    v_cvt_pk_bf16_f32 v130, v132, v133
    v_cvt_pk_bf16_f32 v131, v134, v135
    s_add_u32 s52, s52, 4096
    buffer_store_dwordx4 v[128:131], v30, s[12:15], s52 offen offset:0 sc1
    s_barrier
    s_branch k5_sent
k5_own:
    s_barrier
    ds_write_b128 v30, v[64:67] offset:0
    ds_write_b128 v30, v[68:71] offset:1024
    ds_write_b128 v30, v[72:75] offset:2048
    ds_write_b128 v30, v[76:79] offset:3072
    ds_write_b128 v30, v[80:83] offset:4096
    ds_write_b128 v30, v[84:87] offset:5120
    ds_write_b128 v30, v[88:91] offset:6144
    ds_write_b128 v30, v[92:95] offset:7168
    ds_write_b128 v30, v[96:99] offset:8192
    ds_write_b128 v30, v[100:103] offset:9216
    ds_write_b128 v30, v[104:107] offset:10240
    ds_write_b128 v30, v[108:111] offset:11264
    ds_write_b128 v30, v[112:115] offset:12288
    ds_write_b128 v30, v[116:119] offset:13312
    ds_write_b128 v30, v[120:123] offset:14336
    ds_write_b128 v30, v[124:127] offset:15360
    ds_write_b128 v30, v[128:131] offset:16384
    ds_write_b128 v30, v[132:135] offset:17408
k5_sent:
    s_lshl_b32 s31, s20, 1
    s_cmp_lg_u32 s20, 0
    s_addc_u32 s31, s31, 0
    s_lshl_b32 s48, s31, 11
    v_add_u32 v24, s48, v30
    s_lshl_b32 s48, s31, 5
    s_add_u32 s48, s48, 122880
    v_mul_u32_u24 v25, 288, v26
    v_lshl_add_u32 v25, v2, 3, v25
    v_add_u32 v25, s48, v25
    s_lshl_b32 s52, s23, 2
    s_mul_i32 s52, s52, 9472
    s_add_u32 s51, s51, s52
    s_lshl_b32 s48, s31, 10
    s_add_u32 s51, s51, s48
    s_lshl_b32 s48, s20, 6
    v_add_u32 v32, s48, v0
    v_mul_u32_u24 v33, 3641, v32
    v_lshrrev_b32 v33, 16, v33
    v_mul_u32_u24 v34, 18, v33
    v_sub_u32 v34, v32, v34
    v_mul_u32_u24 v33, 1152, v33
    v_lshl_add_u32 v16, v34, 4, v33
    s_lshl_b32 s48, s20, 6
    v_add_u32 v32, s48, v0
    v_add_u32 v32, 256, v32
    v_mul_u32_u24 v33, 3641, v32
    v_lshrrev_b32 v33, 16, v33
    v_mul_u32_u24 v34, 18, v33
    v_sub_u32 v34, v32, v34
    v_mul_u32_u24 v33, 1152, v33
    v_lshl_add_u32 v17, v34, 4, v33
    v_add_u32 v32, 512, v0
    v_mul_u32_u24 v33, 3641, v32
    v_lshrrev_b32 v33, 16, v33
    v_mul_u32_u24 v34, 18, v33
    v_sub_u32 v34, v32, v34
    v_mul_u32_u24 v33, 1152, v33
    v_lshl_add_u32 v18, v34, 4, v33
    s_lshl_b32 s43, s21, 2
    s_add_u32 s43, s43, s23
    s_mul_i32 s43, s43, 36864
    s_mul_i32 s48, s22, 288
    s_add_u32 s43, s43, s48
    s_waitcnt vmcnt(0) lgkmcnt(0)
    s_barrier
    v_lshlrev_b32 v40, 16, v40
    v_lshlrev_b32 v41, 16, v41
    s_cmp_lg_u32 s20, 0
    s_cbranch_scc1 k5_e2
    v_mov_b32 v42, 1
    s_lshl_b32 s48, s23, 7
    v_mov_b32 v43, s48
    s_mov_b64 exec, 1
    buffer_store_dword v42, v43, s[12:15], s53 offen sc1
    s_mov_b64 exec, -1
    ds_read_b128 v[64:67], v24 offset:0
    ds_read_b64 v[136:137], v25 offset:0
    ds_read_b128 v[68:71], v24 offset:1024
    ds_read_b64 v[138:139], v25 offset:4608
    ds_read_b128 v[72:75], v24 offset:2048
    ds_read_b64 v[140:141], v25 offset:32
    ds_read_b128 v[76:79], v24 offset:3072
    ds_read_b64 v[142:143], v25 offset:4640
    ds_read_b128 v[80:83], v24 offset:4096
    ds_read_b64 v[144:145], v25 offset:64
    ds_read_b128 v[84:87], v24 offset:5120
    ds_read_b64 v[146:147], v25 offset:4672
    s_waitcnt lgkmcnt(0)
    v_lshlrev_b32 v44, 16, v136
    v_and_b32 v45, 0xffff0000, v136
    v_lshlrev_b32 v46, 16, v137
    v_and_b32 v47, 0xffff0000, v137
    v_add_f32 v64, v64, v40
    v_add_f32 v65, v65, v40
    v_add_f32 v66, v66, v40
    v_add_f32 v67, v67, v40
    v_add_f32 v64, v64, v44
    v_add_f32 v65, v65, v45
    v_add_f32 v66, v66, v46
    v_add_f32 v67, v67, v47
    v_lshlrev_b32 v44, 16, v138
    v_and_b32 v45, 0xffff0000, v138
    v_lshlrev_b32 v46, 16, v139
    v_and_b32 v47, 0xffff0000, v139
    v_add_f32 v68, v68, v41
    v_add_f32 v69, v69, v41
    v_add_f32 v70, v70, v41
    v_add_f32 v71, v71, v41
    v_add_f32 v68, v68, v44
    v_add_f32 v69, v69, v45
    v_add_f32 v70, v70, v46
    v_add_f32 v71, v71, v47
    v_lshlrev_b32 v44, 16, v140
    v_and_b32 v45, 0xffff0000, v140
    v_lshlrev_b32 v46, 16, v141
    v_and_b32 v47, 0xffff0000, v141
    v_add_f32 v72, v72, v40
    v_add_f32 v73, v73, v40
    v_add_f32 v74, v74, v40
    v_add_f32 v75, v75, v40
    v_add_f32 v72, v72, v44
    v_add_f32 v73, v73, v45
    v_add_f32 v74, v74, v46
    v_add_f32 v75, v75, v47
    v_lshlrev_b32 v44, 16, v142
    v_and_b32 v45, 0xffff0000, v142
    v_lshlrev_b32 v46, 16, v143
    v_and_b32 v47, 0xffff0000, v143
    v_add_f32 v76, v76, v41
    v_add_f32 v77, v77, v41
    v_add_f32 v78, v78, v41
    v_add_f32 v79, v79, v41
    v_add_f32 v76, v76, v44
    v_add_f32 v77, v77, v45
    v_add_f32 v78, v78, v46
    v_add_f32 v79, v79, v47
    v_lshlrev_b32 v44, 16, v144
    v_and_b32 v45, 0xffff0000, v144
    v_lshlrev_b32 v46, 16, v145
    v_and_b32 v47, 0xffff0000, v145
    v_add_f32 v80, v80, v40
    v_add_f32 v81, v81, v40
    v_add_f32 v82, v82, v40
    v_add_f32 v83, v83, v40
    v_add_f32 v80, v80, v44
    v_add_f32 v81, v81, v45
    v_add_f32 v82, v82, v46
    v_add_f32 v83, v83, v47
    v_lshlrev_b32 v44, 16, v146
    v_and_b32 v45, 0xffff0000, v146
    v_lshlrev_b32 v46, 16, v147
    v_and_b32 v47, 0xffff0000, v147
    v_add_f32 v84, v84, v41
    v_add_f32 v85, v85, v41
    v_add_f32 v86, v86, v41
    v_add_f32 v87, v87, v41
    v_add_f32 v84, v84, v44
    v_add_f32 v85, v85, v45
    v_add_f32 v86, v86, v46
    v_add_f32 v87, v87, v47
    v_and_b32 v43, 3, v0
    v_lshlrev_b32 v43, 7, v43
    s_mov_b32 s54, 0x20000
k5_e3_poll:
    buffer_load_dword v44, v43, s[12:15], s53 offen sc1
    s_sub_u32 s54, s54, 1
    s_waitcnt vmcnt(0)
    v_cmp_eq_u32 vcc, 0, v44
    s_cmp_eq_u32 s54, 0
    s_cbranch_scc1 k5_e3_polled
    s_cmp_eq_u64 vcc, 0
    s_cbranch_scc1 k5_e3_polled
    s_sleep 2
    s_branch k5_e3_poll
k5_e3_polled:
    s_barrier
    s_add_u32 s48, s23, 1
    s_and_b32 s48, s48, 3
    s_mul_i32 s48, s48, 9472
    s_add_u32 s52, s51, s48
    buffer_load_dwordx4 v[152:155], v30, s[12:15], s52 offen offset:0 sc1
    buffer_load_dwordx4 v[156:159], v30, s[12:15], s52 offen offset:1024 sc1
    buffer_load_dwordx4 v[160:163], v30, s[12:15], s52 offen offset:2048 sc1
    s_add_u32 s48, s23, 2
    s_and_b32 s48, s48, 3
    s_mul_i32 s48, s48, 9472
    s_add_u32 s52, s51, s48
    buffer_load_dwordx4 v[164:167], v30, s[12:15], s52 offen offset:0 sc1
    buffer_load_dwordx4 v[168:171], v30, s[12:15], s52 offen offset:1024 sc1
    buffer_load_dwordx4 v[172:175], v30, s[12:15], s52 offen offset:2048 sc1
    s_add_u32 s48, s23, 3
    s_and_b32 s48, s48, 3
    s_mul_i32 s48, s48, 9472
    s_add_u32 s52, s51, s48
    buffer_load_dwordx4 v[176:179], v30, s[12:15], s52 offen offset:0 sc1
    buffer_load_dwordx4 v[180:183], v30, s[12:15], s52 offen offset:1024 sc1
    buffer_load_dwordx4 v[184:187], v30, s[12:15], s52 offen offset:2048 sc1
    s_waitcnt vmcnt(8)
    v_lshlrev_b32 v44, 16, v152
    v_and_b32 v45, 0xffff0000, v152
    v_pk_add_f32 v[64:65], v[64:65], v[44:45]
    v_lshlrev_b32 v44, 16, v153
    v_and_b32 v45, 0xffff0000, v153
    v_pk_add_f32 v[66:67], v[66:67], v[44:45]
    v_lshlrev_b32 v44, 16, v154
    v_and_b32 v45, 0xffff0000, v154
    v_pk_add_f32 v[68:69], v[68:69], v[44:45]
    v_lshlrev_b32 v44, 16, v155
    v_and_b32 v45, 0xffff0000, v155
    v_pk_add_f32 v[70:71], v[70:71], v[44:45]
    s_waitcnt vmcnt(7)
    v_lshlrev_b32 v44, 16, v156
    v_and_b32 v45, 0xffff0000, v156
    v_pk_add_f32 v[72:73], v[72:73], v[44:45]
    v_lshlrev_b32 v44, 16, v157
    v_and_b32 v45, 0xffff0000, v157
    v_pk_add_f32 v[74:75], v[74:75], v[44:45]
    v_lshlrev_b32 v44, 16, v158
    v_and_b32 v45, 0xffff0000, v158
    v_pk_add_f32 v[76:77], v[76:77], v[44:45]
    v_lshlrev_b32 v44, 16, v159
    v_and_b32 v45, 0xffff0000, v159
    v_pk_add_f32 v[78:79], v[78:79], v[44:45]
    s_waitcnt vmcnt(6)
    v_lshlrev_b32 v44, 16, v160
    v_and_b32 v45, 0xffff0000, v160
    v_pk_add_f32 v[80:81], v[80:81], v[44:45]
    v_lshlrev_b32 v44, 16, v161
    v_and_b32 v45, 0xffff0000, v161
    v_pk_add_f32 v[82:83], v[82:83], v[44:45]
    v_lshlrev_b32 v44, 16, v162
    v_and_b32 v45, 0xffff0000, v162
    v_pk_add_f32 v[84:85], v[84:85], v[44:45]
    v_lshlrev_b32 v44, 16, v163
    v_and_b32 v45, 0xffff0000, v163
    v_pk_add_f32 v[86:87], v[86:87], v[44:45]
    s_waitcnt vmcnt(5)
    v_lshlrev_b32 v44, 16, v164
    v_and_b32 v45, 0xffff0000, v164
    v_pk_add_f32 v[64:65], v[64:65], v[44:45]
    v_lshlrev_b32 v44, 16, v165
    v_and_b32 v45, 0xffff0000, v165
    v_pk_add_f32 v[66:67], v[66:67], v[44:45]
    v_lshlrev_b32 v44, 16, v166
    v_and_b32 v45, 0xffff0000, v166
    v_pk_add_f32 v[68:69], v[68:69], v[44:45]
    v_lshlrev_b32 v44, 16, v167
    v_and_b32 v45, 0xffff0000, v167
    v_pk_add_f32 v[70:71], v[70:71], v[44:45]
    s_waitcnt vmcnt(4)
    v_lshlrev_b32 v44, 16, v168
    v_and_b32 v45, 0xffff0000, v168
    v_pk_add_f32 v[72:73], v[72:73], v[44:45]
    v_lshlrev_b32 v44, 16, v169
    v_and_b32 v45, 0xffff0000, v169
    v_pk_add_f32 v[74:75], v[74:75], v[44:45]
    v_lshlrev_b32 v44, 16, v170
    v_and_b32 v45, 0xffff0000, v170
    v_pk_add_f32 v[76:77], v[76:77], v[44:45]
    v_lshlrev_b32 v44, 16, v171
    v_and_b32 v45, 0xffff0000, v171
    v_pk_add_f32 v[78:79], v[78:79], v[44:45]
    s_waitcnt vmcnt(3)
    v_lshlrev_b32 v44, 16, v172
    v_and_b32 v45, 0xffff0000, v172
    v_pk_add_f32 v[80:81], v[80:81], v[44:45]
    v_lshlrev_b32 v44, 16, v173
    v_and_b32 v45, 0xffff0000, v173
    v_pk_add_f32 v[82:83], v[82:83], v[44:45]
    v_lshlrev_b32 v44, 16, v174
    v_and_b32 v45, 0xffff0000, v174
    v_pk_add_f32 v[84:85], v[84:85], v[44:45]
    v_lshlrev_b32 v44, 16, v175
    v_and_b32 v45, 0xffff0000, v175
    v_pk_add_f32 v[86:87], v[86:87], v[44:45]
    s_waitcnt vmcnt(2)
    v_lshlrev_b32 v44, 16, v176
    v_and_b32 v45, 0xffff0000, v176
    v_pk_add_f32 v[64:65], v[64:65], v[44:45]
    v_lshlrev_b32 v44, 16, v177
    v_and_b32 v45, 0xffff0000, v177
    v_pk_add_f32 v[66:67], v[66:67], v[44:45]
    v_lshlrev_b32 v44, 16, v178
    v_and_b32 v45, 0xffff0000, v178
    v_pk_add_f32 v[68:69], v[68:69], v[44:45]
    v_lshlrev_b32 v44, 16, v179
    v_and_b32 v45, 0xffff0000, v179
    v_pk_add_f32 v[70:71], v[70:71], v[44:45]
    s_waitcnt vmcnt(1)
    v_lshlrev_b32 v44, 16, v180
    v_and_b32 v45, 0xffff0000, v180
    v_pk_add_f32 v[72:73], v[72:73], v[44:45]
    v_lshlrev_b32 v44, 16, v181
    v_and_b32 v45, 0xffff0000, v181
    v_pk_add_f32 v[74:75], v[74:75], v[44:45]
    v_lshlrev_b32 v44, 16, v182
    v_and_b32 v45, 0xffff0000, v182
    v_pk_add_f32 v[76:77], v[76:77], v[44:45]
    v_lshlrev_b32 v44, 16, v183
    v_and_b32 v45, 0xffff0000, v183
    v_pk_add_f32 v[78:79], v[78:79], v[44:45]
    s_waitcnt vmcnt(0)
    v_lshlrev_b32 v44, 16, v184
    v_and_b32 v45, 0xffff0000, v184
    v_pk_add_f32 v[80:81], v[80:81], v[44:45]
    v_lshlrev_b32 v44, 16, v185
    v_and_b32 v45, 0xffff0000, v185
    v_pk_add_f32 v[82:83], v[82:83], v[44:45]
    v_lshlrev_b32 v44, 16, v186
    v_and_b32 v45, 0xffff0000, v186
    v_pk_add_f32 v[84:85], v[84:85], v[44:45]
    v_lshlrev_b32 v44, 16, v187
    v_and_b32 v45, 0xffff0000, v187
    v_pk_add_f32 v[86:87], v[86:87], v[44:45]
    v_cvt_pk_bf16_f32 v64, v64, v65
    v_cvt_pk_bf16_f32 v65, v66, v67
    ds_write_b64 v25, v[64:65] offset:0
    v_cvt_pk_bf16_f32 v68, v68, v69
    v_cvt_pk_bf16_f32 v69, v70, v71
    ds_write_b64 v25, v[68:69] offset:4608
    v_cvt_pk_bf16_f32 v72, v72, v73
    v_cvt_pk_bf16_f32 v73, v74, v75
    ds_write_b64 v25, v[72:73] offset:32
    v_cvt_pk_bf16_f32 v76, v76, v77
    v_cvt_pk_bf16_f32 v77, v78, v79
    ds_write_b64 v25, v[76:77] offset:4640
    v_cvt_pk_bf16_f32 v80, v80, v81
    v_cvt_pk_bf16_f32 v81, v82, v83
    ds_write_b64 v25, v[80:81] offset:64
    v_cvt_pk_bf16_f32 v84, v84, v85
    v_cvt_pk_bf16_f32 v85, v86, v87
    ds_write_b64 v25, v[84:85] offset:4672
    s_branch k5_fin
k5_e2:
    ds_read_b128 v[64:67], v24 offset:0
    ds_read_b64 v[136:137], v25 offset:0
    ds_read_b128 v[68:71], v24 offset:1024
    ds_read_b64 v[138:139], v25 offset:4608
    ds_read_b128 v[72:75], v24 offset:2048
    ds_read_b64 v[140:141], v25 offset:32
    ds_read_b128 v[76:79], v24 offset:3072
    ds_read_b64 v[142:143], v25 offset:4640
    s_waitcnt lgkmcnt(0)
    v_lshlrev_b32 v44, 16, v136
    v_and_b32 v45, 0xffff0000, v136
    v_lshlrev_b32 v46, 16, v137
    v_and_b32 v47, 0xffff0000, v137
    v_add_f32 v64, v64, v40
    v_add_f32 v65, v65, v40
    v_add_f32 v66, v66, v40
    v_add_f32 v67, v67, v40
    v_add_f32 v64, v64, v44
    v_add_f32 v65, v65, v45
    v_add_f32 v66, v66, v46
    v_add_f32 v67, v67, v47
    v_lshlrev_b32 v44, 16, v138
    v_and_b32 v45, 0xffff0000, v138
    v_lshlrev_b32 v46, 16, v139
    v_and_b32 v47, 0xffff0000, v139
    v_add_f32 v68, v68, v41
    v_add_f32 v69, v69, v41
    v_add_f32 v70, v70, v41
    v_add_f32 v71, v71, v41
    v_add_f32 v68, v68, v44
    v_add_f32 v69, v69, v45
    v_add_f32 v70, v70, v46
    v_add_f32 v71, v71, v47
    v_lshlrev_b32 v44, 16, v140
    v_and_b32 v45, 0xffff0000, v140
    v_lshlrev_b32 v46, 16, v141
    v_and_b32 v47, 0xffff0000, v141
    v_add_f32 v72, v72, v40
    v_add_f32 v73, v73, v40
    v_add_f32 v74, v74, v40
    v_add_f32 v75, v75, v40
    v_add_f32 v72, v72, v44
    v_add_f32 v73, v73, v45
    v_add_f32 v74, v74, v46
    v_add_f32 v75, v75, v47
    v_lshlrev_b32 v44, 16, v142
    v_and_b32 v45, 0xffff0000, v142
    v_lshlrev_b32 v46, 16, v143
    v_and_b32 v47, 0xffff0000, v143
    v_add_f32 v76, v76, v41
    v_add_f32 v77, v77, v41
    v_add_f32 v78, v78, v41
    v_add_f32 v79, v79, v41
    v_add_f32 v76, v76, v44
    v_add_f32 v77, v77, v45
    v_add_f32 v78, v78, v46
    v_add_f32 v79, v79, v47
    s_barrier
    s_add_u32 s48, s23, 1
    s_and_b32 s48, s48, 3
    s_mul_i32 s48, s48, 9472
    s_add_u32 s52, s51, s48
    buffer_load_dwordx4 v[152:155], v30, s[12:15], s52 offen offset:0 sc1
    buffer_load_dwordx4 v[156:159], v30, s[12:15], s52 offen offset:1024 sc1
    s_add_u32 s48, s23, 2
    s_and_b32 s48, s48, 3
    s_mul_i32 s48, s48, 9472
    s_add_u32 s52, s51, s48
    buffer_load_dwordx4 v[160:163], v30, s[12:15], s52 offen offset:0 sc1
    buffer_load_dwordx4 v[164:167], v30, s[12:15], s52 offen offset:1024 sc1
    s_add_u32 s48, s23, 3
    s_and_b32 s48, s48, 3
    s_mul_i32 s48, s48, 9472
    s_add_u32 s52, s51, s48
    buffer_load_dwordx4 v[168:171], v30, s[12:15], s52 offen offset:0 sc1
    buffer_load_dwordx4 v[172:175], v30, s[12:15], s52 offen offset:1024 sc1
    s_waitcnt vmcnt(5)
    v_lshlrev_b32 v44, 16, v152
    v_and_b32 v45, 0xffff0000, v152
    v_pk_add_f32 v[64:65], v[64:65], v[44:45]
    v_lshlrev_b32 v44, 16, v153
    v_and_b32 v45, 0xffff0000, v153
    v_pk_add_f32 v[66:67], v[66:67], v[44:45]
    v_lshlrev_b32 v44, 16, v154
    v_and_b32 v45, 0xffff0000, v154
    v_pk_add_f32 v[68:69], v[68:69], v[44:45]
    v_lshlrev_b32 v44, 16, v155
    v_and_b32 v45, 0xffff0000, v155
    v_pk_add_f32 v[70:71], v[70:71], v[44:45]
    s_waitcnt vmcnt(4)
    v_lshlrev_b32 v44, 16, v156
    v_and_b32 v45, 0xffff0000, v156
    v_pk_add_f32 v[72:73], v[72:73], v[44:45]
    v_lshlrev_b32 v44, 16, v157
    v_and_b32 v45, 0xffff0000, v157
    v_pk_add_f32 v[74:75], v[74:75], v[44:45]
    v_lshlrev_b32 v44, 16, v158
    v_and_b32 v45, 0xffff0000, v158
    v_pk_add_f32 v[76:77], v[76:77], v[44:45]
    v_lshlrev_b32 v44, 16, v159
    v_and_b32 v45, 0xffff0000, v159
    v_pk_add_f32 v[78:79], v[78:79], v[44:45]
    s_waitcnt vmcnt(3)
    v_lshlrev_b32 v44, 16, v160
    v_and_b32 v45, 0xffff0000, v160
    v_pk_add_f32 v[64:65], v[64:65], v[44:45]
    v_lshlrev_b32 v44, 16, v161
    v_and_b32 v45, 0xffff0000, v161
    v_pk_add_f32 v[66:67], v[66:67], v[44:45]
    v_lshlrev_b32 v44, 16, v162
    v_and_b32 v45, 0xffff0000, v162
    v_pk_add_f32 v[68:69], v[68:69], v[44:45]
    v_lshlrev_b32 v44, 16, v163
    v_and_b32 v45, 0xffff0000, v163
    v_pk_add_f32 v[70:71], v[70:71], v[44:45]
    s_waitcnt vmcnt(2)
    v_lshlrev_b32 v44, 16, v164
    v_and_b32 v45, 0xffff0000, v164
    v_pk_add_f32 v[72:73], v[72:73], v[44:45]
    v_lshlrev_b32 v44, 16, v165
    v_and_b32 v45, 0xffff0000, v165
    v_pk_add_f32 v[74:75], v[74:75], v[44:45]
    v_lshlrev_b32 v44, 16, v166
    v_and_b32 v45, 0xffff0000, v166
    v_pk_add_f32 v[76:77], v[76:77], v[44:45]
    v_lshlrev_b32 v44, 16, v167
    v_and_b32 v45, 0xffff0000, v167
    v_pk_add_f32 v[78:79], v[78:79], v[44:45]
    s_waitcnt vmcnt(1)
    v_lshlrev_b32 v44, 16, v168
    v_and_b32 v45, 0xffff0000, v168
    v_pk_add_f32 v[64:65], v[64:65], v[44:45]
    v_lshlrev_b32 v44, 16, v169
    v_and_b32 v45, 0xffff0000, v169
    v_pk_add_f32 v[66:67], v[66:67], v[44:45]
    v_lshlrev_b32 v44, 16, v170
    v_and_b32 v45, 0xffff0000, v170
    v_pk_add_f32 v[68:69], v[68:69], v[44:45]
    v_lshlrev_b32 v44, 16, v171
    v_and_b32 v45, 0xffff0000, v171
    v_pk_add_f32 v[70:71], v[70:71], v[44:45]
    s_waitcnt vmcnt(0)
    v_lshlrev_b32 v44, 16, v172
    v_and_b32 v45, 0xffff0000, v172
    v_pk_add_f32 v[72:73], v[72:73], v[44:45]
    v_lshlrev_b32 v44, 16, v173
    v_and_b32 v45, 0xffff0000, v173
    v_pk_add_f32 v[74:75], v[74:75], v[44:45]
    v_lshlrev_b32 v44, 16, v174
    v_and_b32 v45, 0xffff0000, v174
    v_pk_add_f32 v[76:77], v[76:77], v[44:45]
    v_lshlrev_b32 v44, 16, v175
    v_and_b32 v45, 0xffff0000, v175
    v_pk_add_f32 v[78:79], v[78:79], v[44:45]
    v_cvt_pk_bf16_f32 v64, v64, v65
    v_cvt_pk_bf16_f32 v65, v66, v67
    ds_write_b64 v25, v[64:65] offset:0
    v_cvt_pk_bf16_f32 v68, v68, v69
    v_cvt_pk_bf16_f32 v69, v70, v71
    ds_write_b64 v25, v[68:69] offset:4608
    v_cvt_pk_bf16_f32 v72, v72, v73
    v_cvt_pk_bf16_f32 v73, v74, v75
    ds_write_b64 v25, v[72:73] offset:32
    v_cvt_pk_bf16_f32 v76, v76, v77
    v_cvt_pk_bf16_f32 v77, v78, v79
    ds_write_b64 v25, v[76:77] offset:4640
k5_fin:
    s_lshl_b32 s48, s20, 10
    s_add_u32 s48, s48, 122880
    v_add_u32 v24, s48, v30
    v_add_u32 v25, 131072, v30
    s_waitcnt lgkmcnt(0)
    s_barrier
    ds_read_b128 v[136:139], v24
    ds_read_b128 v[140:143], v24 offset:4096
    ds_read_b128 v[144:147], v25
    s_waitcnt lgkmcnt(2)
    buffer_store_dwordx4 v[136:139], v16, s[44:47], s43 offen sc1
    s_waitcnt lgkmcnt(1)
    buffer_store_dwordx4 v[140:143], v17, s[44:47], s43 offen sc1
    s_cmp_lg_u32 s20, 3
    s_cbranch_scc1 k5_done
    s_waitcnt lgkmcnt(0)
    buffer_store_dwordx4 v[144:147], v18, s[44:47], s43 offen sc1
k5_done:
    s_endpgm
k5_loader:
    s_sub_u32 s20, s20, 4
    v_lshrrev_b32 v2, 4, v0
    v_and_b32 v3, 15, v0
    v_lshlrev_b32 v4, 1, v2
    v_xor_b32 v4, v3, v4
    v_lshlrev_b32 v4, 4, v4
    v_lshl_add_u32 v8, v2, 12, v4
    v_xor_b32 v6, 128, v8
    v_add_u32 v9, 15360, v6
    v_add_u32 v10, 30720, v8
    v_add_u32 v11, 46080, v6
    s_mul_i32 s24, s23, 72
    s_add_u32 s24, s24, s20
    s_lshl_b32 s24, s24, 16
    s_lshl_b32 s28, s21, 8
    s_add_u32 s24, s24, s28
    s_mul_i32 s25, s23, 36
    s_lshr_b32 s28, s20, 1
    s_add_u32 s25, s25, s28
    s_mul_i32 s25, s25, 36864
    s_mul_i32 s29, s28, 9216
    s_mul_i32 s28, s22, 9216
    s_add_u32 s25, s25, s28
    s_add_u32 s25, s25, 14155776
    s_lshl_b32 s61, s60, 1
    s_mov_b32 s63, s61
    s_mul_i32 s57, s61, 262144
    s_add_u32 s24, s24, s57
    s_mul_i32 s57, s61, 73728
    s_add_u32 s25, s25, s57
    s_lshl_b32 s30, s20, 12
    s_add_u32 s30, s30, 73728
    s_mov_b32 s26, 0
    s_waitcnt lgkmcnt(0)
    s_mov_b32 s8, s32
    s_and_b32 s9, s33, 0xffff
    s_mov_b32 s10, 0x1200000
    s_mov_b32 s11, 0x20000
    s_mov_b32 s12, s36
    s_and_b32 s13, s37, 0xffff
    s_mov_b32 s14, 0x1c06000
    s_mov_b32 s15, 0x20000
    s_bitcmp1_b32 s20, 0
    s_cbranch_scc1 k5_ld_odd
    s_mov_b32 s42, 0
    s_add_u32 m0, s26, s30
    s_nop 0
    buffer_load_dwordx4 v8, s[8:11], s24 offen offset:0 lds
    buffer_load_dwordx4 v9, s[8:11], s24 offen offset:1024 lds
    buffer_load_dwordx4 v10, s[8:11], s24 offen offset:2048 lds
    buffer_load_dwordx4 v11, s[8:11], s24 offen offset:3072 lds
    s_add_u32 s24, s24, 262144
    s_add_u32 s63, s63, 1
    s_cmp_eq_u32 s63, 18
    s_cselect_b32 s48, 4718592, 0
    s_sub_u32 s24, s24, s48
    s_add_u32 s26, s26, 16384
    s_cmp_eq_u32 s26, 81920
    s_cselect_b32 s26, 0, s26
    s_add_u32 m0, s26, s30
    s_nop 0
    buffer_load_dwordx4 v8, s[8:11], s24 offen offset:0 lds
    buffer_load_dwordx4 v9, s[8:11], s24 offen offset:1024 lds
    buffer_load_dwordx4 v10, s[8:11], s24 offen offset:2048 lds
    buffer_load_dwordx4 v11, s[8:11], s24 offen offset:3072 lds
    s_add_u32 s24, s24, 262144
    s_add_u32 s63, s63, 1
    s_cmp_eq_u32 s63, 18
    s_cselect_b32 s48, 4718592, 0
    s_sub_u32 s24, s24, s48
    s_add_u32 s26, s26, 16384
    s_cmp_eq_u32 s26, 81920
    s_cselect_b32 s26, 0, s26
    s_add_u32 m0, s26, s30
    s_nop 0
    buffer_load_dwordx4 v8, s[8:11], s24 offen offset:0 lds
    buffer_load_dwordx4 v9, s[8:11], s24 offen offset:1024 lds
    buffer_load_dwordx4 v10, s[8:11], s24 offen offset:2048 lds
    buffer_load_dwordx4 v11, s[8:11], s24 offen offset:3072 lds
    s_add_u32 s24, s24, 262144
    s_add_u32 s63, s63, 1
    s_cmp_eq_u32 s63, 18
    s_cselect_b32 s48, 4718592, 0
    s_sub_u32 s24, s24, s48
    s_add_u32 s26, s26, 16384
    s_cmp_eq_u32 s26, 81920
    s_cselect_b32 s26, 0, s26
    s_add_u32 m0, s26, s30
    s_nop 0
    buffer_load_dwordx4 v8, s[8:11], s24 offen offset:0 lds
    buffer_load_dwordx4 v9, s[8:11], s24 offen offset:1024 lds
    buffer_load_dwordx4 v10, s[8:11], s24 offen offset:2048 lds
    buffer_load_dwordx4 v11, s[8:11], s24 offen offset:3072 lds
    s_add_u32 s24, s24, 262144
    s_add_u32 s63, s63, 1
    s_cmp_eq_u32 s63, 18
    s_cselect_b32 s48, 4718592, 0
    s_sub_u32 s24, s24, s48
    s_add_u32 s26, s26, 16384
    s_cmp_eq_u32 s26, 81920
    s_cselect_b32 s26, 0, s26
    s_add_u32 m0, s26, s30
    s_nop 0
    buffer_load_dwordx4 v8, s[8:11], s24 offen offset:0 lds
    buffer_load_dwordx4 v9, s[8:11], s24 offen offset:1024 lds
    buffer_load_dwordx4 v10, s[8:11], s24 offen offset:2048 lds
    buffer_load_dwordx4 v11, s[8:11], s24 offen offset:3072 lds
    s_add_u32 s24, s24, 262144
    s_add_u32 s63, s63, 1
    s_cmp_eq_u32 s63, 18
    s_cselect_b32 s48, 4718592, 0
    s_sub_u32 s24, s24, s48
    s_add_u32 s26, s26, 16384
    s_cmp_eq_u32 s26, 81920
    s_cselect_b32 s26, 0, s26
    v_min_u32 v32, 17, v0
    v_lshrrev_b32 v33, 1, v32
    v_add_u32 v33, s60, v33
    v_subrev_u32 v34, 9, v33
    v_min_u32 v33, v33, v34
    v_mul_u32_u24 v33, 768, v33
    v_and_b32 v32, 1, v32
    v_lshl_add_u32 v36, v32, 7, v33
    s_mul_i32 s56, s23, 6912
    s_mul_i32 s57, s22, 3
    s_lshr_b32 s57, s57, 1
    s_lshl_b32 s57, s57, 7
    s_add_u32 s56, s56, s57
    s_add_u32 s56, s56, 29286400
    v_mov_b32 v34, 1
    v_mov_b32 v35, 0
    s_barrier
    s_cmp_eq_u32 s20, 0
    s_cselect_b32 s55, -1, 0
    s_cbranch_scc0 k5_o0_noflag
    s_mov_b64 exec, 1
    buffer_store_dword v34, v35, s[12:15], s59 offen sc1
    s_mov_b64 exec, -1
k5_o0_noflag:
    s_mov_b32 s54, 0xf
    s_mov_b32 s53, 2
    s_and_b32 s52, s55, s54
    s_cbranch_scc0 k5_o0_rdy0
    s_mov_b32 s58, 0x20000
k5_o0_poll0:
    buffer_load_dword v37, v36, s[12:15], s56 offen sc1
    s_sub_u32 s58, s58, 1
    s_waitcnt vmcnt(0)
    v_cmp_eq_u32 vcc, 0, v37
    s_cmp_eq_u32 s58, 0
    s_cbranch_scc1 k5_o0_rdy0
    s_mov_b32 s55, vcc_lo
    s_and_b32 s52, s55, s54
    s_cbranch_scc0 k5_o0_rdy0
    s_sleep 2
    s_branch k5_o0_poll0
k5_o0_rdy0:
    s_barrier
    s_add_u32 m0, s42, s29
    s_nop 0
    buffer_load_dwordx4 v30, s[12:15], s25 offen offset:0 lds
    buffer_load_dwordx4 v30, s[12:15], s25 offen offset:1024 lds
    buffer_load_dwordx4 v30, s[12:15], s25 offen offset:2048 lds
    buffer_load_dwordx4 v30, s[12:15], s25 offen offset:3072 lds
    s_add_u32 m0, m0, 4096
    s_add_u32 s48, s25, 4096
    buffer_load_dwordx4 v30, s[12:15], s48 offen lds
    s_add_u32 s25, s25, 73728
    s_add_u32 s61, s61, 1
    s_cmp_eq_u32 s61, 18
    s_cselect_b32 s48, 1327104, 0
    s_sub_u32 s25, s25, s48
    s_add_u32 s42, s42, 18432
    s_cmp_eq_u32 s42, 73728
    s_cselect_b32 s42, 0, s42
    s_add_u32 m0, s42, s29
    s_nop 0
    buffer_load_dwordx4 v30, s[12:15], s25 offen offset:0 lds
    buffer_load_dwordx4 v30, s[12:15], s25 offen offset:1024 lds
    buffer_load_dwordx4 v30, s[12:15], s25 offen offset:2048 lds
    buffer_load_dwordx4 v30, s[12:15], s25 offen offset:3072 lds
    s_add_u32 m0, m0, 4096
    s_add_u32 s48, s25, 4096
    buffer_load_dwordx4 v30, s[12:15], s48 offen lds
    s_add_u32 s25, s25, 73728
    s_add_u32 s61, s61, 1
    s_cmp_eq_u32 s61, 18
    s_cselect_b32 s48, 1327104, 0
    s_sub_u32 s25, s25, s48
    s_add_u32 s42, s42, 18432
    s_cmp_eq_u32 s42, 73728
    s_cselect_b32 s42, 0, s42
    s_add_u32 m0, s42, s29
    s_nop 0
    buffer_load_dwordx4 v30, s[12:15], s25 offen offset:0 lds
    buffer_load_dwordx4 v30, s[12:15], s25 offen offset:1024 lds
    buffer_load_dwordx4 v30, s[12:15], s25 offen offset:2048 lds
    buffer_load_dwordx4 v30, s[12:15], s25 offen offset:3072 lds
    s_add_u32 m0, m0, 4096
    s_add_u32 s48, s25, 4096
    buffer_load_dwordx4 v30, s[12:15], s48 offen lds
    s_add_u32 s25, s25, 73728
    s_add_u32 s61, s61, 1
    s_cmp_eq_u32 s61, 18
    s_cselect_b32 s48, 1327104, 0
    s_sub_u32 s25, s25, s48
    s_add_u32 s42, s42, 18432
    s_cmp_eq_u32 s42, 73728
    s_cselect_b32 s42, 0, s42
    s_add_u32 s53, s53, 1
    s_lshr_b32 s54, s53, 1
    s_lshl_b32 s54, s54, 1
    s_lshl_b32 s54, 3, s54
    s_and_b32 s52, s55, s54
    s_cbranch_scc0 k5_o0_rdya
    s_mov_b32 s58, 0x20000
k5_o0_polla:
    buffer_load_dword v37, v36, s[12:15], s56 offen sc1
    s_sub_u32 s58, s58, 1
    s_waitcnt vmcnt(0)
    v_cmp_eq_u32 vcc, 0, v37
    s_cmp_eq_u32 s58, 0
    s_cbranch_scc1 k5_o0_rdya
    s_mov_b32 s55, vcc_lo
    s_and_b32 s52, s55, s54
    s_cbranch_scc0 k5_o0_rdya
    s_sleep 2
    s_branch k5_o0_polla
k5_o0_rdya:
    s_waitcnt vmcnt(10)
    s_barrier
    s_add_u32 m0, s42, s29
    s_nop 0
    buffer_load_dwordx4 v30, s[12:15], s25 offen offset:0 lds
    buffer_load_dwordx4 v30, s[12:15], s25 offen offset:1024 lds
    buffer_load_dwordx4 v30, s[12:15], s25 offen offset:2048 lds
    buffer_load_dwordx4 v30, s[12:15], s25 offen offset:3072 lds
    s_add_u32 m0, m0, 4096
    s_add_u32 s48, s25, 4096
    buffer_load_dwordx4 v30, s[12:15], s48 offen lds
    s_add_u32 s25, s25, 73728
    s_add_u32 s61, s61, 1
    s_cmp_eq_u32 s61, 18
    s_cselect_b32 s48, 1327104, 0
    s_sub_u32 s25, s25, s48
    s_add_u32 s42, s42, 18432
    s_cmp_eq_u32 s42, 73728
    s_cselect_b32 s42, 0, s42
    s_waitcnt vmcnt(10)
    s_barrier
    s_add_u32 s53, s53, 1
    s_lshr_b32 s54, s53, 1
    s_lshl_b32 s54, s54, 1
    s_lshl_b32 s54, 3, s54
    s_and_b32 s52, s55, s54
    s_cbranch_scc0 k5_o0_rdyr1
    s_mov_b32 s58, 0x20000
k5_o0_pollr1:
    buffer_load_dword v37, v36, s[12:15], s56 offen sc1
    s_sub_u32 s58, s58, 1
    s_waitcnt vmcnt(0)
    v_cmp_eq_u32 vcc, 0, v37
    s_cmp_eq_u32 s58, 0
    s_cbranch_scc1 k5_o0_rdyr1
    s_mov_b32 s55, vcc_lo
    s_and_b32 s52, s55, s54
    s_cbranch_scc0 k5_o0_rdyr1
    s_sleep 2
    s_branch k5_o0_pollr1
k5_o0_rdyr1:
    s_waitcnt vmcnt(5)
    s_barrier
    s_add_u32 m0, s26, s30
    s_nop 0
    buffer_load_dwordx4 v8, s[8:11], s24 offen offset:0 lds
    buffer_load_dwordx4 v9, s[8:11], s24 offen offset:1024 lds
    buffer_load_dwordx4 v10, s[8:11], s24 offen offset:2048 lds
    buffer_load_dwordx4 v11, s[8:11], s24 offen offset:3072 lds
    s_add_u32 s24, s24, 262144
    s_add_u32 s63, s63, 1
    s_cmp_eq_u32 s63, 18
    s_cselect_b32 s48, 4718592, 0
    s_sub_u32 s24, s24, s48
    s_add_u32 s26, s26, 16384
    s_cmp_eq_u32 s26, 81920
    s_cselect_b32 s26, 0, s26
    s_add_u32 m0, s42, s29
    s_nop 0
    buffer_load_dwordx4 v30, s[12:15], s25 offen offset:0 lds
    buffer_load_dwordx4 v30, s[12:15], s25 offen offset:1024 lds
    buffer_load_dwordx4 v30, s[12:15], s25 offen offset:2048 lds
    buffer_load_dwordx4 v30, s[12:15], s25 offen offset:3072 lds
    s_add_u32 m0, m0, 4096
    s_add_u32 s48, s25, 4096
    buffer_load_dwordx4 v30, s[12:15], s48 offen lds
    s_add_u32 s25, s25, 73728
    s_add_u32 s61, s61, 1
    s_cmp_eq_u32 s61, 18
    s_cselect_b32 s48, 1327104, 0
    s_sub_u32 s25, s25, s48
    s_add_u32 s42, s42, 18432
    s_cmp_eq_u32 s42, 73728
    s_cselect_b32 s42, 0, s42
    s_add_u32 s53, s53, 1
    s_lshr_b32 s54, s53, 1
    s_lshl_b32 s54, s54, 1
    s_lshl_b32 s54, 3, s54
    s_and_b32 s52, s55, s54
    s_cbranch_scc0 k5_o0_rdyr2
    s_mov_b32 s58, 0x20000
k5_o0_pollr2:
    buffer_load_dword v37, v36, s[12:15], s56 offen sc1
    s_sub_u32 s58, s58, 1
    s_waitcnt vmcnt(0)
    v_cmp_eq_u32 vcc, 0, v37
    s_cmp_eq_u32 s58, 0
    s_cbranch_scc1 k5_o0_rdyr2
    s_mov_b32 s55, vcc_lo
    s_and_b32 s52, s55, s54
    s_cbranch_scc0 k5_o0_rdyr2
    s_sleep 2
    s_branch k5_o0_pollr2
k5_o0_rdyr2:
    s_waitcnt vmcnt(9)
    s_barrier
    s_add_u32 m0, s26, s30
    s_nop 0
    buffer_load_dwordx4 v8, s[8:11], s24 offen offset:0 lds
    buffer_load_dwordx4 v9, s[8:11], s24 offen offset:1024 lds
    buffer_load_dwordx4 v10, s[8:11], s24 offen offset:2048 lds
    buffer_load_dwordx4 v11, s[8:11], s24 offen offset:3072 lds
    s_add_u32 s24, s24, 262144
    s_add_u32 s63, s63, 1
    s_cmp_eq_u32 s63, 18
    s_cselect_b32 s48, 4718592, 0
    s_sub_u32 s24, s24, s48
    s_add_u32 s26, s26, 16384
    s_cmp_eq_u32 s26, 81920
    s_cselect_b32 s26, 0, s26
    s_add_u32 m0, s42, s29
    s_nop 0
    buffer_load_dwordx4 v30, s[12:15], s25 offen offset:0 lds
    buffer_load_dwordx4 v30, s[12:15], s25 offen offset:1024 lds
    buffer_load_dwordx4 v30, s[12:15], s25 offen offset:2048 lds
    buffer_load_dwordx4 v30, s[12:15], s25 offen offset:3072 lds
    s_add_u32 m0, m0, 4096
    s_add_u32 s48, s25, 4096
    buffer_load_dwordx4 v30, s[12:15], s48 offen lds
    s_add_u32 s25, s25, 73728
    s_add_u32 s61, s61, 1
    s_cmp_eq_u32 s61, 18
    s_cselect_b32 s48, 1327104, 0
    s_sub_u32 s25, s25, s48
    s_add_u32 s42, s42, 18432
    s_cmp_eq_u32 s42, 73728
    s_cselect_b32 s42, 0, s42
    s_add_u32 s53, s53, 1
    s_lshr_b32 s54, s53, 1
    s_lshl_b32 s54, s54, 1
    s_lshl_b32 s54, 3, s54
    s_and_b32 s52, s55, s54
    s_cbranch_scc0 k5_o0_rdyr3
    s_mov_b32 s58, 0x20000
k5_o0_pollr3:
    buffer_load_dword v37, v36, s[12:15], s56 offen sc1
    s_sub_u32 s58, s58, 1
    s_waitcnt vmcnt(0)
    v_cmp_eq_u32 vcc, 0, v37
    s_cmp_eq_u32 s58, 0
    s_cbranch_scc1 k5_o0_rdyr3
    s_mov_b32 s55, vcc_lo
    s_and_b32 s52, s55, s54
    s_cbranch_scc0 k5_o0_rdyr3
    s_sleep 2
    s_branch k5_o0_pollr3
k5_o0_rdyr3:
    s_waitcnt vmcnt(9)
    s_barrier
    s_add_u32 m0, s26, s30
    s_nop 0
    buffer_load_dwordx4 v8, s[8:11], s24 offen offset:0 lds
    buffer_load_dwordx4 v9, s[8:11], s24 offen offset:1024 lds
    buffer_load_dwordx4 v10, s[8:11], s24 offen offset:2048 lds
    buffer_load_dwordx4 v11, s[8:11], s24 offen offset:3072 lds
    s_add_u32 s24, s24, 262144
    s_add_u32 s63, s63, 1
    s_cmp_eq_u32 s63, 18
    s_cselect_b32 s48, 4718592, 0
    s_sub_u32 s24, s24, s48
    s_add_u32 s26, s26, 16384
    s_cmp_eq_u32 s26, 81920
    s_cselect_b32 s26, 0, s26
    s_add_u32 m0, s42, s29
    s_nop 0
    buffer_load_dwordx4 v30, s[12:15], s25 offen offset:0 lds
    buffer_load_dwordx4 v30, s[12:15], s25 offen offset:1024 lds
    buffer_load_dwordx4 v30, s[12:15], s25 offen offset:2048 lds
    buffer_load_dwordx4 v30, s[12:15], s25 offen offset:3072 lds
    s_add_u32 m0, m0, 4096
    s_add_u32 s48, s25, 4096
    buffer_load_dwordx4 v30, s[12:15], s48 offen lds
    s_add_u32 s25, s25, 73728
    s_add_u32 s61, s61, 1
    s_cmp_eq_u32 s61, 18
    s_cselect_b32 s48, 1327104, 0
    s_sub_u32 s25, s25, s48
    s_add_u32 s42, s42, 18432
    s_cmp_eq_u32 s42, 73728
    s_cselect_b32 s42, 0, s42
    s_mov_b32 s27, 10
k5_o0_ld_loop:
    s_add_u32 s53, s53, 1
    s_lshr_b32 s54, s53, 1
    s_lshl_b32 s54, s54, 1
    s_lshl_b32 s54, 3, s54
    s_and_b32 s52, s55, s54
    s_cbranch_scc0 k5_o0_rdyl
    s_mov_b32 s58, 0x20000
k5_o0_polll:
    buffer_load_dword v37, v36, s[12:15], s56 offen sc1
    s_sub_u32 s58, s58, 1
    s_waitcnt vmcnt(0)
    v_cmp_eq_u32 vcc, 0, v37
    s_cmp_eq_u32 s58, 0
    s_cbranch_scc1 k5_o0_rdyl
    s_mov_b32 s55, vcc_lo
    s_and_b32 s52, s55, s54
    s_cbranch_scc0 k5_o0_rdyl
    s_sleep 2
    s_branch k5_o0_polll
k5_o0_rdyl:
    s_waitcnt vmcnt(9)
    s_barrier
    s_add_u32 m0, s26, s30
    s_nop 0
    buffer_load_dwordx4 v8, s[8:11], s24 offen offset:0 lds
    buffer_load_dwordx4 v9, s[8:11], s24 offen offset:1024 lds
    buffer_load_dwordx4 v10, s[8:11], s24 offen offset:2048 lds
    buffer_load_dwordx4 v11, s[8:11], s24 offen offset:3072 lds
    s_add_u32 s24, s24, 262144
    s_add_u32 s63, s63, 1
    s_cmp_eq_u32 s63, 18
    s_cselect_b32 s48, 4718592, 0
    s_sub_u32 s24, s24, s48
    s_add_u32 s26, s26, 16384
    s_cmp_eq_u32 s26, 81920
    s_cselect_b32 s26, 0, s26
    s_add_u32 m0, s42, s29
    s_nop 0
    buffer_load_dwordx4 v30, s[12:15], s25 offen offset:0 lds
    buffer_load_dwordx4 v30, s[12:15], s25 offen offset:1024 lds
    buffer_load_dwordx4 v30, s[12:15], s25 offen offset:2048 lds
    buffer_load_dwordx4 v30, s[12:15], s25 offen offset:3072 lds
    s_add_u32 m0, m0, 4096
    s_add_u32 s48, s25, 4096
    buffer_load_dwordx4 v30, s[12:15], s48 offen lds
    s_add_u32 s25, s25, 73728
    s_add_u32 s61, s61, 1
    s_cmp_eq_u32 s61, 18
    s_cselect_b32 s48, 1327104, 0
    s_sub_u32 s25, s25, s48
    s_add_u32 s42, s42, 18432
    s_cmp_eq_u32 s42, 73728
    s_cselect_b32 s42, 0, s42
    s_sub_u32 s27, s27, 1
    s_cmp_lg_u32 s27, 0
    s_cbranch_scc1 k5_o0_ld_loop
    s_add_u32 s53, s53, 1
    s_lshr_b32 s54, s53, 1
    s_lshl_b32 s54, s54, 1
    s_lshl_b32 s54, 3, s54
    s_and_b32 s52, s55, s54
    s_cbranch_scc0 k5_o0_rdyt14
    s_mov_b32 s58, 0x20000
k5_o0_pollt14:
    buffer_load_dword v37, v36, s[12:15], s56 offen sc1
    s_sub_u32 s58, s58, 1
    s_waitcnt vmcnt(0)
    v_cmp_eq_u32 vcc, 0, v37
    s_cmp_eq_u32 s58, 0
    s_cbranch_scc1 k5_o0_rdyt14
    s_mov_b32 s55, vcc_lo
    s_and_b32 s52, s55, s54
    s_cbranch_scc0 k5_o0_rdyt14
    s_sleep 2
    s_branch k5_o0_pollt14
k5_o0_rdyt14:
    s_waitcnt vmcnt(9)
    s_barrier
    s_lshl_b32 s43, s21, 2
    s_add_u32 s43, s43, s23
    s_lshl_b32 s43, s43, 2
    s_add_u32 s43, s43, s22
    s_mul_i32 s43, s43, 9216
    s_add_u32 s43, s43, 0
    s_lshl_b32 s49, s20, 10
    s_add_u32 m0, s49, 122880
    s_add_u32 s48, s43, s49
    s_add_u32 s48, s48, 0
    buffer_load_dwordx4 v30, s[12:15], s48 offen lds
    s_add_u32 m0, s49, 126976
    s_add_u32 s48, s43, s49
    s_add_u32 s48, s48, 4096
    buffer_load_dwordx4 v30, s[12:15], s48 offen lds
    s_mov_b32 m0, 131072
    s_add_u32 s48, s43, 8192
    buffer_load_dwordx4 v30, s[12:15], s48 offen lds
    s_add_u32 m0, s42, s29
    s_nop 0
    buffer_load_dwordx4 v30, s[12:15], s25 offen offset:0 lds
    buffer_load_dwordx4 v30, s[12:15], s25 offen offset:1024 lds
    buffer_load_dwordx4 v30, s[12:15], s25 offen offset:2048 lds
    buffer_load_dwordx4 v30, s[12:15], s25 offen offset:3072 lds
    s_add_u32 m0, m0, 4096
    s_add_u32 s48, s25, 4096
    buffer_load_dwordx4 v30, s[12:15], s48 offen lds
    s_add_u32 s25, s25, 73728
    s_add_u32 s61, s61, 1
    s_cmp_eq_u32 s61, 18
    s_cselect_b32 s48, 1327104, 0
    s_sub_u32 s25, s25, s48
    s_add_u32 s42, s42, 18432
    s_cmp_eq_u32 s42, 73728
    s_cselect_b32 s42, 0, s42
    s_waitcnt vmcnt(8)
    s_barrier
    s_waitcnt vmcnt(0)
    s_barrier
    s_endpgm
k5_ld_odd:
    s_add_u32 s25, s25, 5120
    s_add_u32 s29, s29, 5120
    s_mov_b32 s42, 0
    s_add_u32 m0, s26, s30
    s_nop 0
    buffer_load_dwordx4 v8, s[8:11], s24 offen offset:0 lds
    buffer_load_dwordx4 v9, s[8:11], s24 offen offset:1024 lds
    buffer_load_dwordx4 v10, s[8:11], s24 offen offset:2048 lds
    buffer_load_dwordx4 v11, s[8:11], s24 offen offset:3072 lds
    s_add_u32 s24, s24, 262144
    s_add_u32 s63, s63, 1
    s_cmp_eq_u32 s63, 18
    s_cselect_b32 s48, 4718592, 0
    s_sub_u32 s24, s24, s48
    s_add_u32 s26, s26, 16384
    s_cmp_eq_u32 s26, 81920
    s_cselect_b32 s26, 0, s26
    s_add_u32 m0, s26, s30
    s_nop 0
    buffer_load_dwordx4 v8, s[8:11], s24 offen offset:0 lds
    buffer_load_dwordx4 v9, s[8:11], s24 offen offset:1024 lds
    buffer_load_dwordx4 v10, s[8:11], s24 offen offset:2048 lds
    buffer_load_dwordx4 v11, s[8:11], s24 offen offset:3072 lds
    s_add_u32 s24, s24, 262144
    s_add_u32 s63, s63, 1
    s_cmp_eq_u32 s63, 18
    s_cselect_b32 s48, 4718592, 0
    s_sub_u32 s24, s24, s48
    s_add_u32 s26, s26, 16384
    s_cmp_eq_u32 s26, 81920
    s_cselect_b32 s26, 0, s26
    s_add_u32 m0, s26, s30
    s_nop 0
    buffer_load_dwordx4 v8, s[8:11], s24 offen offset:0 lds
    buffer_load_dwordx4 v9, s[8:11], s24 offen offset:1024 lds
    buffer_load_dwordx4 v10, s[8:11], s24 offen offset:2048 lds
    buffer_load_dwordx4 v11, s[8:11], s24 offen offset:3072 lds
    s_add_u32 s24, s24, 262144
    s_add_u32 s63, s63, 1
    s_cmp_eq_u32 s63, 18
    s_cselect_b32 s48, 4718592, 0
    s_sub_u32 s24, s24, s48
    s_add_u32 s26, s26, 16384
    s_cmp_eq_u32 s26, 81920
    s_cselect_b32 s26, 0, s26
    s_add_u32 m0, s26, s30
    s_nop 0
    buffer_load_dwordx4 v8, s[8:11], s24 offen offset:0 lds
    buffer_load_dwordx4 v9, s[8:11], s24 offen offset:1024 lds
    buffer_load_dwordx4 v10, s[8:11], s24 offen offset:2048 lds
    buffer_load_dwordx4 v11, s[8:11], s24 offen offset:3072 lds
    s_add_u32 s24, s24, 262144
    s_add_u32 s63, s63, 1
    s_cmp_eq_u32 s63, 18
    s_cselect_b32 s48, 4718592, 0
    s_sub_u32 s24, s24, s48
    s_add_u32 s26, s26, 16384
    s_cmp_eq_u32 s26, 81920
    s_cselect_b32 s26, 0, s26
    s_add_u32 m0, s26, s30
    s_nop 0
    buffer_load_dwordx4 v8, s[8:11], s24 offen offset:0 lds
    buffer_load_dwordx4 v9, s[8:11], s24 offen offset:1024 lds
    buffer_load_dwordx4 v10, s[8:11], s24 offen offset:2048 lds
    buffer_load_dwordx4 v11, s[8:11], s24 offen offset:3072 lds
    s_add_u32 s24, s24, 262144
    s_add_u32 s63, s63, 1
    s_cmp_eq_u32 s63, 18
    s_cselect_b32 s48, 4718592, 0
    s_sub_u32 s24, s24, s48
    s_add_u32 s26, s26, 16384
    s_cmp_eq_u32 s26, 81920
    s_cselect_b32 s26, 0, s26
    v_min_u32 v32, 17, v0
    v_lshrrev_b32 v33, 1, v32
    v_add_u32 v33, s60, v33
    v_subrev_u32 v34, 9, v33
    v_min_u32 v33, v33, v34
    v_mul_u32_u24 v33, 768, v33
    v_and_b32 v32, 1, v32
    v_lshl_add_u32 v36, v32, 7, v33
    s_mul_i32 s56, s23, 6912
    s_mul_i32 s57, s22, 3
    s_lshr_b32 s57, s57, 1
    s_lshl_b32 s57, s57, 7
    s_add_u32 s56, s56, s57
    s_add_u32 s56, s56, 29286400
    v_mov_b32 v34, 1
    v_mov_b32 v35, 0
    s_barrier
    s_barrier
    s_add_u32 m0, s42, s29
    s_nop 0
    buffer_load_dwordx4 v30, s[12:15], s25 offen offset:0 lds
    buffer_load_dwordx4 v30, s[12:15], s25 offen offset:1024 lds
    buffer_load_dwordx4 v30, s[12:15], s25 offen offset:2048 lds
    buffer_load_dwordx4 v30, s[12:15], s25 offen offset:3072 lds
    s_add_u32 s25, s25, 73728
    s_add_u32 s61, s61, 1
    s_cmp_eq_u32 s61, 18
    s_cselect_b32 s48, 1327104, 0
    s_sub_u32 s25, s25, s48
    s_add_u32 s42, s42, 18432
    s_cmp_eq_u32 s42, 73728
    s_cselect_b32 s42, 0, s42
    s_add_u32 m0, s42, s29
    s_nop 0
    buffer_load_dwordx4 v30, s[12:15], s25 offen offset:0 lds
    buffer_load_dwordx4 v30, s[12:15], s25 offen offset:1024 lds
    buffer_load_dwordx4 v30, s[12:15], s25 offen offset:2048 lds
    buffer_load_dwordx4 v30, s[12:15], s25 offen offset:3072 lds
    s_add_u32 s25, s25, 73728
    s_add_u32 s61, s61, 1
    s_cmp_eq_u32 s61, 18
    s_cselect_b32 s48, 1327104, 0
    s_sub_u32 s25, s25, s48
    s_add_u32 s42, s42, 18432
    s_cmp_eq_u32 s42, 73728
    s_cselect_b32 s42, 0, s42
    s_add_u32 m0, s42, s29
    s_nop 0
    buffer_load_dwordx4 v30, s[12:15], s25 offen offset:0 lds
    buffer_load_dwordx4 v30, s[12:15], s25 offen offset:1024 lds
    buffer_load_dwordx4 v30, s[12:15], s25 offen offset:2048 lds
    buffer_load_dwordx4 v30, s[12:15], s25 offen offset:3072 lds
    s_add_u32 s25, s25, 73728
    s_add_u32 s61, s61, 1
    s_cmp_eq_u32 s61, 18
    s_cselect_b32 s48, 1327104, 0
    s_sub_u32 s25, s25, s48
    s_add_u32 s42, s42, 18432
    s_cmp_eq_u32 s42, 73728
    s_cselect_b32 s42, 0, s42
    s_waitcnt vmcnt(8)
    s_barrier
    s_add_u32 m0, s42, s29
    s_nop 0
    buffer_load_dwordx4 v30, s[12:15], s25 offen offset:0 lds
    buffer_load_dwordx4 v30, s[12:15], s25 offen offset:1024 lds
    buffer_load_dwordx4 v30, s[12:15], s25 offen offset:2048 lds
    buffer_load_dwordx4 v30, s[12:15], s25 offen offset:3072 lds
    s_add_u32 s25, s25, 73728
    s_add_u32 s61, s61, 1
    s_cmp_eq_u32 s61, 18
    s_cselect_b32 s48, 1327104, 0
    s_sub_u32 s25, s25, s48
    s_add_u32 s42, s42, 18432
    s_cmp_eq_u32 s42, 73728
    s_cselect_b32 s42, 0, s42
    s_waitcnt vmcnt(8)
    s_barrier
    s_waitcnt vmcnt(4)
    s_barrier
    s_add_u32 m0, s26, s30
    s_nop 0
    buffer_load_dwordx4 v8, s[8:11], s24 offen offset:0 lds
    buffer_load_dwordx4 v9, s[8:11], s24 offen offset:1024 lds
    buffer_load_dwordx4 v10, s[8:11], s24 offen offset:2048 lds
    buffer_load_dwordx4 v11, s[8:11], s24 offen offset:3072 lds
    s_add_u32 s24, s24, 262144
    s_add_u32 s63, s63, 1
    s_cmp_eq_u32 s63, 18
    s_cselect_b32 s48, 4718592, 0
    s_sub_u32 s24, s24, s48
    s_add_u32 s26, s26, 16384
    s_cmp_eq_u32 s26, 81920
    s_cselect_b32 s26, 0, s26
    s_add_u32 m0, s42, s29
    s_nop 0
    buffer_load_dwordx4 v30, s[12:15], s25 offen offset:0 lds
    buffer_load_dwordx4 v30, s[12:15], s25 offen offset:1024 lds
    buffer_load_dwordx4 v30, s[12:15], s25 offen offset:2048 lds
    buffer_load_dwordx4 v30, s[12:15], s25 offen offset:3072 lds
    s_add_u32 s25, s25, 73728
    s_add_u32 s61, s61, 1
    s_cmp_eq_u32 s61, 18
    s_cselect_b32 s48, 1327104, 0
    s_sub_u32 s25, s25, s48
    s_add_u32 s42, s42, 18432
    s_cmp_eq_u32 s42, 73728
    s_cselect_b32 s42, 0, s42
    s_waitcnt vmcnt(8)
    s_barrier
    s_add_u32 m0, s26, s30
    s_nop 0
    buffer_load_dwordx4 v8, s[8:11], s24 offen offset:0 lds
    buffer_load_dwordx4 v9, s[8:11], s24 offen offset:1024 lds
    buffer_load_dwordx4 v10, s[8:11], s24 offen offset:2048 lds
    buffer_load_dwordx4 v11, s[8:11], s24 offen offset:3072 lds
    s_add_u32 s24, s24, 262144
    s_add_u32 s63, s63, 1
    s_cmp_eq_u32 s63, 18
    s_cselect_b32 s48, 4718592, 0
    s_sub_u32 s24, s24, s48
    s_add_u32 s26, s26, 16384
    s_cmp_eq_u32 s26, 81920
    s_cselect_b32 s26, 0, s26
    s_add_u32 m0, s42, s29
    s_nop 0
    buffer_load_dwordx4 v30, s[12:15], s25 offen offset:0 lds
    buffer_load_dwordx4 v30, s[12:15], s25 offen offset:1024 lds
    buffer_load_dwordx4 v30, s[12:15], s25 offen offset:2048 lds
    buffer_load_dwordx4 v30, s[12:15], s25 offen offset:3072 lds
    s_add_u32 s25, s25, 73728
    s_add_u32 s61, s61, 1
    s_cmp_eq_u32 s61, 18
    s_cselect_b32 s48, 1327104, 0
    s_sub_u32 s25, s25, s48
    s_add_u32 s42, s42, 18432
    s_cmp_eq_u32 s42, 73728
    s_cselect_b32 s42, 0, s42
    s_waitcnt vmcnt(8)
    s_barrier
    s_add_u32 m0, s26, s30
    s_nop 0
    buffer_load_dwordx4 v8, s[8:11], s24 offen offset:0 lds
    buffer_load_dwordx4 v9, s[8:11], s24 offen offset:1024 lds
    buffer_load_dwordx4 v10, s[8:11], s24 offen offset:2048 lds
    buffer_load_dwordx4 v11, s[8:11], s24 offen offset:3072 lds
    s_add_u32 s24, s24, 262144
    s_add_u32 s63, s63, 1
    s_cmp_eq_u32 s63, 18
    s_cselect_b32 s48, 4718592, 0
    s_sub_u32 s24, s24, s48
    s_add_u32 s26, s26, 16384
    s_cmp_eq_u32 s26, 81920
    s_cselect_b32 s26, 0, s26
    s_add_u32 m0, s42, s29
    s_nop 0
    buffer_load_dwordx4 v30, s[12:15], s25 offen offset:0 lds
    buffer_load_dwordx4 v30, s[12:15], s25 offen offset:1024 lds
    buffer_load_dwordx4 v30, s[12:15], s25 offen offset:2048 lds
    buffer_load_dwordx4 v30, s[12:15], s25 offen offset:3072 lds
    s_add_u32 s25, s25, 73728
    s_add_u32 s61, s61, 1
    s_cmp_eq_u32 s61, 18
    s_cselect_b32 s48, 1327104, 0
    s_sub_u32 s25, s25, s48
    s_add_u32 s42, s42, 18432
    s_cmp_eq_u32 s42, 73728
    s_cselect_b32 s42, 0, s42
    s_mov_b32 s27, 10
k5_o1_ld_loop:
    s_waitcnt vmcnt(8)
    s_barrier
    s_add_u32 m0, s26, s30
    s_nop 0
    buffer_load_dwordx4 v8, s[8:11], s24 offen offset:0 lds
    buffer_load_dwordx4 v9, s[8:11], s24 offen offset:1024 lds
    buffer_load_dwordx4 v10, s[8:11], s24 offen offset:2048 lds
    buffer_load_dwordx4 v11, s[8:11], s24 offen offset:3072 lds
    s_add_u32 s24, s24, 262144
    s_add_u32 s63, s63, 1
    s_cmp_eq_u32 s63, 18
    s_cselect_b32 s48, 4718592, 0
    s_sub_u32 s24, s24, s48
    s_add_u32 s26, s26, 16384
    s_cmp_eq_u32 s26, 81920
    s_cselect_b32 s26, 0, s26
    s_add_u32 m0, s42, s29
    s_nop 0
    buffer_load_dwordx4 v30, s[12:15], s25 offen offset:0 lds
    buffer_load_dwordx4 v30, s[12:15], s25 offen offset:1024 lds
    buffer_load_dwordx4 v30, s[12:15], s25 offen offset:2048 lds
    buffer_load_dwordx4 v30, s[12:15], s25 offen offset:3072 lds
    s_add_u32 s25, s25, 73728
    s_add_u32 s61, s61, 1
    s_cmp_eq_u32 s61, 18
    s_cselect_b32 s48, 1327104, 0
    s_sub_u32 s25, s25, s48
    s_add_u32 s42, s42, 18432
    s_cmp_eq_u32 s42, 73728
    s_cselect_b32 s42, 0, s42
    s_sub_u32 s27, s27, 1
    s_cmp_lg_u32 s27, 0
    s_cbranch_scc1 k5_o1_ld_loop
    s_waitcnt vmcnt(8)
    s_barrier
    s_lshl_b32 s43, s21, 2
    s_add_u32 s43, s43, s23
    s_lshl_b32 s43, s43, 2
    s_add_u32 s43, s43, s22
    s_mul_i32 s43, s43, 9216
    s_add_u32 s43, s43, 0
    s_lshl_b32 s49, s20, 10
    s_add_u32 m0, s49, 122880
    s_add_u32 s48, s43, s49
    s_add_u32 s48, s48, 0
    buffer_load_dwordx4 v30, s[12:15], s48 offen lds
    s_add_u32 m0, s49, 126976
    s_add_u32 s48, s43, s49
    s_add_u32 s48, s48, 4096
    buffer_load_dwordx4 v30, s[12:15], s48 offen lds
    s_mov_b32 m0, 131072
    s_add_u32 s48, s43, 8192
    buffer_load_dwordx4 v30, s[12:15], s48 offen lds
    s_add_u32 m0, s42, s29
    s_nop 0
    buffer_load_dwordx4 v30, s[12:15], s25 offen offset:0 lds
    buffer_load_dwordx4 v30, s[12:15], s25 offen offset:1024 lds
    buffer_load_dwordx4 v30, s[12:15], s25 offen offset:2048 lds
    buffer_load_dwordx4 v30, s[12:15], s25 offen offset:3072 lds
    s_add_u32 s25, s25, 73728
    s_add_u32 s61, s61, 1
    s_cmp_eq_u32 s61, 18
    s_cselect_b32 s48, 1327104, 0
    s_sub_u32 s25, s25, s48
    s_add_u32 s42, s42, 18432
    s_cmp_eq_u32 s42, 73728
    s_cselect_b32 s42, 0, s42
    s_waitcnt vmcnt(7)
    s_barrier
    s_waitcnt vmcnt(0)
    s_barrier
    s_endpgm
k5_end:
    s_endpgm
all_code_end:
    s_endpgm
.section .rodata,"a"
.p2align 6
.amdhsa_kernel sequential_preLN__sliding_block__mixer_token_mlp__prompt_kernel
  .amdhsa_next_free_vgpr 256
  .amdhsa_next_free_sgpr 102
  .amdhsa_accum_offset 256
  .amdhsa_group_segment_fixed_size 0
  .amdhsa_kernarg_size 88
  .amdhsa_user_sgpr_count 2
  .amdhsa_user_sgpr_kernarg_segment_ptr 1
  .amdhsa_system_sgpr_workgroup_id_x 1
  .amdhsa_float_denorm_mode_32 3
.end_amdhsa_kernel
```
